```python
import torch

def _softmax(x, axis=-1):
    return torch.softmax(x, dim=axis)
def _gelu(x):
    return torch.nn.functional.gelu(x, approximate="tanh")
def _silu(x):
    return torch.nn.functional.silu(x)
def _sigmoid(x):
    return torch.sigmoid(x)
def _layernorm(x, axis=-1, eps=1e-5):
    m = x.mean(dim=axis, keepdim=True)
    v = x.var(dim=axis, keepdim=True, unbiased=False)
    return (x - m) / torch.sqrt(v + eps)
def _scatter_add(tgt, idx, src, axis=0):
    return tgt.clone().index_add_(axis, idx, src)
def _segment_sum(src, seg, n):
    out = torch.zeros((n,) + src.shape[1:], dtype=src.dtype)
    return out.index_add_(0, seg, src)
def _pad(x, pw):
    flat = tuple(v for pair in reversed(pw) for v in pair)
    return torch.nn.functional.pad(x, flat)

kernel_name = 'concat_heads__ssm_conv_s4d__spectral_gfnet__prompt'

def setup_inputs():

    _w = (lambda a: (lambda t: t.to(torch.bfloat16) if t.is_floating_point() else t)(torch.as_tensor(a)))
    def _A_setup():
        Bsz, L, D, N = 1, 2048, 1024, 128
        return {
            "u": _w((lambda *s: torch.randn(*s, dtype=torch.bfloat16) * 0.05)(Bsz, L, D)),
            "log_A_real": _w((lambda *s: torch.randn(*s, dtype=torch.bfloat16) * 6.4)(D, N) * 0.5),
            "A_imag": _w((lambda *s: torch.randn(*s, dtype=torch.bfloat16) * 0.05)(D, N) * 3.14),
            "C_real": _w((lambda *s: torch.randn(*s, dtype=torch.bfloat16) * 0.05)(D, N) / N ** 0.5),
            "C_imag": _w((lambda *s: torch.randn(*s, dtype=torch.bfloat16) * 0.05)(D, N) / N ** 0.5),
            "log_dt": _w((lambda *s: torch.randn(*s, dtype=torch.bfloat16) * 0.05)(D) * 0.5 - 4.0),
            "D_skip": _w((lambda *s: torch.randn(*s, dtype=torch.bfloat16) * 0.05)(D)),
        }
    _A_in = _A_setup()

    def _B_setup():
        B, S, D = 1, 2048, 1024
        Df = D // 2 + 1
        return {
            "x": _w((lambda *s: torch.randn(*s, dtype=torch.bfloat16) * 0.05)(B, S, D)),
            "w_r": _w((lambda *s: torch.randn(*s, dtype=torch.bfloat16) * 0.8)(S, Df) * 0.02),
            "w_i": _w((lambda *s: torch.randn(*s, dtype=torch.bfloat16) * 0.8)(S, Df) * 0.02),
        }
    _B_in = _B_setup()

    return {
        "A_u": _A_in["u"],
        "A_log_A_real": _A_in["log_A_real"],
        "A_A_imag": _A_in["A_imag"],
        "A_C_real": _A_in["C_real"],
        "A_C_imag": _A_in["C_imag"],
        "A_log_dt": _A_in["log_dt"],
        "A_D_skip": _A_in["D_skip"],
        "B_x": _B_in["x"],
        "B_w_r": _B_in["w_r"],
        "B_w_i": _B_in["w_i"],
    }

def reference(A_u, A_log_A_real, A_A_imag, A_C_real, A_C_imag, A_log_dt, A_D_skip, B_x, B_w_r, B_w_i):
    def _A_ref(u, log_A_real, A_imag, C_real, C_imag, log_dt, D_skip):
        L = u.shape[1]
        dt = torch.exp(log_dt)
        A = -torch.exp(log_A_real) + 1j * A_imag
        C = (C_real + 1j * C_imag) * dt[:, None]
        pos = (lambda x, dt: x.to(dt))(torch.arange(L), log_dt.dtype)
        P = torch.exp((A * dt[:, None])[:, :, None] * pos[None, None, :])
        K = 2.0 * torch.einsum("dn,dnl->dl", C, P).real
        L2 = 2 * L
        u_t = (lambda x, *d: x.permute(*d))(u, 0, 2, 1)
        Kf = (lambda x, *a, **k: torch.fft.rfft(x.float(), *a, **k))(K, L2)
        Uf = (lambda x, *a, **k: torch.fft.rfft(x.float(), *a, **k))(u_t, L2)
        y = (lambda x, *a, **k: torch.fft.irfft(x, *a, **k).to(torch.bfloat16))(Uf * Kf[None, :, :], L2)[:, :, :L]
        y = (lambda x, *d: x.permute(*d))(y, 0, 2, 1)
        return y + u * D_skip[None, None, :]

    def _B_ref(x, w_r, w_i):
        B, S, D = x.shape
        X = (lambda x, axes=(-2,-1): torch.fft.rfft2(x.float(), dim=axes))(x, axes=(-2, -1))
        W = w_r + 1j * w_i
        X = X * W
        y = (lambda x, s, axes=(-2,-1): torch.fft.irfft2(x, s=s, dim=axes).to(torch.bfloat16))(X, (S, D), axes=(-2, -1))
        return y

    a = _A_ref(A_u, A_log_A_real, A_A_imag, A_C_real, A_C_imag, A_log_dt, A_D_skip)
    b = _B_ref(B_x, B_w_r, B_w_i)
    return torch.concatenate([a, b], axis=-1)
```

```asm
; @launch grid=(776,1,1) block=(256,1,1) lds=53248
.amdgcn_target "amdgcn-amd-amdhsa--gfx950"
.text
.globl concat_heads__ssm_conv_s4d__spectral_gfnet__prompt_kernel
.p2align 8
.type concat_heads__ssm_conv_s4d__spectral_gfnet__prompt_kernel,@function
concat_heads__ssm_conv_s4d__spectral_gfnet__prompt_kernel:
    s_load_dwordx16 s[52:67], s[0:1], 0
    s_load_dwordx8 s[68:75], s[0:1], 64
    s_load_dwordx2 s[76:77], s[0:1], 96
    s_cmp_lt_u32 s2, 192
    s_cbranch_scc0 L_nopf
    s_getpc_b64 s[42:43]
L_npfpc:
    s_lshr_b32 s3, s2, 3
    s_and_b32 s5, s3, 7
    s_lshr_b32 s3, s3, 3
    s_lshl_b32 s3, s3, 15
    s_lshl_b32 s5, s5, 7
    s_add_u32 s3, s3, s5
    v_lshrrev_b32 v166, 3, v0
    v_lshl_add_u32 v166, v166, 10, s3
    v_min_u32 v166, (L_tab-L_npfpc+41980), v166
    global_load_dword v167, v166, s[42:43]
L_nopf:
    v_and_b32 v1, 63, v0
    v_lshrrev_b32 v2, 6, v0
    s_nop 0
    v_readfirstlane_b32 s4, v2
    v_mov_b32 v165, 0
    s_and_b32 s40, s2, 255
    s_lshr_b32 s3, s2, 8
    s_cmp_eq_u32 s3, 1
    s_cbranch_scc1 L_typeB
    s_and_b32 s5, s2, 7
    s_lshl_b32 s5, s5, 5
    s_lshr_b32 s40, s40, 3
    s_or_b32 s40, s40, s5
    s_cmp_eq_u32 s3, 2
    s_cbranch_scc1 L_typeT
    s_cmp_eq_u32 s3, 0
    s_cbranch_scc0 L_typeN0
    s_getpc_b64 s[44:45]
L_tabpc1:
    s_add_u32 s44, s44, (L_tab-L_tabpc1)
    s_addc_u32 s45, s45, 0
    s_mov_b32 s46, 41984
    s_mov_b32 s47, 0x00020000
    v_lshlrev_b32 v3, 4, v1
    s_lshl_b32 s5, s4, 11
    s_add_u32 s6, s5, 2048
    s_mov_b32 m0, s6
    s_add_u32 s5, s5, 16384
    buffer_load_dwordx4 v3, s[44:47], s5 offen lds
    buffer_load_dwordx4 v3, s[44:47], s5 offen offset:1024 lds
    s_cmp_lg_u32 s4, 3
    s_cbranch_scc1 L_at1
    buffer_load_dwordx4 v3, s[44:47], s5 offen offset:2048 lds
L_at1:
    s_lshr_b32 s5, s40, 2
    s_lshl_b32 s5, s5, 4
    s_and_b32 s6, s40, 3
    s_add_u32 s5, s5, s6
    s_lshl_b32 s6, s4, 2
    s_add_u32 s5, s5, s6
    s_lshl_b32 s6, s5, 8
    s_lshr_b32 s7, s5, 1
    s_lshl_b32 s7, s7, 2
    s_and_b32 s35, s5, 1
    s_lshl_b32 s35, s35, 4
    v_lshlrev_b32 v2, 2, v1
    s_lshr_b32 s34, s40, 4
    s_lshl_b32 s33, s34, 10
    s_add_u32 s33, s33, 16973824
    s_lshl_b32 s34, s34, 7
    s_add_u32 s34, s34, 16777344
    s_waitcnt lgkmcnt(0)
    s_load_dword s28, s[62:63], s7
    s_load_dword s29, s[64:65], s7
    s_load_dword s98, s[76:77], s34
    s_mov_b64 s[8:9], s[54:55]
    s_mov_b32 s10, 262144
    s_mov_b32 s11, 0x00020000
    s_mov_b64 s[12:13], s[56:57]
    s_mov_b32 s14, 262144
    s_mov_b32 s15, 0x00020000
    s_mov_b64 s[20:21], s[58:59]
    s_mov_b32 s22, 262144
    s_mov_b32 s23, 0x00020000
    s_mov_b64 s[24:25], s[60:61]
    s_mov_b32 s26, 262144
    s_mov_b32 s27, 0x00020000
    buffer_load_dword v92, v2, s[8:11], s6 offen nt
    buffer_load_dword v93, v2, s[12:15], s6 offen nt
    buffer_load_dword v94, v2, s[20:23], s6 offen nt
    buffer_load_dword v95, v2, s[24:27], s6 offen nt
    s_branch L_typeA2
L_typeB:
    v_lshlrev_b32 v3, 4, v1
    s_lshl_b32 s5, s4, 12
    s_getpc_b64 s[12:13]
L_tabpc2:
    s_add_u32 s12, s12, (L_tab-L_tabpc2)
    s_addc_u32 s13, s13, 0
    s_mov_b32 s14, 41984
    s_mov_b32 s15, 0x00020000
    s_add_u32 s6, s5, 36864
    s_mov_b32 m0, s6
    s_setprio 2
    buffer_load_dwordx4 v3, s[12:15], s5 offen offset:0 lds
    buffer_load_dwordx4 v3, s[12:15], s5 offen offset:1024 lds
    buffer_load_dwordx4 v3, s[12:15], s5 offen offset:2048 lds
    buffer_load_dwordx4 v3, s[12:15], s5 offen offset:3072 lds
    s_mov_b32 m0, s5
    v_lshrrev_b32 v4, 5, v1
    v_bfe_u32 v2, v1, 2, 2
    v_lshl_add_u32 v2, v4, 3, v2
    v_lshl_add_u32 v2, v2, 6, s5
    v_bfe_u32 v5, v1, 4, 1
    v_lshl_add_u32 v2, v5, 5, v2
    v_and_b32 v5, 3, v1
    v_lshl_add_u32 v2, v5, 3, v2
    s_lshl_b32 s5, s40, 11
    s_lshl_b32 s6, s4, 20
    s_add_u32 s5, s5, s6
    s_add_u32 s6, s5, 522240
    s_mov_b32 s50, 16777216
    s_lshl2_add_u32 s7, s40, s4
    s_lshl_b32 s7, s7, 7
    s_add_u32 s7, s7, 16842752
    v_lshlrev_b32 v92, 2, v1
    v_mov_b32 v93, 1513920000
    s_mov_b32 s18, 268435456
    s_mov_b32 s19, 0x00020000
    s_mov_b32 s10, 4194304
    s_mov_b32 s11, 0x00020000
    s_mov_b32 s30, 2101248
    s_mov_b32 s31, 0x00020000
    s_mov_b32 s34, 2101248
    s_mov_b32 s35, 0x00020000
    s_mov_b32 s38, 8388608
    s_mov_b32 s39, 0x00020000
    v_lshrrev_b32 v95, 5, v1
    v_mul_u32_u24 v95, 8208, v95
    v_and_b32 v94, 31, v1
    v_lshlrev_b32 v94, 7, v94
    v_min_u32 v94, 1022, v94
    v_add_u32 v95, v94, v95
    s_and_b32 s44, s40, 7
    s_mul_i32 s44, s44, 1026
    s_lshr_b32 s45, s40, 3
    s_lshl_b32 s45, s45, 2
    s_add_u32 s45, s45, s4
    s_mul_i32 s45, s45, 16416
    s_add_u32 s44, s44, s45
    s_mov_b64 exec, 65535
    s_waitcnt lgkmcnt(0)
    s_mov_b64 s[16:17], s[76:77]
    s_mov_b64 s[8:9], s[66:67]
    buffer_store_dword v93, v92, s[16:19], s7 offen sc1
    s_mov_b64 exec, -1
    buffer_load_dwordx4 v3, s[8:11], s5 offen nt lds
    buffer_load_dwordx4 v3, s[8:11], s5 offen offset:1024 nt lds
    buffer_load_dwordx4 v3, s[8:11], s6 offen offset:2048 nt lds
    buffer_load_dwordx4 v3, s[8:11], s6 offen offset:3072 nt lds
    s_load_dword s98, s[76:77], s50
    s_mov_b64 s[28:29], s[68:69]
    s_mov_b64 s[32:33], s[70:71]
    s_mov_b64 s[36:37], s[72:73]
    s_branch L_typeB2
L_typeT:
    s_lshr_b32 s26, s40, 4
    s_lshl_b32 s25, s26, 10
    s_add_u32 s25, s25, 16973824
    s_lshl_b32 s26, s26, 7
    s_add_u32 s26, s26, 16777344
    s_bfe_u32 s41, s40, 0x40000
    s_lshl2_add_u32 s42, s41, s4
    s_lshl_b32 s42, s42, 7
    s_add_u32 s42, s42, s25
    v_lshlrev_b32 v2, 2, v1
    s_and_b32 s93, s40, 15
    s_lshl_b32 s93, s93, 2
    s_add_u32 s93, s93, s4
    s_lshr_b32 s92, s40, 4
    v_and_b32 v6, 15, v1
    v_lshrrev_b32 v7, 4, v1
    v_lshlrev_b32 v4, 14, v7
    v_lshl_add_u32 v4, v6, 3, v4
    v_lshrrev_b32 v5, 2, v6
    v_lshlrev_b32 v5, 16, v5
    v_lshl_add_u32 v5, v7, 6, v5
    v_xor_b32 v6, s93, v6
    v_and_b32 v6, 3, v6
    v_lshl_add_u32 v5, v6, 4, v5
    s_lshl_b32 s94, s93, 16
    s_lshl_b32 s95, s92, 7
    s_add_u32 s94, s94, s95
    s_lshl_b32 s95, s92, 18
    s_lshl_b32 s93, s93, 8
    s_add_u32 s95, s95, s93
    s_add_u32 s95, s95, 8388608
    s_mov_b32 s96, 0x05040100
    s_mov_b32 s97, 0x07060302
    s_waitcnt lgkmcnt(0)
    s_load_dword s98, s[76:77], s26
    s_mov_b64 s[16:17], s[76:77]
    s_mov_b32 s18, 268435456
    s_mov_b32 s19, 0x00020000
    s_mov_b64 s[84:85], s[52:53]
    s_mov_b32 s86, 4194304
    s_mov_b32 s87, 0x00020000
    s_cmp_lt_u32 s41, 2
    s_cbranch_scc0 L_t_ni
    s_waitcnt lgkmcnt(0)
    s_not_b32 s43, s98
    s_xor_b32 s43, s43, 0x55555555
    s_andn2_b32 s43, s43, 255
    s_cmp_eq_u32 s41, 0
    s_cselect_b32 s43, s43, 1513920000
    v_mov_b32 v3, s43
    s_mov_b64 exec, 65535
    buffer_store_dword v3, v2, s[16:19], s42 offen sc1
    s_mov_b64 exec, -1
L_t_ni:
    buffer_load_dwordx2 v[16:17], v4, s[84:87], s94 offen offset:0 nt
    buffer_load_dwordx2 v[18:19], v4, s[84:87], s94 offen offset:2048 nt
    s_add_u32 s94, s94, 4096
    buffer_load_dwordx2 v[20:21], v4, s[84:87], s94 offen offset:0 nt
    buffer_load_dwordx2 v[22:23], v4, s[84:87], s94 offen offset:2048 nt
    s_add_u32 s94, s94, 4096
    buffer_load_dwordx2 v[24:25], v4, s[84:87], s94 offen offset:0 nt
    buffer_load_dwordx2 v[26:27], v4, s[84:87], s94 offen offset:2048 nt
    s_add_u32 s94, s94, 4096
    buffer_load_dwordx2 v[28:29], v4, s[84:87], s94 offen offset:0 nt
    buffer_load_dwordx2 v[30:31], v4, s[84:87], s94 offen offset:2048 nt
    s_bfe_u32 s24, s40, 0x20002
    s_lshl_b32 s24, s24, 7
    s_add_u32 s24, s24, s25
    s_waitcnt lgkmcnt(0)
    s_not_b32 s98, s98
    s_bfe_i32 s99, s98, 0x10000
    s_andn2_b32 s100, 0x10001, s99
    s_mov_b32 s101, 0x07060302
    s_mov_b32 s80, 1513920000
    s_mov_b64 s[82:83], 0
    s_xor_b32 s80, s98, 0x55555555
    s_andn2_b32 s80, s80, 255
    s_setprio 3
    s_waitcnt vmcnt(0)
    s_barrier
    v_perm_b32 v32, v18, v16, s96
    v_perm_b32 v33, v22, v20, s96
    v_perm_b32 v34, v26, v24, s96
    v_perm_b32 v35, v30, v28, s96
    buffer_store_dwordx4 v[32:35], v5, s[16:19], s95 offen sc1
    v_perm_b32 v36, v18, v16, s97
    v_perm_b32 v37, v22, v20, s97
    v_perm_b32 v38, v26, v24, s97
    v_perm_b32 v39, v30, v28, s97
    s_add_u32 s95, s95, 16384
    buffer_store_dwordx4 v[36:39], v5, s[16:19], s95 offen sc1
    v_perm_b32 v40, v19, v17, s96
    v_perm_b32 v41, v23, v21, s96
    v_perm_b32 v42, v27, v25, s96
    v_perm_b32 v43, v31, v29, s96
    s_add_u32 s95, s95, 16384
    buffer_store_dwordx4 v[40:43], v5, s[16:19], s95 offen sc1
    v_perm_b32 v44, v19, v17, s97
    v_perm_b32 v45, v23, v21, s97
    v_perm_b32 v46, v27, v25, s97
    v_perm_b32 v47, v31, v29, s97
    s_add_u32 s95, s95, 16384
    buffer_store_dwordx4 v[44:47], v5, s[16:19], s95 offen sc1
    s_waitcnt vmcnt(0)
    v_mul_u32_u24 v165, 0, v1
    v_mov_b32 v167, 1
    s_mov_b32 s82, 1
    s_mov_b64 exec, s[82:83]
    buffer_atomic_add v167, v165, s[16:19], s24 offen sc0 sc1
    s_mov_b64 exec, -1
L_hs_1:
    s_mov_b32 s51, 0
L_hw_2:
    s_waitcnt vmcnt(0)
    s_mov_b64 exec, s[82:83]
    v_xor_b32 v167, s80, v167
    v_cmp_le_u32 vcc, 16, v167
    s_nop 0
    s_mov_b64 s[82:83], vcc
    s_cbranch_vccz L_ac_4
    s_mov_b64 exec, vcc
    v_mov_b32 v167, 1
    buffer_atomic_add v167, v165, s[16:19], s24 offen sc0 sc1
L_ac_4:
    s_add_u32 s51, s51, 1
    s_cbranch_vccz L_hok_3
    s_cmp_gt_u32 s51, 30000
    s_cbranch_scc1 L_hok_3
    s_sleep 1
    s_branch L_hw_2
L_hok_3:
    s_mov_b64 exec, -1
    s_endpgm
L_typeA2:
    s_mov_b64 s[16:17], s[76:77]
    s_mov_b32 s18, 268435456
    s_mov_b32 s19, 0x00020000
    s_mov_b64 s[88:89], s[72:73]
    s_mov_b32 s90, 8388608
    s_mov_b32 s91, 0x00020000
    s_mul_i32 s36, s4, 8704
    s_add_u32 s36, s36, 18432
    s_mov_b32 m0, s36
    v_mov_b32 v160, 0
    v_mov_b32 v161, 0
    v_lshlrev_b32 v162, 3, v0
    ds_write_b64 v162, v[160:161]
    v_mov_b32 v17, 0
    v_mov_b32 v18, 0
    v_mov_b32 v19, 0
    v_mov_b32 v20, 0
    v_mov_b32 v21, 0
    v_mov_b32 v22, 0
    v_mov_b32 v23, 0
    v_mov_b32 v24, 0
    v_mov_b32 v25, 0
    v_mov_b32 v26, 0
    v_mov_b32 v27, 0
    v_mov_b32 v28, 0
    v_mov_b32 v29, 0
    v_mov_b32 v30, 0
    v_mov_b32 v31, 0
    s_lshl_b32 s5, s4, 12
    s_lshl_b32 s6, s40, 14
    s_add_u32 s6, s6, s5
    s_add_u32 s38, s6, 12582912
    s_add_u32 s6, s6, 8388608
    s_lshl_b32 s39, s4, 4
    s_waitcnt vmcnt(4)
    s_barrier
    ds_read_b128 v[120:123], v3 offset:2048
    ds_read_b128 v[124:127], v3 offset:3072
    ds_read_b128 v[128:131], v3 offset:4096
    ds_read_b128 v[132:135], v3 offset:5120
    ds_read_b128 v[136:139], v3 offset:6144
    ds_read_b128 v[4:7], v3 offset:7168
    ds_read_b128 v[8:11], v3 offset:8192
    ds_read_b128 v[12:15], v3 offset:9216
    ds_read_b128 v[112:115], v3 offset:10240
    v_mov_b32 v2, v3
    s_add_u32 s41, s36, 1072
    v_sub_u32 v3, s41, v2
    s_waitcnt lgkmcnt(0)
    s_barrier
    v_xor_b32 v5, s39, v5
    v_xor_b32 v7, s39, v7
    v_xor_b32 v8, s39, v8
    v_xor_b32 v9, s39, v9
    v_xor_b32 v10, s39, v10
    v_xor_b32 v11, s39, v11
    v_xor_b32 v14, s39, v14
    v_xor_b32 v15, s39, v15
    v_add_u32 v4, s36, v4
    v_add_u32 v6, s36, v6
    v_add_u32 v12, s36, v12
    v_add_u32 v13, s36, v13
    v_add_u32 v112, s36, v112
    v_add_u32 v113, s36, v113
    v_add_u32 v114, s36, v114
    v_add_u32 v115, s36, v115
    s_waitcnt lgkmcnt(0)
    s_not_b32 s98, s98
    s_bfe_i32 s99, s98, 0x10000
    s_andn2_b32 s100, 0x10001, s99
    s_mov_b32 s101, 0x07060302
    s_mov_b32 s80, 1513920000
    s_mov_b64 s[82:83], 0
    s_lshr_b32 s28, s28, s35
    s_lshl_b32 s28, s28, 16
    s_lshr_b32 s29, s29, s35
    s_lshl_b32 s29, s29, 16
    v_mov_b32 v110, s28
    v_mov_b32 v108, s29
    v_mul_f32 v160, 0x3fb8aa00, v110
    v_mul_f32 v161, 0x36eca570, v110
    v_exp_f32 v160, v160
    v_exp_f32 v161, v161
    s_nop 0
    v_mul_f32 v160, v160, v161
    v_cvt_pk_bf16_f32 v160, v160, v160
    v_and_b32 v160, 0xffff0000, v160
    v_mov_b32 v110, v160
    v_cmp_eq_u32 vcc, 0, v1
    s_nop 1
    v_cndmask_b32 v16, 0, v108, vcc
    s_waitcnt vmcnt(0)
    v_lshlrev_b32 v88, 16, v92
    v_and_b32 v92, 0xffff0000, v92
    v_lshlrev_b32 v89, 16, v93
    v_and_b32 v93, 0xffff0000, v93
    v_lshlrev_b32 v90, 16, v94
    v_and_b32 v94, 0xffff0000, v94
    v_lshlrev_b32 v91, 16, v95
    v_and_b32 v95, 0xffff0000, v95
    s_mov_b32 s37, 0
    s_mov_b32 s42, 0
    s_mov_b32 s51, 0
    s_xor_b32 s43, s98, 0x55555555
    s_andn2_b32 s43, s43, 255
    s_lshl_b32 s32, s4, 7
    s_add_u32 s32, s32, s33
    s_add_u32 s43, s43, 16
L_kg_loop:
    v_mul_f32 v111, 0x3fb8aa00, v88
    v_mul_f32 v160, 0x36eca570, v88
    v_exp_f32 v111, v111
    v_exp_f32 v160, v160
    s_nop 0
    v_mul_f32 v111, v111, v160
    v_cvt_pk_bf16_f32 v111, v111, v111
    v_and_b32 v111, 0xffff0000, v111
    v_mul_f32 v111, v111, v110
    v_mul_f32 v111, 0xbfb8aa3b, v111
    v_mul_f32 v164, v89, v110
    v_mul_f32 v164, 0x3e22f983, v164
    v_mul_f32 v160, 0x41000000, v111
    v_mul_f32 v161, 0x41000000, v164
    v_exp_f32 v160, v160
    v_fract_f32 v161, v161
    v_cos_f32 v100, v161
    v_sin_f32 v101, v161
    v_mul_f32 v100, v100, v160
    v_mul_f32 v101, v101, v160
    v_mul_f32 v106, v90, v110
    v_mul_f32 v107, v91, v110
    v_add_f32 v106, v106, v106
    v_add_f32 v107, v107, v107
    v_mul_f32 v160, 0x3f800000, v111
    v_mul_f32 v161, 0x3f800000, v164
    v_exp_f32 v160, v160
    v_fract_f32 v161, v161
    v_cos_f32 v96, v161
    v_sin_f32 v97, v161
    v_mul_f32 v96, v96, v160
    v_mul_f32 v97, v97, v160
    v_mul_f32 v160, 0x43800000, v111
    v_mul_f32 v161, 0x43800000, v164
    v_exp_f32 v160, v160
    v_fract_f32 v161, v161
    v_cos_f32 v104, v161
    v_sin_f32 v105, v161
    v_mul_f32 v104, v104, v160
    v_mul_f32 v105, v105, v160
    v_cvt_pk_bf16_f32 v80, 1.0, 0
    ds_write_addtid_b32 v80 offset:0
    v_pk_mul_f32 v[142:143], v[100:101], v[100:101] op_sel:[0,0] op_sel_hi:[0,1]
    v_pk_fma_f32 v[142:143], v[100:101], v[100:101], v[142:143] op_sel:[1,1,0] op_sel_hi:[1,0,1] neg_lo:[1,0,0]
    v_cvt_pk_bf16_f32 v81, v100, -v101
    ds_write_addtid_b32 v81 offset:272
    v_pk_mul_f32 v[144:145], v[142:143], v[100:101] op_sel:[0,0] op_sel_hi:[0,1]
    v_pk_fma_f32 v[144:145], v[142:143], v[100:101], v[144:145] op_sel:[1,1,0] op_sel_hi:[1,0,1] neg_lo:[1,0,0]
    v_pk_mul_f32 v[102:103], v[142:143], v[142:143] op_sel:[0,0] op_sel_hi:[0,1]
    v_pk_fma_f32 v[102:103], v[142:143], v[142:143], v[102:103] op_sel:[1,1,0] op_sel_hi:[1,0,1] neg_lo:[1,0,0]
    v_cvt_pk_bf16_f32 v82, v142, -v143
    ds_write_addtid_b32 v82 offset:544
    v_cvt_pk_bf16_f32 v83, v144, -v145
    ds_write_addtid_b32 v83 offset:816
    v_cvt_pk_bf16_f32 v84, v102, -v103
    ds_write_addtid_b32 v84 offset:1088
    v_pk_mul_f32 v[148:149], v[100:101], v[102:103] op_sel:[0,0] op_sel_hi:[0,1]
    v_pk_mul_f32 v[150:151], v[142:143], v[102:103] op_sel:[0,0] op_sel_hi:[0,1]
    v_pk_mul_f32 v[152:153], v[144:145], v[102:103] op_sel:[0,0] op_sel_hi:[0,1]
    v_pk_mul_f32 v[154:155], v[102:103], v[102:103] op_sel:[0,0] op_sel_hi:[0,1]
    v_pk_fma_f32 v[148:149], v[100:101], v[102:103], v[148:149] op_sel:[1,1,0] op_sel_hi:[1,0,1] neg_lo:[1,0,0]
    v_pk_fma_f32 v[150:151], v[142:143], v[102:103], v[150:151] op_sel:[1,1,0] op_sel_hi:[1,0,1] neg_lo:[1,0,0]
    v_pk_fma_f32 v[152:153], v[144:145], v[102:103], v[152:153] op_sel:[1,1,0] op_sel_hi:[1,0,1] neg_lo:[1,0,0]
    v_pk_fma_f32 v[154:155], v[102:103], v[102:103], v[154:155] op_sel:[1,1,0] op_sel_hi:[1,0,1] neg_lo:[1,0,0]
    v_cvt_pk_bf16_f32 v85, v148, -v149
    ds_write_addtid_b32 v85 offset:1360
    v_cvt_pk_bf16_f32 v86, v150, -v151
    ds_write_addtid_b32 v86 offset:1632
    v_cvt_pk_bf16_f32 v87, v152, -v153
    ds_write_addtid_b32 v87 offset:1904
    v_cvt_pk_bf16_f32 v80, v154, -v155
    ds_write_addtid_b32 v80 offset:2176
    v_pk_mul_f32 v[140:141], v[148:149], v[102:103] op_sel:[0,0] op_sel_hi:[0,1]
    v_pk_mul_f32 v[142:143], v[150:151], v[102:103] op_sel:[0,0] op_sel_hi:[0,1]
    v_pk_mul_f32 v[144:145], v[152:153], v[102:103] op_sel:[0,0] op_sel_hi:[0,1]
    v_pk_mul_f32 v[146:147], v[154:155], v[102:103] op_sel:[0,0] op_sel_hi:[0,1]
    v_pk_fma_f32 v[140:141], v[148:149], v[102:103], v[140:141] op_sel:[1,1,0] op_sel_hi:[1,0,1] neg_lo:[1,0,0]
    v_pk_fma_f32 v[142:143], v[150:151], v[102:103], v[142:143] op_sel:[1,1,0] op_sel_hi:[1,0,1] neg_lo:[1,0,0]
    v_pk_fma_f32 v[144:145], v[152:153], v[102:103], v[144:145] op_sel:[1,1,0] op_sel_hi:[1,0,1] neg_lo:[1,0,0]
    v_pk_fma_f32 v[146:147], v[154:155], v[102:103], v[146:147] op_sel:[1,1,0] op_sel_hi:[1,0,1] neg_lo:[1,0,0]
    v_cvt_pk_bf16_f32 v81, v140, -v141
    ds_write_addtid_b32 v81 offset:2448
    v_cvt_pk_bf16_f32 v82, v142, -v143
    ds_write_addtid_b32 v82 offset:2720
    v_cvt_pk_bf16_f32 v83, v144, -v145
    ds_write_addtid_b32 v83 offset:2992
    v_cvt_pk_bf16_f32 v84, v146, -v147
    ds_write_addtid_b32 v84 offset:3264
    v_pk_mul_f32 v[148:149], v[140:141], v[102:103] op_sel:[0,0] op_sel_hi:[0,1]
    v_pk_mul_f32 v[150:151], v[142:143], v[102:103] op_sel:[0,0] op_sel_hi:[0,1]
    v_pk_mul_f32 v[152:153], v[144:145], v[102:103] op_sel:[0,0] op_sel_hi:[0,1]
    v_pk_mul_f32 v[154:155], v[146:147], v[102:103] op_sel:[0,0] op_sel_hi:[0,1]
    v_pk_fma_f32 v[148:149], v[140:141], v[102:103], v[148:149] op_sel:[1,1,0] op_sel_hi:[1,0,1] neg_lo:[1,0,0]
    v_pk_fma_f32 v[150:151], v[142:143], v[102:103], v[150:151] op_sel:[1,1,0] op_sel_hi:[1,0,1] neg_lo:[1,0,0]
    v_pk_fma_f32 v[152:153], v[144:145], v[102:103], v[152:153] op_sel:[1,1,0] op_sel_hi:[1,0,1] neg_lo:[1,0,0]
    v_pk_fma_f32 v[154:155], v[146:147], v[102:103], v[154:155] op_sel:[1,1,0] op_sel_hi:[1,0,1] neg_lo:[1,0,0]
    v_cvt_pk_bf16_f32 v85, v148, -v149
    ds_write_addtid_b32 v85 offset:3536
    v_cvt_pk_bf16_f32 v86, v150, -v151
    ds_write_addtid_b32 v86 offset:3808
    v_cvt_pk_bf16_f32 v87, v152, -v153
    ds_write_addtid_b32 v87 offset:4080
    v_cvt_pk_bf16_f32 v80, v154, -v155
    ds_write_addtid_b32 v80 offset:4352
    v_pk_mul_f32 v[140:141], v[148:149], v[102:103] op_sel:[0,0] op_sel_hi:[0,1]
    v_pk_mul_f32 v[142:143], v[150:151], v[102:103] op_sel:[0,0] op_sel_hi:[0,1]
    v_pk_mul_f32 v[144:145], v[152:153], v[102:103] op_sel:[0,0] op_sel_hi:[0,1]
    v_pk_mul_f32 v[146:147], v[154:155], v[102:103] op_sel:[0,0] op_sel_hi:[0,1]
    v_pk_fma_f32 v[140:141], v[148:149], v[102:103], v[140:141] op_sel:[1,1,0] op_sel_hi:[1,0,1] neg_lo:[1,0,0]
    v_pk_fma_f32 v[142:143], v[150:151], v[102:103], v[142:143] op_sel:[1,1,0] op_sel_hi:[1,0,1] neg_lo:[1,0,0]
    v_pk_fma_f32 v[144:145], v[152:153], v[102:103], v[144:145] op_sel:[1,1,0] op_sel_hi:[1,0,1] neg_lo:[1,0,0]
    v_pk_fma_f32 v[146:147], v[154:155], v[102:103], v[146:147] op_sel:[1,1,0] op_sel_hi:[1,0,1] neg_lo:[1,0,0]
    v_cvt_pk_bf16_f32 v81, v140, -v141
    ds_write_addtid_b32 v81 offset:4624
    v_cvt_pk_bf16_f32 v82, v142, -v143
    ds_write_addtid_b32 v82 offset:4896
    v_cvt_pk_bf16_f32 v83, v144, -v145
    ds_write_addtid_b32 v83 offset:5168
    v_cvt_pk_bf16_f32 v84, v146, -v147
    ds_write_addtid_b32 v84 offset:5440
    v_pk_mul_f32 v[148:149], v[140:141], v[102:103] op_sel:[0,0] op_sel_hi:[0,1]
    v_pk_mul_f32 v[150:151], v[142:143], v[102:103] op_sel:[0,0] op_sel_hi:[0,1]
    v_pk_mul_f32 v[152:153], v[144:145], v[102:103] op_sel:[0,0] op_sel_hi:[0,1]
    v_pk_mul_f32 v[154:155], v[146:147], v[102:103] op_sel:[0,0] op_sel_hi:[0,1]
    v_pk_fma_f32 v[148:149], v[140:141], v[102:103], v[148:149] op_sel:[1,1,0] op_sel_hi:[1,0,1] neg_lo:[1,0,0]
    v_pk_fma_f32 v[150:151], v[142:143], v[102:103], v[150:151] op_sel:[1,1,0] op_sel_hi:[1,0,1] neg_lo:[1,0,0]
    v_pk_fma_f32 v[152:153], v[144:145], v[102:103], v[152:153] op_sel:[1,1,0] op_sel_hi:[1,0,1] neg_lo:[1,0,0]
    v_pk_fma_f32 v[154:155], v[146:147], v[102:103], v[154:155] op_sel:[1,1,0] op_sel_hi:[1,0,1] neg_lo:[1,0,0]
    v_cvt_pk_bf16_f32 v85, v148, -v149
    ds_write_addtid_b32 v85 offset:5712
    v_cvt_pk_bf16_f32 v86, v150, -v151
    ds_write_addtid_b32 v86 offset:5984
    v_cvt_pk_bf16_f32 v87, v152, -v153
    ds_write_addtid_b32 v87 offset:6256
    v_cvt_pk_bf16_f32 v80, v154, -v155
    ds_write_addtid_b32 v80 offset:6528
    v_pk_mul_f32 v[140:141], v[148:149], v[102:103] op_sel:[0,0] op_sel_hi:[0,1]
    v_pk_mul_f32 v[142:143], v[150:151], v[102:103] op_sel:[0,0] op_sel_hi:[0,1]
    v_pk_mul_f32 v[144:145], v[152:153], v[102:103] op_sel:[0,0] op_sel_hi:[0,1]
    v_pk_mul_f32 v[146:147], v[154:155], v[102:103] op_sel:[0,0] op_sel_hi:[0,1]
    v_pk_fma_f32 v[140:141], v[148:149], v[102:103], v[140:141] op_sel:[1,1,0] op_sel_hi:[1,0,1] neg_lo:[1,0,0]
    v_pk_fma_f32 v[142:143], v[150:151], v[102:103], v[142:143] op_sel:[1,1,0] op_sel_hi:[1,0,1] neg_lo:[1,0,0]
    v_pk_fma_f32 v[144:145], v[152:153], v[102:103], v[144:145] op_sel:[1,1,0] op_sel_hi:[1,0,1] neg_lo:[1,0,0]
    v_pk_fma_f32 v[146:147], v[154:155], v[102:103], v[146:147] op_sel:[1,1,0] op_sel_hi:[1,0,1] neg_lo:[1,0,0]
    v_cvt_pk_bf16_f32 v81, v140, -v141
    ds_write_addtid_b32 v81 offset:6800
    v_cvt_pk_bf16_f32 v82, v142, -v143
    ds_write_addtid_b32 v82 offset:7072
    v_cvt_pk_bf16_f32 v83, v144, -v145
    ds_write_addtid_b32 v83 offset:7344
    v_cvt_pk_bf16_f32 v84, v146, -v147
    ds_write_addtid_b32 v84 offset:7616
    v_pk_mul_f32 v[148:149], v[140:141], v[102:103] op_sel:[0,0] op_sel_hi:[0,1]
    v_pk_mul_f32 v[150:151], v[142:143], v[102:103] op_sel:[0,0] op_sel_hi:[0,1]
    v_pk_mul_f32 v[152:153], v[144:145], v[102:103] op_sel:[0,0] op_sel_hi:[0,1]
    v_pk_fma_f32 v[148:149], v[140:141], v[102:103], v[148:149] op_sel:[1,1,0] op_sel_hi:[1,0,1] neg_lo:[1,0,0]
    v_pk_fma_f32 v[150:151], v[142:143], v[102:103], v[150:151] op_sel:[1,1,0] op_sel_hi:[1,0,1] neg_lo:[1,0,0]
    v_pk_fma_f32 v[152:153], v[144:145], v[102:103], v[152:153] op_sel:[1,1,0] op_sel_hi:[1,0,1] neg_lo:[1,0,0]
    v_cvt_pk_bf16_f32 v85, v148, -v149
    ds_write_addtid_b32 v85 offset:7888
    v_cvt_pk_bf16_f32 v86, v150, -v151
    ds_write_addtid_b32 v86 offset:8160
    v_cvt_pk_bf16_f32 v87, v152, -v153
    ds_write_addtid_b32 v87 offset:8432
    ds_read_b128 v[32:35], v115 offset:0
    ds_read_b128 v[36:39], v115 offset:32
    ds_read_b128 v[40:43], v115 offset:64
    ds_read_b128 v[44:47], v115 offset:96
    ds_read_b128 v[48:51], v115 offset:128
    ds_read_b128 v[52:55], v115 offset:160
    ds_read_b128 v[56:59], v115 offset:192
    ds_read_b128 v[60:63], v115 offset:224
    v_pk_mul_f32 v[98:99], v[96:97], v[96:97] op_sel:[0,0] op_sel_hi:[0,1]
    v_pk_fma_f32 v[98:99], v[96:97], v[96:97], v[98:99] op_sel:[1,1,0] op_sel_hi:[1,0,1] neg_lo:[1,0,0]
    v_pk_mul_f32 v[160:161], v[106:107], v[96:97] op_sel:[0,0] op_sel_hi:[0,1]
    v_pk_fma_f32 v[160:161], v[106:107], v[96:97], v[160:161] op_sel:[1,1,0] op_sel_hi:[1,0,1] neg_lo:[1,0,0]
    v_cvt_pk_bf16_f32 v80, v106, v107
    ds_write_addtid_b32 v80 offset:0
    v_pk_mul_f32 v[142:143], v[106:107], v[98:99] op_sel:[0,0] op_sel_hi:[0,1]
    v_pk_fma_f32 v[142:143], v[106:107], v[98:99], v[142:143] op_sel:[1,1,0] op_sel_hi:[1,0,1] neg_lo:[1,0,0]
    v_cvt_pk_bf16_f32 v81, v160, v161
    ds_write_addtid_b32 v81 offset:272
    v_pk_mul_f32 v[162:163], v[160:161], v[98:99] op_sel:[0,0] op_sel_hi:[0,1]
    v_pk_fma_f32 v[162:163], v[160:161], v[98:99], v[162:163] op_sel:[1,1,0] op_sel_hi:[1,0,1] neg_lo:[1,0,0]
    v_pk_mul_f32 v[144:145], v[142:143], v[98:99] op_sel:[0,0] op_sel_hi:[0,1]
    v_pk_fma_f32 v[144:145], v[142:143], v[98:99], v[144:145] op_sel:[1,1,0] op_sel_hi:[1,0,1] neg_lo:[1,0,0]
    v_cvt_pk_bf16_f32 v82, v142, v143
    ds_write_addtid_b32 v82 offset:544
    v_cvt_pk_bf16_f32 v83, v162, v163
    ds_write_addtid_b32 v83 offset:816
    v_pk_mul_f32 v[160:161], v[162:163], v[98:99] op_sel:[0,0] op_sel_hi:[0,1]
    v_pk_fma_f32 v[160:161], v[162:163], v[98:99], v[160:161] op_sel:[1,1,0] op_sel_hi:[1,0,1] neg_lo:[1,0,0]
    v_pk_mul_f32 v[146:147], v[144:145], v[98:99] op_sel:[0,0] op_sel_hi:[0,1]
    v_pk_fma_f32 v[146:147], v[144:145], v[98:99], v[146:147] op_sel:[1,1,0] op_sel_hi:[1,0,1] neg_lo:[1,0,0]
    v_cvt_pk_bf16_f32 v84, v144, v145
    ds_write_addtid_b32 v84 offset:2176
    v_cvt_pk_bf16_f32 v85, v160, v161
    ds_write_addtid_b32 v85 offset:2448
    v_pk_mul_f32 v[162:163], v[160:161], v[98:99] op_sel:[0,0] op_sel_hi:[0,1]
    v_pk_fma_f32 v[162:163], v[160:161], v[98:99], v[162:163] op_sel:[1,1,0] op_sel_hi:[1,0,1] neg_lo:[1,0,0]
    v_pk_mul_f32 v[148:149], v[146:147], v[98:99] op_sel:[0,0] op_sel_hi:[0,1]
    v_pk_fma_f32 v[148:149], v[146:147], v[98:99], v[148:149] op_sel:[1,1,0] op_sel_hi:[1,0,1] neg_lo:[1,0,0]
    v_cvt_pk_bf16_f32 v86, v146, v147
    ds_write_addtid_b32 v86 offset:2720
    v_cvt_pk_bf16_f32 v87, v162, v163
    ds_write_addtid_b32 v87 offset:2992
    v_cvt_pk_bf16_f32 v80, v148, v149
    ds_write_addtid_b32 v80 offset:4352
    v_pk_mul_f32 v[150:151], v[106:107], v[104:105] op_sel:[0,0] op_sel_hi:[0,1]
    v_pk_mul_f32 v[152:153], v[142:143], v[104:105] op_sel:[0,0] op_sel_hi:[0,1]
    v_pk_mul_f32 v[154:155], v[144:145], v[104:105] op_sel:[0,0] op_sel_hi:[0,1]
    v_pk_mul_f32 v[156:157], v[146:147], v[104:105] op_sel:[0,0] op_sel_hi:[0,1]
    v_pk_mul_f32 v[158:159], v[148:149], v[104:105] op_sel:[0,0] op_sel_hi:[0,1]
    v_pk_fma_f32 v[150:151], v[106:107], v[104:105], v[150:151] op_sel:[1,1,0] op_sel_hi:[1,0,1] neg_lo:[1,0,0]
    v_pk_fma_f32 v[152:153], v[142:143], v[104:105], v[152:153] op_sel:[1,1,0] op_sel_hi:[1,0,1] neg_lo:[1,0,0]
    v_pk_fma_f32 v[154:155], v[144:145], v[104:105], v[154:155] op_sel:[1,1,0] op_sel_hi:[1,0,1] neg_lo:[1,0,0]
    v_pk_fma_f32 v[156:157], v[146:147], v[104:105], v[156:157] op_sel:[1,1,0] op_sel_hi:[1,0,1] neg_lo:[1,0,0]
    v_pk_fma_f32 v[158:159], v[148:149], v[104:105], v[158:159] op_sel:[1,1,0] op_sel_hi:[1,0,1] neg_lo:[1,0,0]
    v_cvt_pk_bf16_f32 v81, v150, v151
    ds_write_addtid_b32 v81 offset:1088
    ds_write_addtid_b32 v81 offset:1360
    v_cvt_pk_bf16_f32 v82, v152, v153
    ds_write_addtid_b32 v82 offset:1632
    v_cvt_pk_bf16_f32 v83, v154, v155
    ds_write_addtid_b32 v83 offset:1904
    ds_write_addtid_b32 v83 offset:3264
    ds_write_addtid_b32 v83 offset:3536
    v_cvt_pk_bf16_f32 v84, v156, v157
    ds_write_addtid_b32 v84 offset:3808
    v_cvt_pk_bf16_f32 v85, v158, v159
    ds_write_addtid_b32 v85 offset:4080
    ds_write_addtid_b32 v85 offset:5440
    v_pk_mul_f32 v[144:145], v[154:155], v[104:105] op_sel:[0,0] op_sel_hi:[0,1]
    v_pk_mul_f32 v[148:149], v[158:159], v[104:105] op_sel:[0,0] op_sel_hi:[0,1]
    v_pk_fma_f32 v[144:145], v[154:155], v[104:105], v[144:145] op_sel:[1,1,0] op_sel_hi:[1,0,1] neg_lo:[1,0,0]
    v_pk_fma_f32 v[148:149], v[158:159], v[104:105], v[148:149] op_sel:[1,1,0] op_sel_hi:[1,0,1] neg_lo:[1,0,0]
    v_cvt_pk_bf16_f32 v86, v144, v145
    ds_write_addtid_b32 v86 offset:4896
    v_cvt_pk_bf16_f32 v87, v148, v149
    ds_write_addtid_b32 v87 offset:5168
    v_pk_mul_f32 v[154:155], v[144:145], v[104:105] op_sel:[0,0] op_sel_hi:[0,1]
    v_pk_mul_f32 v[158:159], v[148:149], v[104:105] op_sel:[0,0] op_sel_hi:[0,1]
    v_pk_fma_f32 v[154:155], v[144:145], v[104:105], v[154:155] op_sel:[1,1,0] op_sel_hi:[1,0,1] neg_lo:[1,0,0]
    v_pk_fma_f32 v[158:159], v[148:149], v[104:105], v[158:159] op_sel:[1,1,0] op_sel_hi:[1,0,1] neg_lo:[1,0,0]
    v_cvt_pk_bf16_f32 v80, v154, v155
    ds_write_addtid_b32 v80 offset:5984
    v_cvt_pk_bf16_f32 v81, v158, v159
    ds_write_addtid_b32 v81 offset:6256
    v_pk_mul_f32 v[148:149], v[158:159], v[104:105] op_sel:[0,0] op_sel_hi:[0,1]
    v_pk_fma_f32 v[148:149], v[158:159], v[104:105], v[148:149] op_sel:[1,1,0] op_sel_hi:[1,0,1] neg_lo:[1,0,0]
    v_cvt_pk_bf16_f32 v82, v148, v149
    ds_write_addtid_b32 v82 offset:6528
    v_pk_mul_f32 v[158:159], v[148:149], v[104:105] op_sel:[0,0] op_sel_hi:[0,1]
    v_pk_fma_f32 v[158:159], v[148:149], v[104:105], v[158:159] op_sel:[1,1,0] op_sel_hi:[1,0,1] neg_lo:[1,0,0]
    v_cvt_pk_bf16_f32 v83, v158, v159
    ds_write_addtid_b32 v83 offset:7616
    v_pk_mul_f32 v[148:149], v[158:159], v[104:105] op_sel:[0,0] op_sel_hi:[0,1]
    v_pk_fma_f32 v[148:149], v[158:159], v[104:105], v[148:149] op_sel:[1,1,0] op_sel_hi:[1,0,1] neg_lo:[1,0,0]
    v_cvt_pk_bf16_f32 v84, v148, v149
    ds_write_addtid_b32 v84 offset:6800
    v_pk_mul_f32 v[158:159], v[148:149], v[104:105] op_sel:[0,0] op_sel_hi:[0,1]
    v_pk_fma_f32 v[158:159], v[148:149], v[104:105], v[158:159] op_sel:[1,1,0] op_sel_hi:[1,0,1] neg_lo:[1,0,0]
    v_cvt_pk_bf16_f32 v85, v158, v159
    ds_write_addtid_b32 v85 offset:7888
    ds_read_b128 v[64:67], v115 offset:0
    ds_read_b128 v[68:71], v115 offset:32
    ds_read_b128 v[72:75], v115 offset:64
    ds_read_b128 v[76:79], v115 offset:96
    s_mov_b64 exec, 1
    v_mov_b32 v166, 0
    buffer_atomic_add v166, v165, s[16:19], s32 offen sc0 sc1
    s_mov_b64 exec, -1
    v_mul_f32 v111, 0x3fb8aa00, v92
    v_mul_f32 v160, 0x36eca570, v92
    v_exp_f32 v111, v111
    v_exp_f32 v160, v160
    s_nop 0
    v_mul_f32 v111, v111, v160
    v_cvt_pk_bf16_f32 v111, v111, v111
    v_and_b32 v111, 0xffff0000, v111
    v_mul_f32 v111, v111, v110
    s_waitcnt lgkmcnt(3)
    v_mfma_f32_32x32x16_bf16 v[16:31], v[64:67], v[32:35], v[16:31]
    ds_read_b128 v[64:67], v115 offset:128
    v_mul_f32 v111, 0xbfb8aa3b, v111
    v_mul_f32 v164, v93, v110
    v_mul_f32 v164, 0x3e22f983, v164
    v_mul_f32 v160, 0x41000000, v111
    s_waitcnt lgkmcnt(3)
    v_mfma_f32_32x32x16_bf16 v[16:31], v[68:71], v[36:39], v[16:31]
    ds_read_b128 v[68:71], v115 offset:160
    v_mul_f32 v161, 0x41000000, v164
    v_exp_f32 v160, v160
    v_fract_f32 v161, v161
    v_cos_f32 v100, v161
    s_waitcnt lgkmcnt(3)
    v_mfma_f32_32x32x16_bf16 v[16:31], v[72:75], v[40:43], v[16:31]
    ds_read_b128 v[72:75], v115 offset:192
    v_sin_f32 v101, v161
    v_mul_f32 v100, v100, v160
    v_mul_f32 v101, v101, v160
    v_mul_f32 v106, v94, v110
    s_waitcnt lgkmcnt(3)
    v_mfma_f32_32x32x16_bf16 v[16:31], v[76:79], v[44:47], v[16:31]
    ds_read_b128 v[76:79], v115 offset:224
    v_mul_f32 v107, v95, v110
    v_add_f32 v106, v106, v106
    v_add_f32 v107, v107, v107
    v_mul_f32 v160, 0x3f800000, v111
    s_waitcnt lgkmcnt(3)
    v_mfma_f32_32x32x16_bf16 v[16:31], v[64:67], v[48:51], v[16:31]
    v_mul_f32 v161, 0x3f800000, v164
    v_exp_f32 v160, v160
    v_fract_f32 v161, v161
    v_cos_f32 v96, v161
    s_waitcnt lgkmcnt(2)
    v_mfma_f32_32x32x16_bf16 v[16:31], v[68:71], v[52:55], v[16:31]
    v_sin_f32 v97, v161
    v_mul_f32 v96, v96, v160
    v_mul_f32 v97, v97, v160
    v_mul_f32 v160, 0x43800000, v111
    s_waitcnt lgkmcnt(1)
    v_mfma_f32_32x32x16_bf16 v[16:31], v[72:75], v[56:59], v[16:31]
    v_mul_f32 v161, 0x43800000, v164
    v_exp_f32 v160, v160
    v_fract_f32 v161, v161
    v_cos_f32 v104, v161
    s_waitcnt lgkmcnt(0)
    v_mfma_f32_32x32x16_bf16 v[16:31], v[76:79], v[60:63], v[16:31]
    v_sin_f32 v105, v161
    v_mul_f32 v104, v104, v160
    v_mul_f32 v105, v105, v160
    s_getreg_b32 s41, hwreg(HW_REG_IB_STS, 0, 4)
    s_cmp_lg_u32 s41, 0
    s_cbranch_scc1 L_uc_5
    s_waitcnt vmcnt(0)
    v_readfirstlane_b32 s41, v166
    s_nop 0
    s_cmp_lg_u32 s41, s43
    s_cbranch_scc1 L_ua_6
    s_add_u32 s41, s5, 2048
    s_mov_b32 m0, s41
    s_nop 0
    buffer_load_dwordx4 v2, s[16:19], s6 offen offset:0 sc1 lds
    buffer_load_dwordx4 v2, s[16:19], s6 offen offset:1024 sc1 lds
    buffer_load_dwordx4 v2, s[16:19], s6 offen offset:2048 sc1 lds
    buffer_load_dwordx4 v2, s[16:19], s6 offen offset:3072 sc1 lds
    s_mov_b32 m0, s36
    s_mov_b32 s42, 1
    s_branch L_uc_5
L_ua_6:
    s_mov_b64 exec, 1
    v_mov_b32 v166, 0
    buffer_atomic_add v166, v165, s[16:19], s32 offen sc0 sc1
    s_mov_b64 exec, -1
L_uc_5:
    v_cvt_pk_bf16_f32 v86, 1.0, 0
    ds_write_addtid_b32 v86 offset:0
    v_pk_mul_f32 v[142:143], v[100:101], v[100:101] op_sel:[0,0] op_sel_hi:[0,1]
    v_pk_fma_f32 v[142:143], v[100:101], v[100:101], v[142:143] op_sel:[1,1,0] op_sel_hi:[1,0,1] neg_lo:[1,0,0]
    v_cvt_pk_bf16_f32 v87, v100, -v101
    ds_write_addtid_b32 v87 offset:272
    v_pk_mul_f32 v[144:145], v[142:143], v[100:101] op_sel:[0,0] op_sel_hi:[0,1]
    v_pk_fma_f32 v[144:145], v[142:143], v[100:101], v[144:145] op_sel:[1,1,0] op_sel_hi:[1,0,1] neg_lo:[1,0,0]
    v_pk_mul_f32 v[102:103], v[142:143], v[142:143] op_sel:[0,0] op_sel_hi:[0,1]
    v_pk_fma_f32 v[102:103], v[142:143], v[142:143], v[102:103] op_sel:[1,1,0] op_sel_hi:[1,0,1] neg_lo:[1,0,0]
    v_cvt_pk_bf16_f32 v80, v142, -v143
    ds_write_addtid_b32 v80 offset:544
    v_cvt_pk_bf16_f32 v81, v144, -v145
    ds_write_addtid_b32 v81 offset:816
    v_cvt_pk_bf16_f32 v82, v102, -v103
    ds_write_addtid_b32 v82 offset:1088
    v_pk_mul_f32 v[148:149], v[100:101], v[102:103] op_sel:[0,0] op_sel_hi:[0,1]
    v_pk_mul_f32 v[150:151], v[142:143], v[102:103] op_sel:[0,0] op_sel_hi:[0,1]
    v_pk_mul_f32 v[152:153], v[144:145], v[102:103] op_sel:[0,0] op_sel_hi:[0,1]
    v_pk_mul_f32 v[154:155], v[102:103], v[102:103] op_sel:[0,0] op_sel_hi:[0,1]
    v_pk_fma_f32 v[148:149], v[100:101], v[102:103], v[148:149] op_sel:[1,1,0] op_sel_hi:[1,0,1] neg_lo:[1,0,0]
    v_pk_fma_f32 v[150:151], v[142:143], v[102:103], v[150:151] op_sel:[1,1,0] op_sel_hi:[1,0,1] neg_lo:[1,0,0]
    v_pk_fma_f32 v[152:153], v[144:145], v[102:103], v[152:153] op_sel:[1,1,0] op_sel_hi:[1,0,1] neg_lo:[1,0,0]
    v_pk_fma_f32 v[154:155], v[102:103], v[102:103], v[154:155] op_sel:[1,1,0] op_sel_hi:[1,0,1] neg_lo:[1,0,0]
    v_cvt_pk_bf16_f32 v83, v148, -v149
    ds_write_addtid_b32 v83 offset:1360
    v_cvt_pk_bf16_f32 v84, v150, -v151
    ds_write_addtid_b32 v84 offset:1632
    v_cvt_pk_bf16_f32 v85, v152, -v153
    ds_write_addtid_b32 v85 offset:1904
    v_cvt_pk_bf16_f32 v86, v154, -v155
    ds_write_addtid_b32 v86 offset:2176
    v_pk_mul_f32 v[140:141], v[148:149], v[102:103] op_sel:[0,0] op_sel_hi:[0,1]
    v_pk_mul_f32 v[142:143], v[150:151], v[102:103] op_sel:[0,0] op_sel_hi:[0,1]
    v_pk_mul_f32 v[144:145], v[152:153], v[102:103] op_sel:[0,0] op_sel_hi:[0,1]
    v_pk_mul_f32 v[146:147], v[154:155], v[102:103] op_sel:[0,0] op_sel_hi:[0,1]
    v_pk_fma_f32 v[140:141], v[148:149], v[102:103], v[140:141] op_sel:[1,1,0] op_sel_hi:[1,0,1] neg_lo:[1,0,0]
    v_pk_fma_f32 v[142:143], v[150:151], v[102:103], v[142:143] op_sel:[1,1,0] op_sel_hi:[1,0,1] neg_lo:[1,0,0]
    v_pk_fma_f32 v[144:145], v[152:153], v[102:103], v[144:145] op_sel:[1,1,0] op_sel_hi:[1,0,1] neg_lo:[1,0,0]
    v_pk_fma_f32 v[146:147], v[154:155], v[102:103], v[146:147] op_sel:[1,1,0] op_sel_hi:[1,0,1] neg_lo:[1,0,0]
    v_cvt_pk_bf16_f32 v87, v140, -v141
    ds_write_addtid_b32 v87 offset:2448
    v_cvt_pk_bf16_f32 v80, v142, -v143
    ds_write_addtid_b32 v80 offset:2720
    v_cvt_pk_bf16_f32 v81, v144, -v145
    ds_write_addtid_b32 v81 offset:2992
    v_cvt_pk_bf16_f32 v82, v146, -v147
    ds_write_addtid_b32 v82 offset:3264
    v_pk_mul_f32 v[148:149], v[140:141], v[102:103] op_sel:[0,0] op_sel_hi:[0,1]
    v_pk_mul_f32 v[150:151], v[142:143], v[102:103] op_sel:[0,0] op_sel_hi:[0,1]
    v_pk_mul_f32 v[152:153], v[144:145], v[102:103] op_sel:[0,0] op_sel_hi:[0,1]
    v_pk_mul_f32 v[154:155], v[146:147], v[102:103] op_sel:[0,0] op_sel_hi:[0,1]
    v_pk_fma_f32 v[148:149], v[140:141], v[102:103], v[148:149] op_sel:[1,1,0] op_sel_hi:[1,0,1] neg_lo:[1,0,0]
    v_pk_fma_f32 v[150:151], v[142:143], v[102:103], v[150:151] op_sel:[1,1,0] op_sel_hi:[1,0,1] neg_lo:[1,0,0]
    v_pk_fma_f32 v[152:153], v[144:145], v[102:103], v[152:153] op_sel:[1,1,0] op_sel_hi:[1,0,1] neg_lo:[1,0,0]
    v_pk_fma_f32 v[154:155], v[146:147], v[102:103], v[154:155] op_sel:[1,1,0] op_sel_hi:[1,0,1] neg_lo:[1,0,0]
    v_cvt_pk_bf16_f32 v83, v148, -v149
    ds_write_addtid_b32 v83 offset:3536
    v_cvt_pk_bf16_f32 v84, v150, -v151
    ds_write_addtid_b32 v84 offset:3808
    v_cvt_pk_bf16_f32 v85, v152, -v153
    ds_write_addtid_b32 v85 offset:4080
    v_cvt_pk_bf16_f32 v86, v154, -v155
    ds_write_addtid_b32 v86 offset:4352
    v_pk_mul_f32 v[140:141], v[148:149], v[102:103] op_sel:[0,0] op_sel_hi:[0,1]
    v_pk_mul_f32 v[142:143], v[150:151], v[102:103] op_sel:[0,0] op_sel_hi:[0,1]
    v_pk_mul_f32 v[144:145], v[152:153], v[102:103] op_sel:[0,0] op_sel_hi:[0,1]
    v_pk_mul_f32 v[146:147], v[154:155], v[102:103] op_sel:[0,0] op_sel_hi:[0,1]
    v_pk_fma_f32 v[140:141], v[148:149], v[102:103], v[140:141] op_sel:[1,1,0] op_sel_hi:[1,0,1] neg_lo:[1,0,0]
    v_pk_fma_f32 v[142:143], v[150:151], v[102:103], v[142:143] op_sel:[1,1,0] op_sel_hi:[1,0,1] neg_lo:[1,0,0]
    v_pk_fma_f32 v[144:145], v[152:153], v[102:103], v[144:145] op_sel:[1,1,0] op_sel_hi:[1,0,1] neg_lo:[1,0,0]
    v_pk_fma_f32 v[146:147], v[154:155], v[102:103], v[146:147] op_sel:[1,1,0] op_sel_hi:[1,0,1] neg_lo:[1,0,0]
    v_cvt_pk_bf16_f32 v87, v140, -v141
    ds_write_addtid_b32 v87 offset:4624
    v_cvt_pk_bf16_f32 v80, v142, -v143
    ds_write_addtid_b32 v80 offset:4896
    v_cvt_pk_bf16_f32 v81, v144, -v145
    ds_write_addtid_b32 v81 offset:5168
    v_cvt_pk_bf16_f32 v82, v146, -v147
    ds_write_addtid_b32 v82 offset:5440
    v_pk_mul_f32 v[148:149], v[140:141], v[102:103] op_sel:[0,0] op_sel_hi:[0,1]
    v_pk_mul_f32 v[150:151], v[142:143], v[102:103] op_sel:[0,0] op_sel_hi:[0,1]
    v_pk_mul_f32 v[152:153], v[144:145], v[102:103] op_sel:[0,0] op_sel_hi:[0,1]
    v_pk_mul_f32 v[154:155], v[146:147], v[102:103] op_sel:[0,0] op_sel_hi:[0,1]
    v_pk_fma_f32 v[148:149], v[140:141], v[102:103], v[148:149] op_sel:[1,1,0] op_sel_hi:[1,0,1] neg_lo:[1,0,0]
    v_pk_fma_f32 v[150:151], v[142:143], v[102:103], v[150:151] op_sel:[1,1,0] op_sel_hi:[1,0,1] neg_lo:[1,0,0]
    v_pk_fma_f32 v[152:153], v[144:145], v[102:103], v[152:153] op_sel:[1,1,0] op_sel_hi:[1,0,1] neg_lo:[1,0,0]
    v_pk_fma_f32 v[154:155], v[146:147], v[102:103], v[154:155] op_sel:[1,1,0] op_sel_hi:[1,0,1] neg_lo:[1,0,0]
    v_cvt_pk_bf16_f32 v83, v148, -v149
    ds_write_addtid_b32 v83 offset:5712
    v_cvt_pk_bf16_f32 v84, v150, -v151
    ds_write_addtid_b32 v84 offset:5984
    v_cvt_pk_bf16_f32 v85, v152, -v153
    ds_write_addtid_b32 v85 offset:6256
    v_cvt_pk_bf16_f32 v86, v154, -v155
    ds_write_addtid_b32 v86 offset:6528
    v_pk_mul_f32 v[140:141], v[148:149], v[102:103] op_sel:[0,0] op_sel_hi:[0,1]
    v_pk_mul_f32 v[142:143], v[150:151], v[102:103] op_sel:[0,0] op_sel_hi:[0,1]
    v_pk_mul_f32 v[144:145], v[152:153], v[102:103] op_sel:[0,0] op_sel_hi:[0,1]
    v_pk_mul_f32 v[146:147], v[154:155], v[102:103] op_sel:[0,0] op_sel_hi:[0,1]
    v_pk_fma_f32 v[140:141], v[148:149], v[102:103], v[140:141] op_sel:[1,1,0] op_sel_hi:[1,0,1] neg_lo:[1,0,0]
    v_pk_fma_f32 v[142:143], v[150:151], v[102:103], v[142:143] op_sel:[1,1,0] op_sel_hi:[1,0,1] neg_lo:[1,0,0]
    v_pk_fma_f32 v[144:145], v[152:153], v[102:103], v[144:145] op_sel:[1,1,0] op_sel_hi:[1,0,1] neg_lo:[1,0,0]
    v_pk_fma_f32 v[146:147], v[154:155], v[102:103], v[146:147] op_sel:[1,1,0] op_sel_hi:[1,0,1] neg_lo:[1,0,0]
    v_cvt_pk_bf16_f32 v87, v140, -v141
    ds_write_addtid_b32 v87 offset:6800
    v_cvt_pk_bf16_f32 v80, v142, -v143
    ds_write_addtid_b32 v80 offset:7072
    v_cvt_pk_bf16_f32 v81, v144, -v145
    ds_write_addtid_b32 v81 offset:7344
    v_cvt_pk_bf16_f32 v82, v146, -v147
    ds_write_addtid_b32 v82 offset:7616
    v_pk_mul_f32 v[148:149], v[140:141], v[102:103] op_sel:[0,0] op_sel_hi:[0,1]
    v_pk_mul_f32 v[150:151], v[142:143], v[102:103] op_sel:[0,0] op_sel_hi:[0,1]
    v_pk_mul_f32 v[152:153], v[144:145], v[102:103] op_sel:[0,0] op_sel_hi:[0,1]
    v_pk_fma_f32 v[148:149], v[140:141], v[102:103], v[148:149] op_sel:[1,1,0] op_sel_hi:[1,0,1] neg_lo:[1,0,0]
    v_pk_fma_f32 v[150:151], v[142:143], v[102:103], v[150:151] op_sel:[1,1,0] op_sel_hi:[1,0,1] neg_lo:[1,0,0]
    v_pk_fma_f32 v[152:153], v[144:145], v[102:103], v[152:153] op_sel:[1,1,0] op_sel_hi:[1,0,1] neg_lo:[1,0,0]
    v_cvt_pk_bf16_f32 v83, v148, -v149
    ds_write_addtid_b32 v83 offset:7888
    v_cvt_pk_bf16_f32 v84, v150, -v151
    ds_write_addtid_b32 v84 offset:8160
    v_cvt_pk_bf16_f32 v85, v152, -v153
    ds_write_addtid_b32 v85 offset:8432
    ds_read_b128 v[32:35], v115 offset:0
    ds_read_b128 v[36:39], v115 offset:32
    ds_read_b128 v[40:43], v115 offset:64
    ds_read_b128 v[44:47], v115 offset:96
    ds_read_b128 v[48:51], v115 offset:128
    ds_read_b128 v[52:55], v115 offset:160
    ds_read_b128 v[56:59], v115 offset:192
    ds_read_b128 v[60:63], v115 offset:224
    s_cmp_lg_u32 s42, 0
    s_cbranch_scc1 L_uc_7
    s_getreg_b32 s41, hwreg(HW_REG_IB_STS, 0, 4)
    s_cmp_lg_u32 s41, 0
    s_cbranch_scc1 L_uc_7
    s_waitcnt vmcnt(0)
    v_readfirstlane_b32 s41, v166
    s_nop 0
    s_cmp_lg_u32 s41, s43
    s_cbranch_scc1 L_ua_8
    s_add_u32 s41, s5, 2048
    s_mov_b32 m0, s41
    s_nop 0
    buffer_load_dwordx4 v2, s[16:19], s6 offen offset:0 sc1 lds
    buffer_load_dwordx4 v2, s[16:19], s6 offen offset:1024 sc1 lds
    buffer_load_dwordx4 v2, s[16:19], s6 offen offset:2048 sc1 lds
    buffer_load_dwordx4 v2, s[16:19], s6 offen offset:3072 sc1 lds
    s_mov_b32 m0, s36
    s_mov_b32 s42, 1
    s_branch L_uc_7
L_ua_8:
    s_mov_b64 exec, 1
    v_mov_b32 v166, 0
    buffer_atomic_add v166, v165, s[16:19], s32 offen sc0 sc1
    s_mov_b64 exec, -1
L_uc_7:
    v_pk_mul_f32 v[98:99], v[96:97], v[96:97] op_sel:[0,0] op_sel_hi:[0,1]
    v_pk_fma_f32 v[98:99], v[96:97], v[96:97], v[98:99] op_sel:[1,1,0] op_sel_hi:[1,0,1] neg_lo:[1,0,0]
    v_pk_mul_f32 v[160:161], v[106:107], v[96:97] op_sel:[0,0] op_sel_hi:[0,1]
    v_pk_fma_f32 v[160:161], v[106:107], v[96:97], v[160:161] op_sel:[1,1,0] op_sel_hi:[1,0,1] neg_lo:[1,0,0]
    v_cvt_pk_bf16_f32 v86, v106, v107
    ds_write_addtid_b32 v86 offset:0
    v_pk_mul_f32 v[142:143], v[106:107], v[98:99] op_sel:[0,0] op_sel_hi:[0,1]
    v_pk_fma_f32 v[142:143], v[106:107], v[98:99], v[142:143] op_sel:[1,1,0] op_sel_hi:[1,0,1] neg_lo:[1,0,0]
    v_cvt_pk_bf16_f32 v87, v160, v161
    ds_write_addtid_b32 v87 offset:272
    v_pk_mul_f32 v[162:163], v[160:161], v[98:99] op_sel:[0,0] op_sel_hi:[0,1]
    v_pk_fma_f32 v[162:163], v[160:161], v[98:99], v[162:163] op_sel:[1,1,0] op_sel_hi:[1,0,1] neg_lo:[1,0,0]
    v_pk_mul_f32 v[144:145], v[142:143], v[98:99] op_sel:[0,0] op_sel_hi:[0,1]
    v_pk_fma_f32 v[144:145], v[142:143], v[98:99], v[144:145] op_sel:[1,1,0] op_sel_hi:[1,0,1] neg_lo:[1,0,0]
    v_cvt_pk_bf16_f32 v80, v142, v143
    ds_write_addtid_b32 v80 offset:544
    v_cvt_pk_bf16_f32 v81, v162, v163
    ds_write_addtid_b32 v81 offset:816
    v_pk_mul_f32 v[160:161], v[162:163], v[98:99] op_sel:[0,0] op_sel_hi:[0,1]
    v_pk_fma_f32 v[160:161], v[162:163], v[98:99], v[160:161] op_sel:[1,1,0] op_sel_hi:[1,0,1] neg_lo:[1,0,0]
    v_pk_mul_f32 v[146:147], v[144:145], v[98:99] op_sel:[0,0] op_sel_hi:[0,1]
    v_pk_fma_f32 v[146:147], v[144:145], v[98:99], v[146:147] op_sel:[1,1,0] op_sel_hi:[1,0,1] neg_lo:[1,0,0]
    v_cvt_pk_bf16_f32 v82, v144, v145
    ds_write_addtid_b32 v82 offset:2176
    v_cvt_pk_bf16_f32 v83, v160, v161
    ds_write_addtid_b32 v83 offset:2448
    v_pk_mul_f32 v[162:163], v[160:161], v[98:99] op_sel:[0,0] op_sel_hi:[0,1]
    v_pk_fma_f32 v[162:163], v[160:161], v[98:99], v[162:163] op_sel:[1,1,0] op_sel_hi:[1,0,1] neg_lo:[1,0,0]
    v_pk_mul_f32 v[148:149], v[146:147], v[98:99] op_sel:[0,0] op_sel_hi:[0,1]
    v_pk_fma_f32 v[148:149], v[146:147], v[98:99], v[148:149] op_sel:[1,1,0] op_sel_hi:[1,0,1] neg_lo:[1,0,0]
    v_cvt_pk_bf16_f32 v84, v146, v147
    ds_write_addtid_b32 v84 offset:2720
    v_cvt_pk_bf16_f32 v85, v162, v163
    ds_write_addtid_b32 v85 offset:2992
    v_cvt_pk_bf16_f32 v86, v148, v149
    ds_write_addtid_b32 v86 offset:4352
    v_pk_mul_f32 v[150:151], v[106:107], v[104:105] op_sel:[0,0] op_sel_hi:[0,1]
    v_pk_mul_f32 v[152:153], v[142:143], v[104:105] op_sel:[0,0] op_sel_hi:[0,1]
    v_pk_mul_f32 v[154:155], v[144:145], v[104:105] op_sel:[0,0] op_sel_hi:[0,1]
    v_pk_mul_f32 v[156:157], v[146:147], v[104:105] op_sel:[0,0] op_sel_hi:[0,1]
    v_pk_mul_f32 v[158:159], v[148:149], v[104:105] op_sel:[0,0] op_sel_hi:[0,1]
    v_pk_fma_f32 v[150:151], v[106:107], v[104:105], v[150:151] op_sel:[1,1,0] op_sel_hi:[1,0,1] neg_lo:[1,0,0]
    v_pk_fma_f32 v[152:153], v[142:143], v[104:105], v[152:153] op_sel:[1,1,0] op_sel_hi:[1,0,1] neg_lo:[1,0,0]
    v_pk_fma_f32 v[154:155], v[144:145], v[104:105], v[154:155] op_sel:[1,1,0] op_sel_hi:[1,0,1] neg_lo:[1,0,0]
    v_pk_fma_f32 v[156:157], v[146:147], v[104:105], v[156:157] op_sel:[1,1,0] op_sel_hi:[1,0,1] neg_lo:[1,0,0]
    v_pk_fma_f32 v[158:159], v[148:149], v[104:105], v[158:159] op_sel:[1,1,0] op_sel_hi:[1,0,1] neg_lo:[1,0,0]
    v_cvt_pk_bf16_f32 v87, v150, v151
    ds_write_addtid_b32 v87 offset:1088
    ds_write_addtid_b32 v87 offset:1360
    v_cvt_pk_bf16_f32 v80, v152, v153
    ds_write_addtid_b32 v80 offset:1632
    v_cvt_pk_bf16_f32 v81, v154, v155
    ds_write_addtid_b32 v81 offset:1904
    ds_write_addtid_b32 v81 offset:3264
    ds_write_addtid_b32 v81 offset:3536
    v_cvt_pk_bf16_f32 v82, v156, v157
    ds_write_addtid_b32 v82 offset:3808
    v_cvt_pk_bf16_f32 v83, v158, v159
    ds_write_addtid_b32 v83 offset:4080
    ds_write_addtid_b32 v83 offset:5440
    v_pk_mul_f32 v[144:145], v[154:155], v[104:105] op_sel:[0,0] op_sel_hi:[0,1]
    v_pk_mul_f32 v[148:149], v[158:159], v[104:105] op_sel:[0,0] op_sel_hi:[0,1]
    v_pk_fma_f32 v[144:145], v[154:155], v[104:105], v[144:145] op_sel:[1,1,0] op_sel_hi:[1,0,1] neg_lo:[1,0,0]
    v_pk_fma_f32 v[148:149], v[158:159], v[104:105], v[148:149] op_sel:[1,1,0] op_sel_hi:[1,0,1] neg_lo:[1,0,0]
    v_cvt_pk_bf16_f32 v84, v144, v145
    ds_write_addtid_b32 v84 offset:4896
    v_cvt_pk_bf16_f32 v85, v148, v149
    ds_write_addtid_b32 v85 offset:5168
    v_pk_mul_f32 v[154:155], v[144:145], v[104:105] op_sel:[0,0] op_sel_hi:[0,1]
    v_pk_mul_f32 v[158:159], v[148:149], v[104:105] op_sel:[0,0] op_sel_hi:[0,1]
    v_pk_fma_f32 v[154:155], v[144:145], v[104:105], v[154:155] op_sel:[1,1,0] op_sel_hi:[1,0,1] neg_lo:[1,0,0]
    v_pk_fma_f32 v[158:159], v[148:149], v[104:105], v[158:159] op_sel:[1,1,0] op_sel_hi:[1,0,1] neg_lo:[1,0,0]
    v_cvt_pk_bf16_f32 v86, v154, v155
    ds_write_addtid_b32 v86 offset:5984
    v_cvt_pk_bf16_f32 v87, v158, v159
    ds_write_addtid_b32 v87 offset:6256
    v_pk_mul_f32 v[148:149], v[158:159], v[104:105] op_sel:[0,0] op_sel_hi:[0,1]
    v_pk_fma_f32 v[148:149], v[158:159], v[104:105], v[148:149] op_sel:[1,1,0] op_sel_hi:[1,0,1] neg_lo:[1,0,0]
    v_cvt_pk_bf16_f32 v80, v148, v149
    ds_write_addtid_b32 v80 offset:6528
    v_pk_mul_f32 v[158:159], v[148:149], v[104:105] op_sel:[0,0] op_sel_hi:[0,1]
    v_pk_fma_f32 v[158:159], v[148:149], v[104:105], v[158:159] op_sel:[1,1,0] op_sel_hi:[1,0,1] neg_lo:[1,0,0]
    v_cvt_pk_bf16_f32 v81, v158, v159
    ds_write_addtid_b32 v81 offset:7616
    v_pk_mul_f32 v[148:149], v[158:159], v[104:105] op_sel:[0,0] op_sel_hi:[0,1]
    v_pk_fma_f32 v[148:149], v[158:159], v[104:105], v[148:149] op_sel:[1,1,0] op_sel_hi:[1,0,1] neg_lo:[1,0,0]
    v_cvt_pk_bf16_f32 v82, v148, v149
    ds_write_addtid_b32 v82 offset:6800
    v_pk_mul_f32 v[158:159], v[148:149], v[104:105] op_sel:[0,0] op_sel_hi:[0,1]
    v_pk_fma_f32 v[158:159], v[148:149], v[104:105], v[158:159] op_sel:[1,1,0] op_sel_hi:[1,0,1] neg_lo:[1,0,0]
    v_cvt_pk_bf16_f32 v83, v158, v159
    ds_write_addtid_b32 v83 offset:7888
    ds_read_b128 v[64:67], v115 offset:0
    ds_read_b128 v[68:71], v115 offset:32
    ds_read_b128 v[72:75], v115 offset:64
    ds_read_b128 v[76:79], v115 offset:96
    s_cmp_lg_u32 s42, 0
    s_cbranch_scc1 L_uc_9
    s_getreg_b32 s41, hwreg(HW_REG_IB_STS, 0, 4)
    s_cmp_lg_u32 s41, 0
    s_cbranch_scc1 L_uc_9
    s_waitcnt vmcnt(0)
    v_readfirstlane_b32 s41, v166
    s_nop 0
    s_cmp_lg_u32 s41, s43
    s_cbranch_scc1 L_ua_10
    s_add_u32 s41, s5, 2048
    s_mov_b32 m0, s41
    s_nop 0
    buffer_load_dwordx4 v2, s[16:19], s6 offen offset:0 sc1 lds
    buffer_load_dwordx4 v2, s[16:19], s6 offen offset:1024 sc1 lds
    buffer_load_dwordx4 v2, s[16:19], s6 offen offset:2048 sc1 lds
    buffer_load_dwordx4 v2, s[16:19], s6 offen offset:3072 sc1 lds
    s_mov_b32 m0, s36
    s_mov_b32 s42, 1
    s_branch L_uc_9
L_ua_10:
    s_mov_b64 exec, 1
    v_mov_b32 v166, 0
    buffer_atomic_add v166, v165, s[16:19], s32 offen sc0 sc1
    s_mov_b64 exec, -1
L_uc_9:
    s_waitcnt lgkmcnt(3)
    v_mfma_f32_32x32x16_bf16 v[16:31], v[64:67], v[32:35], v[16:31]
    ds_read_b128 v[64:67], v115 offset:128
    s_waitcnt lgkmcnt(3)
    v_mfma_f32_32x32x16_bf16 v[16:31], v[68:71], v[36:39], v[16:31]
    ds_read_b128 v[68:71], v115 offset:160
    s_waitcnt lgkmcnt(3)
    v_mfma_f32_32x32x16_bf16 v[16:31], v[72:75], v[40:43], v[16:31]
    ds_read_b128 v[72:75], v115 offset:192
    s_waitcnt lgkmcnt(3)
    v_mfma_f32_32x32x16_bf16 v[16:31], v[76:79], v[44:47], v[16:31]
    ds_read_b128 v[76:79], v115 offset:224
    s_waitcnt lgkmcnt(3)
    v_mfma_f32_32x32x16_bf16 v[16:31], v[64:67], v[48:51], v[16:31]
    s_waitcnt lgkmcnt(2)
    v_mfma_f32_32x32x16_bf16 v[16:31], v[68:71], v[52:55], v[16:31]
    s_waitcnt lgkmcnt(1)
    v_mfma_f32_32x32x16_bf16 v[16:31], v[72:75], v[56:59], v[16:31]
    s_waitcnt lgkmcnt(0)
    v_mfma_f32_32x32x16_bf16 v[16:31], v[76:79], v[60:63], v[16:31]
L_kg_end:
    s_cmp_lg_u32 s42, 0
    s_cbranch_scc1 L_kg_h2
    s_mov_b32 s51, 0
L_hw_11:
    s_waitcnt vmcnt(0)
    s_mov_b64 exec, 1
    v_cmp_ne_u32 vcc, s43, v166
    s_add_u32 s51, s51, 1
    s_cbranch_vccz L_hok_12
    s_cmp_gt_u32 s51, 30000
    s_cbranch_scc1 L_hok_12
    s_sleep 1
    v_mov_b32 v166, 0
    buffer_atomic_add v166, v165, s[16:19], s32 offen sc0 sc1
    s_branch L_hw_11
L_hok_12:
    s_mov_b64 exec, -1
    s_add_u32 s41, s5, 2048
    s_mov_b32 m0, s41
    s_nop 0
    buffer_load_dwordx4 v2, s[16:19], s6 offen offset:0 sc1 lds
    buffer_load_dwordx4 v2, s[16:19], s6 offen offset:1024 sc1 lds
    buffer_load_dwordx4 v2, s[16:19], s6 offen offset:2048 sc1 lds
    buffer_load_dwordx4 v2, s[16:19], s6 offen offset:3072 sc1 lds
    s_mov_b32 m0, s36
L_kg_h2:
    v_mov_b32 v64, 0
    v_mov_b32 v65, 0
    v_mov_b32 v66, 0
    v_mov_b32 v67, 0
    ds_write_b128 v114, v[64:67] offset:0
    ds_write_b128 v114, v[64:67] offset:1024
    ds_write_b128 v114, v[64:67] offset:2048
    ds_write_b128 v114, v[64:67] offset:3072
    v_mov_b32 v68, s36
    s_nop 7
    v_cvt_pk_bf16_f32 v48, v23, v22
    v_cvt_pk_bf16_f32 v49, v21, v20
    v_cvt_pk_bf16_f32 v50, v19, v18
    v_cvt_pk_bf16_f32 v51, v17, v16
    ds_write_b128 v3, v[48:51] offset:0
    v_cvt_pk_bf16_f32 v52, v24, v23
    v_cvt_pk_bf16_f32 v53, v22, v21
    v_cvt_pk_bf16_f32 v54, v20, v19
    v_cvt_pk_bf16_f32 v55, v18, v17
    ds_write_b128 v3, v[52:55] offset:1216
    v_cvt_pk_bf16_f32 v101, v26, v27
    v_cvt_pk_bf16_f32 v102, v28, v29
    ds_write_b32 v112, v101
    ds_write_b16 v113, v102 offset:128
    ds_write_b16_d16_hi v113, v102
    v_readlane_b32 s26, v52, 63
    v_readlane_b32 s27, v51, 0
    v_readlane_b32 s28, v101, 63
    s_lshl_b32 s29, s26, 16
    s_and_b32 s26, s26, 65535
    s_or_b32 s26, s26, s29
    s_lshr_b32 s27, s27, 16
    s_lshr_b32 s30, s28, 16
    s_and_b32 s28, s28, 0xffff0000
    s_or_b32 s28, s28, s30
    v_mov_b32 v56, s29
    v_mov_b32 v57, s26
    v_mov_b32 v58, s27
    ds_write_b64 v68, v[56:57] offset:56
    ds_write_b32 v68, v57 offset:1276
    ds_write_b32 v68, v58 offset:2304
    v_and_b32 v136, s28, v136
    v_and_b32 v137, s28, v137
    v_and_b32 v138, s28, v138
    v_and_b32 v139, s28, v139
    ds_read2_b32 v[80:81], v4 offset0:0 offset1:1
    ds_read2_b32 v[82:83], v4 offset0:2 offset1:3
    ds_read2_b32 v[84:85], v6 offset0:128 offset1:129
    ds_read2_b32 v[86:87], v6 offset0:130 offset1:131
    ds_read2_b32 v[140:141], v6 offset0:0 offset1:1
    ds_read2_b32 v[142:143], v6 offset0:2 offset1:3
    ds_read_b64 v[96:97], v12 offset:320
    ds_read_b64 v[98:99], v12 offset:328
    ds_read_b64 v[100:101], v12 offset:256
    ds_read_b64 v[102:103], v12 offset:264
    ds_read_b64 v[104:105], v12 offset:192
    ds_read_b64 v[106:107], v12 offset:200
    ds_read_b64 v[108:109], v12 offset:128
    ds_read_b64 v[110:111], v12 offset:136
    ds_read_b64 v[112:113], v12 offset:64
    ds_read_b64 v[114:115], v12 offset:72
    ds_read_b64 v[116:117], v12 offset:0
    ds_read_b64 v[118:119], v12 offset:8
    s_waitcnt vmcnt(0)
    s_barrier
    ds_read_b128 v[76:79], v7 offset:15360
    ds_read_b128 v[72:75], v7 offset:13312
    ds_read_b128 v[68:71], v7 offset:11264
    ds_read_b128 v[64:67], v7 offset:9216
    ds_read_b128 v[60:63], v7 offset:7168
    ds_read_b128 v[56:59], v7 offset:5120
    ds_read_b128 v[52:55], v7 offset:3072
    ds_read_b128 v[48:51], v7 offset:1024
    s_waitcnt lgkmcnt(4)
    v_mfma_f32_16x16x32_bf16 v[44:47], v[80:83], v[76:79], 0
    ds_read_b128 v[160:163], v14 offset:0
    ds_read_b128 v[164:167], v14 offset:1024
    v_mfma_f32_16x16x32_bf16 v[40:43], v[80:83], v[72:75], 0
    ds_read_b128 v[76:79], v8 offset:15360
    ds_read2_b32 v[88:89], v6 offset0:240 offset1:241
    v_mfma_f32_16x16x32_bf16 v[44:47], v[84:87], v[72:75], v[44:47]
    ds_read2_b32 v[90:91], v6 offset0:242 offset1:243
    ds_read2_b32 v[92:93], v6 offset0:112 offset1:113
    v_mfma_f32_16x16x32_bf16 v[36:39], v[80:83], v[68:71], 0
    ds_read2_b32 v[94:95], v6 offset0:114 offset1:115
    ds_read_b128 v[72:75], v8 offset:13312
    v_mfma_f32_16x16x32_bf16 v[40:43], v[84:87], v[68:71], v[40:43]
    v_mfma_f32_16x16x32_bf16 v[44:47], v[140:143], v[68:71], v[44:47]
    ds_read_b128 v[68:71], v8 offset:11264
    v_mfma_f32_16x16x32_bf16 v[32:35], v[80:83], v[64:67], 0
    v_mfma_f32_16x16x32_bf16 v[36:39], v[84:87], v[64:67], v[36:39]
    v_mfma_f32_16x16x32_bf16 v[40:43], v[140:143], v[64:67], v[40:43]
    ds_read_b128 v[64:67], v8 offset:9216
    s_waitcnt lgkmcnt(4)
    v_mfma_f32_16x16x32_bf16 v[28:31], v[80:83], v[60:63], 0
    v_mfma_f32_16x16x32_bf16 v[32:35], v[84:87], v[60:63], v[32:35]
    v_mfma_f32_16x16x32_bf16 v[36:39], v[140:143], v[60:63], v[36:39]
    v_mfma_f32_16x16x32_bf16 v[44:47], v[136:139], v[60:63], v[44:47]
    ds_read_b128 v[60:63], v8 offset:7168
    v_mfma_f32_16x16x32_bf16 v[24:27], v[80:83], v[56:59], 0
    v_mfma_f32_16x16x32_bf16 v[28:31], v[84:87], v[56:59], v[28:31]
    v_mfma_f32_16x16x32_bf16 v[32:35], v[140:143], v[56:59], v[32:35]
    v_mfma_f32_16x16x32_bf16 v[40:43], v[136:139], v[56:59], v[40:43]
    ds_read_b128 v[56:59], v8 offset:5120
    v_mfma_f32_16x16x32_bf16 v[20:23], v[80:83], v[52:55], 0
    v_mfma_f32_16x16x32_bf16 v[24:27], v[84:87], v[52:55], v[24:27]
    v_mfma_f32_16x16x32_bf16 v[28:31], v[140:143], v[52:55], v[28:31]
    v_mfma_f32_16x16x32_bf16 v[36:39], v[136:139], v[52:55], v[36:39]
    ds_read_b128 v[52:55], v8 offset:3072
    v_mfma_f32_16x16x32_bf16 v[16:19], v[80:83], v[48:51], 0
    v_mfma_f32_16x16x32_bf16 v[20:23], v[84:87], v[48:51], v[20:23]
    v_mfma_f32_16x16x32_bf16 v[24:27], v[140:143], v[48:51], v[24:27]
    v_mfma_f32_16x16x32_bf16 v[32:35], v[136:139], v[48:51], v[32:35]
    ds_read_b128 v[48:51], v8 offset:1024
    v_mfma_f32_16x16x32_bf16 v[136:139], v[160:163], v[120:123], 0
    v_mfma_f32_16x16x32_bf16 v[140:143], v[160:163], v[124:127], 0
    v_mfma_f32_16x16x32_bf16 v[144:147], v[164:167], v[120:123], 0
    v_mfma_f32_16x16x32_bf16 v[148:151], v[164:167], v[124:127], 0
    v_mfma_f32_16x16x32_bf16 v[44:47], v[88:91], v[76:79], v[44:47]
    ds_read_b128 v[160:163], v14 offset:2048
    ds_read_b128 v[164:167], v14 offset:3072
    s_waitcnt lgkmcnt(4)
    v_mfma_f32_16x16x32_bf16 v[40:43], v[88:91], v[72:75], v[40:43]
    ds_read_b128 v[76:79], v9 offset:15360
    ds_read2_b32 v[80:81], v6 offset0:224 offset1:225
    v_mfma_f32_16x16x32_bf16 v[44:47], v[92:95], v[72:75], v[44:47]
    ds_read2_b32 v[82:83], v6 offset0:226 offset1:227
    ds_read2_b32 v[84:85], v6 offset0:96 offset1:97
    v_mfma_f32_16x16x32_bf16 v[36:39], v[88:91], v[68:71], v[36:39]
    ds_read2_b32 v[86:87], v6 offset0:98 offset1:99
    ds_read_b128 v[72:75], v9 offset:13312
    v_mfma_f32_16x16x32_bf16 v[40:43], v[92:95], v[68:71], v[40:43]
    v_cvt_pk_bf16_f32 v159, v147, v151
    v_cvt_pk_bf16_f32 v158, v146, v150
    v_mfma_f32_16x16x32_bf16 v[32:35], v[88:91], v[64:67], v[32:35]
    v_cvt_pk_bf16_f32 v157, v145, v149
    v_cvt_pk_bf16_f32 v156, v144, v148
    v_mfma_f32_16x16x32_bf16 v[36:39], v[92:95], v[64:67], v[36:39]
    v_cvt_pk_bf16_f32 v155, v139, v143
    v_cvt_pk_bf16_f32 v154, v138, v142
    v_mfma_f32_16x16x32_bf16 v[28:31], v[88:91], v[60:63], v[28:31]
    v_cvt_pk_bf16_f32 v153, v137, v141
    v_cvt_pk_bf16_f32 v152, v136, v140
    s_nop 1
    v_mfma_f32_16x16x32_bf16 v[24:27], v[152:155], v[100:103], v[24:27]
    ds_read_b128 v[68:71], v9 offset:11264
    ds_read_b128 v[64:67], v9 offset:9216
    v_mfma_f32_16x16x32_bf16 v[28:31], v[152:155], v[108:111], v[28:31]
    v_mfma_f32_16x16x32_bf16 v[32:35], v[152:155], v[116:119], v[32:35]
    v_mfma_f32_16x16x32_bf16 v[24:27], v[156:159], v[96:99], v[24:27]
    v_mfma_f32_16x16x32_bf16 v[28:31], v[156:159], v[104:107], v[28:31]
    v_mfma_f32_16x16x32_bf16 v[32:35], v[156:159], v[112:115], v[32:35]
    s_waitcnt lgkmcnt(4)
    v_mfma_f32_16x16x32_bf16 v[136:139], v[160:163], v[120:123], 0
    v_mfma_f32_16x16x32_bf16 v[140:143], v[160:163], v[124:127], 0
    v_mfma_f32_16x16x32_bf16 v[144:147], v[164:167], v[120:123], 0
    v_mfma_f32_16x16x32_bf16 v[148:151], v[164:167], v[124:127], 0
    v_mfma_f32_16x16x32_bf16 v[32:35], v[92:95], v[60:63], v[32:35]
    ds_read_b128 v[160:163], v14 offset:4096
    ds_read_b128 v[164:167], v14 offset:5120
    v_mfma_f32_16x16x32_bf16 v[24:27], v[88:91], v[56:59], v[24:27]
    ds_read_b128 v[60:63], v9 offset:7168
    v_mfma_f32_16x16x32_bf16 v[28:31], v[92:95], v[56:59], v[28:31]
    ds_read_b128 v[56:59], v9 offset:5120
    v_mfma_f32_16x16x32_bf16 v[20:23], v[88:91], v[52:55], v[20:23]
    v_mfma_f32_16x16x32_bf16 v[24:27], v[92:95], v[52:55], v[24:27]
    v_cvt_pk_bf16_f32 v159, v147, v151
    v_cvt_pk_bf16_f32 v158, v146, v150
    v_mfma_f32_16x16x32_bf16 v[16:19], v[88:91], v[48:51], v[16:19]
    v_cvt_pk_bf16_f32 v157, v145, v149
    v_cvt_pk_bf16_f32 v156, v144, v148
    v_mfma_f32_16x16x32_bf16 v[20:23], v[92:95], v[48:51], v[20:23]
    v_cvt_pk_bf16_f32 v155, v139, v143
    v_cvt_pk_bf16_f32 v154, v138, v142
    v_mfma_f32_16x16x32_bf16 v[44:47], v[80:83], v[76:79], v[44:47]
    v_cvt_pk_bf16_f32 v153, v137, v141
    v_cvt_pk_bf16_f32 v152, v136, v140
    s_nop 1
    v_mfma_f32_16x16x32_bf16 v[28:31], v[152:155], v[100:103], v[28:31]
    ds_read_b128 v[52:55], v9 offset:3072
    ds_read_b128 v[48:51], v9 offset:1024
    v_mfma_f32_16x16x32_bf16 v[32:35], v[152:155], v[108:111], v[32:35]
    ds_read_b128 v[76:79], v10 offset:15360
    ds_read2_b32 v[88:89], v6 offset0:208 offset1:209
    v_mfma_f32_16x16x32_bf16 v[36:39], v[152:155], v[116:119], v[36:39]
    ds_read2_b32 v[90:91], v6 offset0:210 offset1:211
    ds_read2_b32 v[92:93], v6 offset0:80 offset1:81
    v_mfma_f32_16x16x32_bf16 v[28:31], v[156:159], v[96:99], v[28:31]
    ds_read2_b32 v[94:95], v6 offset0:82 offset1:83
    v_mfma_f32_16x16x32_bf16 v[32:35], v[156:159], v[104:107], v[32:35]
    v_mfma_f32_16x16x32_bf16 v[36:39], v[156:159], v[112:115], v[36:39]
    s_waitcnt lgkmcnt(4)
    v_mfma_f32_16x16x32_bf16 v[136:139], v[160:163], v[120:123], 0
    v_mfma_f32_16x16x32_bf16 v[140:143], v[160:163], v[124:127], 0
    v_mfma_f32_16x16x32_bf16 v[144:147], v[164:167], v[120:123], 0
    v_mfma_f32_16x16x32_bf16 v[148:151], v[164:167], v[124:127], 0
    v_mfma_f32_16x16x32_bf16 v[40:43], v[80:83], v[72:75], v[40:43]
    ds_read_b128 v[160:163], v14 offset:6144
    ds_read_b128 v[164:167], v14 offset:7168
    v_mfma_f32_16x16x32_bf16 v[44:47], v[84:87], v[72:75], v[44:47]
    ds_read_b128 v[72:75], v10 offset:13312
    v_mfma_f32_16x16x32_bf16 v[36:39], v[80:83], v[68:71], v[36:39]
    v_mfma_f32_16x16x32_bf16 v[40:43], v[84:87], v[68:71], v[40:43]
    ds_read_b128 v[68:71], v10 offset:11264
    v_mfma_f32_16x16x32_bf16 v[32:35], v[80:83], v[64:67], v[32:35]
    v_cvt_pk_bf16_f32 v159, v147, v151
    v_cvt_pk_bf16_f32 v158, v146, v150
    v_mfma_f32_16x16x32_bf16 v[36:39], v[84:87], v[64:67], v[36:39]
    v_cvt_pk_bf16_f32 v157, v145, v149
    v_cvt_pk_bf16_f32 v156, v144, v148
    v_mfma_f32_16x16x32_bf16 v[28:31], v[80:83], v[60:63], v[28:31]
    v_cvt_pk_bf16_f32 v155, v139, v143
    v_cvt_pk_bf16_f32 v154, v138, v142
    v_mfma_f32_16x16x32_bf16 v[32:35], v[84:87], v[60:63], v[32:35]
    v_cvt_pk_bf16_f32 v153, v137, v141
    v_cvt_pk_bf16_f32 v152, v136, v140
    s_nop 1
    v_mfma_f32_16x16x32_bf16 v[32:35], v[152:155], v[100:103], v[32:35]
    ds_read_b128 v[64:67], v10 offset:9216
    ds_read_b128 v[60:63], v10 offset:7168
    v_mfma_f32_16x16x32_bf16 v[36:39], v[152:155], v[108:111], v[36:39]
    v_mfma_f32_16x16x32_bf16 v[40:43], v[152:155], v[116:119], v[40:43]
    v_mfma_f32_16x16x32_bf16 v[32:35], v[156:159], v[96:99], v[32:35]
    v_mfma_f32_16x16x32_bf16 v[36:39], v[156:159], v[104:107], v[36:39]
    v_mfma_f32_16x16x32_bf16 v[40:43], v[156:159], v[112:115], v[40:43]
    s_waitcnt lgkmcnt(4)
    v_mfma_f32_16x16x32_bf16 v[136:139], v[160:163], v[120:123], 0
    v_mfma_f32_16x16x32_bf16 v[140:143], v[160:163], v[124:127], 0
    v_mfma_f32_16x16x32_bf16 v[144:147], v[164:167], v[120:123], 0
    v_mfma_f32_16x16x32_bf16 v[148:151], v[164:167], v[124:127], 0
    v_mfma_f32_16x16x32_bf16 v[24:27], v[80:83], v[56:59], v[24:27]
    ds_read_b128 v[160:163], v14 offset:8192
    ds_read_b128 v[164:167], v14 offset:9216
    v_mfma_f32_16x16x32_bf16 v[28:31], v[84:87], v[56:59], v[28:31]
    ds_read_b128 v[56:59], v10 offset:5120
    v_mfma_f32_16x16x32_bf16 v[20:23], v[80:83], v[52:55], v[20:23]
    v_mfma_f32_16x16x32_bf16 v[24:27], v[84:87], v[52:55], v[24:27]
    ds_read_b128 v[52:55], v10 offset:3072
    v_mfma_f32_16x16x32_bf16 v[16:19], v[80:83], v[48:51], v[16:19]
    v_cvt_pk_bf16_f32 v159, v147, v151
    v_cvt_pk_bf16_f32 v158, v146, v150
    v_mfma_f32_16x16x32_bf16 v[20:23], v[84:87], v[48:51], v[20:23]
    v_cvt_pk_bf16_f32 v157, v145, v149
    v_cvt_pk_bf16_f32 v156, v144, v148
    v_mfma_f32_16x16x32_bf16 v[44:47], v[88:91], v[76:79], v[44:47]
    v_cvt_pk_bf16_f32 v155, v139, v143
    v_cvt_pk_bf16_f32 v154, v138, v142
    s_waitcnt lgkmcnt(4)
    v_mfma_f32_16x16x32_bf16 v[40:43], v[88:91], v[72:75], v[40:43]
    v_cvt_pk_bf16_f32 v153, v137, v141
    v_cvt_pk_bf16_f32 v152, v136, v140
    s_nop 1
    v_mfma_f32_16x16x32_bf16 v[36:39], v[152:155], v[100:103], v[36:39]
    ds_read_b128 v[48:51], v10 offset:1024
    ds_read_b128 v[76:79], v7 offset:14336
    v_mfma_f32_16x16x32_bf16 v[40:43], v[152:155], v[108:111], v[40:43]
    ds_read2_b32 v[80:81], v6 offset0:192 offset1:193
    ds_read2_b32 v[82:83], v6 offset0:194 offset1:195
    v_mfma_f32_16x16x32_bf16 v[44:47], v[152:155], v[116:119], v[44:47]
    ds_read2_b32 v[84:85], v6 offset0:64 offset1:65
    ds_read2_b32 v[86:87], v6 offset0:66 offset1:67
    v_mfma_f32_16x16x32_bf16 v[36:39], v[156:159], v[96:99], v[36:39]
    v_mfma_f32_16x16x32_bf16 v[40:43], v[156:159], v[104:107], v[40:43]
    v_mfma_f32_16x16x32_bf16 v[44:47], v[156:159], v[112:115], v[44:47]
    s_waitcnt lgkmcnt(4)
    v_mfma_f32_16x16x32_bf16 v[136:139], v[160:163], v[120:123], 0
    v_mfma_f32_16x16x32_bf16 v[140:143], v[160:163], v[124:127], 0
    v_mfma_f32_16x16x32_bf16 v[144:147], v[164:167], v[120:123], 0
    v_mfma_f32_16x16x32_bf16 v[148:151], v[164:167], v[124:127], 0
    v_mfma_f32_16x16x32_bf16 v[44:47], v[92:95], v[72:75], v[44:47]
    ds_read_b128 v[160:163], v14 offset:10240
    ds_read_b128 v[164:167], v14 offset:11264
    v_mfma_f32_16x16x32_bf16 v[36:39], v[88:91], v[68:71], v[36:39]
    ds_read_b128 v[72:75], v7 offset:12288
    v_mfma_f32_16x16x32_bf16 v[40:43], v[92:95], v[68:71], v[40:43]
    ds_read_b128 v[68:71], v7 offset:10240
    v_mfma_f32_16x16x32_bf16 v[32:35], v[88:91], v[64:67], v[32:35]
    v_mfma_f32_16x16x32_bf16 v[36:39], v[92:95], v[64:67], v[36:39]
    v_cvt_pk_bf16_f32 v159, v147, v151
    v_cvt_pk_bf16_f32 v158, v146, v150
    v_mfma_f32_16x16x32_bf16 v[28:31], v[88:91], v[60:63], v[28:31]
    v_cvt_pk_bf16_f32 v157, v145, v149
    v_cvt_pk_bf16_f32 v156, v144, v148
    v_mfma_f32_16x16x32_bf16 v[32:35], v[92:95], v[60:63], v[32:35]
    v_cvt_pk_bf16_f32 v155, v139, v143
    v_cvt_pk_bf16_f32 v154, v138, v142
    v_mfma_f32_16x16x32_bf16 v[24:27], v[88:91], v[56:59], v[24:27]
    v_cvt_pk_bf16_f32 v153, v137, v141
    v_cvt_pk_bf16_f32 v152, v136, v140
    s_nop 1
    v_mfma_f32_16x16x32_bf16 v[40:43], v[152:155], v[100:103], v[40:43]
    ds_read_b128 v[64:67], v7 offset:8192
    ds_read_b128 v[60:63], v7 offset:6144
    v_mfma_f32_16x16x32_bf16 v[44:47], v[152:155], v[108:111], v[44:47]
    v_mfma_f32_16x16x32_bf16 v[40:43], v[156:159], v[96:99], v[40:43]
    v_mfma_f32_16x16x32_bf16 v[44:47], v[156:159], v[104:107], v[44:47]
    s_waitcnt lgkmcnt(4)
    v_mfma_f32_16x16x32_bf16 v[136:139], v[160:163], v[120:123], 0
    v_mfma_f32_16x16x32_bf16 v[140:143], v[160:163], v[124:127], 0
    v_mfma_f32_16x16x32_bf16 v[144:147], v[164:167], v[120:123], 0
    v_mfma_f32_16x16x32_bf16 v[148:151], v[164:167], v[124:127], 0
    v_mfma_f32_16x16x32_bf16 v[28:31], v[92:95], v[56:59], v[28:31]
    ds_read_b128 v[160:163], v5 offset:0
    ds_read_b128 v[164:167], v15 offset:0
    v_mfma_f32_16x16x32_bf16 v[20:23], v[88:91], v[52:55], v[20:23]
    ds_read_b128 v[56:59], v7 offset:4096
    v_mfma_f32_16x16x32_bf16 v[24:27], v[92:95], v[52:55], v[24:27]
    ds_read_b128 v[52:55], v7 offset:2048
    v_mfma_f32_16x16x32_bf16 v[16:19], v[88:91], v[48:51], v[16:19]
    v_mfma_f32_16x16x32_bf16 v[20:23], v[92:95], v[48:51], v[20:23]
    v_cvt_pk_bf16_f32 v159, v147, v151
    v_cvt_pk_bf16_f32 v158, v146, v150
    v_mfma_f32_16x16x32_bf16 v[44:47], v[80:83], v[76:79], v[44:47]
    v_cvt_pk_bf16_f32 v157, v145, v149
    v_cvt_pk_bf16_f32 v156, v144, v148
    s_waitcnt lgkmcnt(4)
    v_mfma_f32_16x16x32_bf16 v[40:43], v[80:83], v[72:75], v[40:43]
    v_cvt_pk_bf16_f32 v155, v139, v143
    v_cvt_pk_bf16_f32 v154, v138, v142
    v_mfma_f32_16x16x32_bf16 v[44:47], v[84:87], v[72:75], v[44:47]
    v_cvt_pk_bf16_f32 v153, v137, v141
    v_cvt_pk_bf16_f32 v152, v136, v140
    s_nop 1
    v_mfma_f32_16x16x32_bf16 v[44:47], v[152:155], v[100:103], v[44:47]
    ds_read_b128 v[48:51], v7 offset:0
    ds_read_b128 v[76:79], v8 offset:14336
    v_mfma_f32_16x16x32_bf16 v[44:47], v[156:159], v[96:99], v[44:47]
    ds_read2_b32 v[88:89], v6 offset0:176 offset1:177
    ds_read2_b32 v[90:91], v6 offset0:178 offset1:179
    s_waitcnt lgkmcnt(4)
    v_mfma_f32_16x16x32_bf16 v[136:139], v[160:163], v[128:131], 0
    ds_read2_b32 v[92:93], v6 offset0:48 offset1:49
    ds_read2_b32 v[94:95], v6 offset0:50 offset1:51
    v_mfma_f32_16x16x32_bf16 v[140:143], v[164:167], v[132:135], 0
    ds_read_b128 v[72:75], v8 offset:12288
    ds_read2_b32 v[96:97], v13 offset0:48 offset1:49
    v_mfma_f32_16x16x32_bf16 v[36:39], v[80:83], v[68:71], v[36:39]
    ds_read2_b32 v[98:99], v13 offset0:50 offset1:51
    ds_read2_b32 v[100:101], v13 offset0:32 offset1:33
    v_mfma_f32_16x16x32_bf16 v[40:43], v[84:87], v[68:71], v[40:43]
    ds_read2_b32 v[102:103], v13 offset0:34 offset1:35
    ds_read2_b32 v[104:105], v13 offset0:16 offset1:17
    v_mfma_f32_16x16x32_bf16 v[32:35], v[80:83], v[64:67], v[32:35]
    ds_read2_b32 v[106:107], v13 offset0:18 offset1:19
    ds_read2_b32 v[108:109], v13 offset0:0 offset1:1
    v_mfma_f32_16x16x32_bf16 v[36:39], v[84:87], v[64:67], v[36:39]
    ds_read2_b32 v[110:111], v13 offset0:2 offset1:3
    ds_read_b128 v[160:163], v5 offset:2048
    v_mfma_f32_16x16x32_bf16 v[28:31], v[80:83], v[60:63], v[28:31]
    v_cvt_pk_bf16_f32 v155, v139, v143
    v_cvt_pk_bf16_f32 v154, v138, v142
    v_mfma_f32_16x16x32_bf16 v[32:35], v[84:87], v[60:63], v[32:35]
    v_cvt_pk_bf16_f32 v153, v137, v141
    v_cvt_pk_bf16_f32 v152, v136, v140
    v_mfma_f32_16x16x32_bf16 v[24:27], v[80:83], v[56:59], v[24:27]
    ds_read_b128 v[164:167], v15 offset:2048
    ds_read_b128 v[68:71], v8 offset:10240
    s_waitcnt lgkmcnt(4)
    v_mfma_f32_16x16x32_bf16 v[32:35], v[152:155], v[96:99], v[32:35]
    ds_read_b128 v[64:67], v8 offset:8192
    ds_read_b128 v[60:63], v8 offset:6144
    v_mfma_f32_16x16x32_bf16 v[36:39], v[152:155], v[100:103], v[36:39]
    v_mfma_f32_16x16x32_bf16 v[40:43], v[152:155], v[104:107], v[40:43]
    s_waitcnt lgkmcnt(4)
    v_mfma_f32_16x16x32_bf16 v[44:47], v[152:155], v[108:111], v[44:47]
    v_mfma_f32_16x16x32_bf16 v[144:147], v[160:163], v[128:131], 0
    s_waitcnt lgkmcnt(3)
    v_mfma_f32_16x16x32_bf16 v[148:151], v[164:167], v[132:135], 0
    v_mfma_f32_16x16x32_bf16 v[28:31], v[84:87], v[56:59], v[28:31]
    ds_read_b128 v[160:163], v5 offset:4096
    ds_read_b128 v[164:167], v15 offset:4096
    v_mfma_f32_16x16x32_bf16 v[20:23], v[80:83], v[52:55], v[20:23]
    ds_read_b128 v[56:59], v8 offset:4096
    v_mfma_f32_16x16x32_bf16 v[24:27], v[84:87], v[52:55], v[24:27]
    ds_read_b128 v[52:55], v8 offset:2048
    v_mfma_f32_16x16x32_bf16 v[16:19], v[80:83], v[48:51], v[16:19]
    v_mfma_f32_16x16x32_bf16 v[20:23], v[84:87], v[48:51], v[20:23]
    v_cvt_pk_bf16_f32 v159, v147, v151
    v_cvt_pk_bf16_f32 v158, v146, v150
    v_mfma_f32_16x16x32_bf16 v[44:47], v[88:91], v[76:79], v[44:47]
    v_cvt_pk_bf16_f32 v157, v145, v149
    v_cvt_pk_bf16_f32 v156, v144, v148
    v_mfma_f32_16x16x32_bf16 v[40:43], v[88:91], v[72:75], v[40:43]
    ds_read_b128 v[48:51], v8 offset:0
    ds_read_b128 v[76:79], v9 offset:14336
    v_mfma_f32_16x16x32_bf16 v[36:39], v[156:159], v[96:99], v[36:39]
    ds_read2_b32 v[80:81], v6 offset0:160 offset1:161
    ds_read2_b32 v[82:83], v6 offset0:162 offset1:163
    v_mfma_f32_16x16x32_bf16 v[40:43], v[156:159], v[100:103], v[40:43]
    ds_read2_b32 v[84:85], v6 offset0:32 offset1:33
    ds_read2_b32 v[86:87], v6 offset0:34 offset1:35
    v_mfma_f32_16x16x32_bf16 v[44:47], v[156:159], v[104:107], v[44:47]
    s_waitcnt lgkmcnt(4)
    v_mfma_f32_16x16x32_bf16 v[136:139], v[160:163], v[128:131], 0
    v_mfma_f32_16x16x32_bf16 v[140:143], v[164:167], v[132:135], 0
    v_mfma_f32_16x16x32_bf16 v[44:47], v[92:95], v[72:75], v[44:47]
    ds_read_b128 v[160:163], v5 offset:6144
    ds_read_b128 v[164:167], v15 offset:6144
    v_mfma_f32_16x16x32_bf16 v[36:39], v[88:91], v[68:71], v[36:39]
    ds_read_b128 v[72:75], v9 offset:12288
    v_mfma_f32_16x16x32_bf16 v[40:43], v[92:95], v[68:71], v[40:43]
    ds_read_b128 v[68:71], v9 offset:10240
    v_mfma_f32_16x16x32_bf16 v[32:35], v[88:91], v[64:67], v[32:35]
    v_mfma_f32_16x16x32_bf16 v[36:39], v[92:95], v[64:67], v[36:39]
    v_cvt_pk_bf16_f32 v155, v139, v143
    v_cvt_pk_bf16_f32 v154, v138, v142
    v_mfma_f32_16x16x32_bf16 v[28:31], v[88:91], v[60:63], v[28:31]
    v_cvt_pk_bf16_f32 v153, v137, v141
    v_cvt_pk_bf16_f32 v152, v136, v140
    v_mfma_f32_16x16x32_bf16 v[32:35], v[92:95], v[60:63], v[32:35]
    ds_read_b128 v[64:67], v9 offset:8192
    ds_read_b128 v[60:63], v9 offset:6144
    v_mfma_f32_16x16x32_bf16 v[40:43], v[152:155], v[96:99], v[40:43]
    v_mfma_f32_16x16x32_bf16 v[44:47], v[152:155], v[100:103], v[44:47]
    s_waitcnt lgkmcnt(4)
    v_mfma_f32_16x16x32_bf16 v[144:147], v[160:163], v[128:131], 0
    v_mfma_f32_16x16x32_bf16 v[148:151], v[164:167], v[132:135], 0
    v_mfma_f32_16x16x32_bf16 v[24:27], v[88:91], v[56:59], v[24:27]
    v_mfma_f32_16x16x32_bf16 v[28:31], v[92:95], v[56:59], v[28:31]
    ds_read_b128 v[56:59], v9 offset:4096
    v_mfma_f32_16x16x32_bf16 v[20:23], v[88:91], v[52:55], v[20:23]
    v_mfma_f32_16x16x32_bf16 v[24:27], v[92:95], v[52:55], v[24:27]
    ds_read_b128 v[52:55], v9 offset:2048
    v_mfma_f32_16x16x32_bf16 v[16:19], v[88:91], v[48:51], v[16:19]
    s_nop 0
    v_cvt_pk_bf16_f32 v159, v147, v151
    v_cvt_pk_bf16_f32 v158, v146, v150
    v_mfma_f32_16x16x32_bf16 v[20:23], v[92:95], v[48:51], v[20:23]
    v_cvt_pk_bf16_f32 v157, v145, v149
    v_cvt_pk_bf16_f32 v156, v144, v148
    v_mfma_f32_16x16x32_bf16 v[44:47], v[80:83], v[76:79], v[44:47]
    ds_read_b128 v[48:51], v9 offset:0
    ds_read_b128 v[76:79], v10 offset:14336
    v_mfma_f32_16x16x32_bf16 v[44:47], v[156:159], v[96:99], v[44:47]
    ds_read2_b32 v[88:89], v6 offset0:144 offset1:145
    ds_read2_b32 v[90:91], v6 offset0:146 offset1:147
    v_mov_b32 v160, 65537
    s_waitcnt lgkmcnt(4)
    v_mfma_f32_16x16x32_bf16 v[40:43], v[80:83], v[72:75], v[40:43]
    ds_read2_b32 v[92:93], v6 offset0:16 offset1:17
    ds_read2_b32 v[94:95], v6 offset0:18 offset1:19
    v_mfma_f32_16x16x32_bf16 v[44:47], v[84:87], v[72:75], v[44:47]
    ds_read_b128 v[72:75], v10 offset:12288
    v_mfma_f32_16x16x32_bf16 v[36:39], v[80:83], v[68:71], v[36:39]
    v_mfma_f32_16x16x32_bf16 v[40:43], v[84:87], v[68:71], v[40:43]
    ds_read_b128 v[68:71], v10 offset:10240
    v_mfma_f32_16x16x32_bf16 v[32:35], v[80:83], v[64:67], v[32:35]
    v_mfma_f32_16x16x32_bf16 v[36:39], v[84:87], v[64:67], v[36:39]
    ds_read_b128 v[64:67], v10 offset:8192
    v_mfma_f32_16x16x32_bf16 v[28:31], v[80:83], v[60:63], v[28:31]
    v_mfma_f32_16x16x32_bf16 v[32:35], v[84:87], v[60:63], v[32:35]
    ds_read_b128 v[60:63], v10 offset:6144
    v_mfma_f32_16x16x32_bf16 v[24:27], v[80:83], v[56:59], v[24:27]
    v_mfma_f32_16x16x32_bf16 v[28:31], v[84:87], v[56:59], v[28:31]
    ds_read_b128 v[56:59], v10 offset:4096
    v_mfma_f32_16x16x32_bf16 v[20:23], v[80:83], v[52:55], v[20:23]
    v_mfma_f32_16x16x32_bf16 v[24:27], v[84:87], v[52:55], v[24:27]
    ds_read_b128 v[52:55], v10 offset:2048
    s_waitcnt lgkmcnt(4)
    v_mfma_f32_16x16x32_bf16 v[16:19], v[80:83], v[48:51], v[16:19]
    v_mfma_f32_16x16x32_bf16 v[20:23], v[84:87], v[48:51], v[20:23]
    ds_read_b128 v[48:51], v10 offset:0
    v_mfma_f32_16x16x32_bf16 v[44:47], v[88:91], v[76:79], v[44:47]
    v_mfma_f32_16x16x32_bf16 v[40:43], v[88:91], v[72:75], v[40:43]
    v_mfma_f32_16x16x32_bf16 v[44:47], v[92:95], v[72:75], v[44:47]
    v_mfma_f32_16x16x32_bf16 v[36:39], v[88:91], v[68:71], v[36:39]
    v_mfma_f32_16x16x32_bf16 v[40:43], v[92:95], v[68:71], v[40:43]
    s_waitcnt lgkmcnt(4)
    v_mfma_f32_16x16x32_bf16 v[32:35], v[88:91], v[64:67], v[32:35]
    v_mfma_f32_16x16x32_bf16 v[36:39], v[92:95], v[64:67], v[36:39]
    s_nop 2
    v_perm_b32 v110, v45, v44, s101
    v_bfi_b32 v110, v160, s99, v110
    v_perm_b32 v111, v47, v46, s101
    v_bfi_b32 v111, v160, s99, v111
    ds_write_b64 v11, v[110:111] offset:14336
    s_waitcnt lgkmcnt(4)
    v_mfma_f32_16x16x32_bf16 v[28:31], v[88:91], v[60:63], v[28:31]
    v_mfma_f32_16x16x32_bf16 v[32:35], v[92:95], v[60:63], v[32:35]
    v_perm_b32 v108, v41, v40, s101
    v_bfi_b32 v108, v160, s99, v108
    v_perm_b32 v109, v43, v42, s101
    v_bfi_b32 v109, v160, s99, v109
    ds_write_b64 v11, v[108:109] offset:12288
    s_waitcnt lgkmcnt(4)
    v_mfma_f32_16x16x32_bf16 v[24:27], v[88:91], v[56:59], v[24:27]
    v_mfma_f32_16x16x32_bf16 v[28:31], v[92:95], v[56:59], v[28:31]
    v_perm_b32 v106, v37, v36, s101
    v_bfi_b32 v106, v160, s99, v106
    v_perm_b32 v107, v39, v38, s101
    v_bfi_b32 v107, v160, s99, v107
    ds_write_b64 v11, v[106:107] offset:10240
    s_waitcnt lgkmcnt(4)
    v_mfma_f32_16x16x32_bf16 v[20:23], v[88:91], v[52:55], v[20:23]
    v_mfma_f32_16x16x32_bf16 v[24:27], v[92:95], v[52:55], v[24:27]
    v_perm_b32 v104, v33, v32, s101
    v_bfi_b32 v104, v160, s99, v104
    v_perm_b32 v105, v35, v34, s101
    v_bfi_b32 v105, v160, s99, v105
    ds_write_b64 v11, v[104:105] offset:8192
    s_waitcnt lgkmcnt(4)
    v_mfma_f32_16x16x32_bf16 v[16:19], v[88:91], v[48:51], v[16:19]
    v_mfma_f32_16x16x32_bf16 v[20:23], v[92:95], v[48:51], v[20:23]
    v_perm_b32 v102, v29, v28, s101
    v_bfi_b32 v102, v160, s99, v102
    v_perm_b32 v103, v31, v30, s101
    v_bfi_b32 v103, v160, s99, v103
    ds_write_b64 v11, v[102:103] offset:6144
    v_perm_b32 v100, v25, v24, s101
    v_bfi_b32 v100, v160, s99, v100
    v_perm_b32 v101, v27, v26, s101
    v_bfi_b32 v101, v160, s99, v101
    ds_write_b64 v11, v[100:101] offset:4096
    v_perm_b32 v98, v21, v20, s101
    v_bfi_b32 v98, v160, s99, v98
    v_perm_b32 v99, v23, v22, s101
    v_bfi_b32 v99, v160, s99, v99
    ds_write_b64 v11, v[98:99] offset:2048
    v_perm_b32 v96, v17, v16, s101
    v_bfi_b32 v96, v160, s99, v96
    v_perm_b32 v97, v19, v18, s101
    v_bfi_b32 v97, v160, s99, v97
    ds_write_b64 v11, v[96:97] offset:0
    s_add_u32 s31, s33, 512
    s_waitcnt lgkmcnt(0)
    s_barrier
    v_add_u32 v3, s5, v2
    ds_read_b128 v[48:51], v3 offset:2048
    ds_read_b128 v[52:55], v3 offset:3072
    ds_read_b128 v[56:59], v3 offset:4096
    ds_read_b128 v[60:63], v3 offset:5120
    s_waitcnt lgkmcnt(3)
    buffer_store_dwordx4 v[48:51], v2, s[16:19], s38 offen offset:0 sc1
    s_waitcnt lgkmcnt(2)
    buffer_store_dwordx4 v[52:55], v2, s[16:19], s38 offen offset:1024 sc1
    s_waitcnt lgkmcnt(1)
    buffer_store_dwordx4 v[56:59], v2, s[16:19], s38 offen offset:2048 sc1
    s_waitcnt lgkmcnt(0)
    buffer_store_dwordx4 v[60:63], v2, s[16:19], s38 offen offset:3072 sc1
    s_cmp_lg_u32 s4, 0
    s_cbranch_scc1 L_hs_13
    v_mul_u32_u24 v163, 128, v1
    v_mov_b32 v164, 1
    s_mov_b32 s82, 15
    s_mov_b64 exec, s[82:83]
    buffer_atomic_add v164, v163, s[16:19], s31 offen sc0 sc1
    s_mov_b64 exec, -1
L_hs_13:
    s_and_b32 s93, s40, 15
    s_lshl_b32 s93, s93, 2
    s_add_u32 s93, s93, s4
    s_lshr_b32 s92, s40, 4
    v_and_b32 v6, 15, v1
    v_lshrrev_b32 v7, 4, v1
    v_lshlrev_b32 v4, 15, v7
    v_lshl_add_u32 v4, v6, 3, v4
    v_lshrrev_b32 v5, 2, v6
    v_lshlrev_b32 v5, 16, v5
    v_lshl_add_u32 v5, v7, 6, v5
    v_xor_b32 v6, s93, v6
    v_and_b32 v6, 3, v6
    v_lshl_add_u32 v5, v6, 4, v5
    s_lshl_b32 s94, s93, 17
    s_lshl_b32 s95, s92, 7
    s_add_u32 s94, s94, s95
    s_lshl_b32 s95, s92, 18
    s_lshl_b32 s93, s93, 8
    s_add_u32 s95, s95, s93
    s_add_u32 s95, s95, 12582912
    s_mov_b32 s96, 0x05040100
    s_mov_b32 s97, 0x07060302
    s_mov_b32 s50, 0
    s_add_u32 s41, s95, 16384
    s_add_u32 s42, s95, 32768
    s_add_u32 s43, s95, 49152
    s_add_u32 s32, s32, 512
    v_mov_b32 v165, 0
    s_mov_b64 exec, 1
    v_mov_b32 v166, 0
    buffer_atomic_add v166, v165, s[16:19], s32 offen sc0 sc1
    s_mov_b64 exec, -1
    s_mov_b32 s51, 0
    s_add_u32 s81, s80, 16
L_hw_14:
    s_waitcnt vmcnt(0)
    s_mov_b64 exec, s[82:83]
    v_xor_b32 v164, s80, v164
    v_cmp_le_u32 vcc, 16, v164
    s_nop 0
    s_mov_b64 s[82:83], vcc
    s_cbranch_vccz L_ac_16
    s_mov_b64 exec, vcc
    v_mov_b32 v164, 1
    buffer_atomic_add v164, v163, s[16:19], s31 offen sc0 sc1
L_ac_16:
    s_mov_b64 exec, 1
    v_cmp_ne_u32 vcc, s81, v166
    s_add_u32 s51, s51, 1
    s_or_b64 vcc, vcc, s[82:83]
    s_cbranch_vccz L_hok_15
    s_cmp_gt_u32 s51, 100
    s_cbranch_scc1 L_hok_15
    s_sleep 1
    v_mov_b32 v166, 0
    buffer_atomic_add v166, v165, s[16:19], s32 offen sc0 sc1
    s_branch L_hw_14
L_hok_15:
    s_mov_b64 exec, -1
    v_mov_b32 v6, s100
L_rx4:
    buffer_load_dwordx4 v[8:11], v5, s[16:19], s95 offen sc1
    buffer_load_dwordx4 v[12:15], v5, s[16:19], s41 offen sc1
    buffer_load_dwordx4 v[16:19], v5, s[16:19], s42 offen sc1
    buffer_load_dwordx4 v[20:23], v5, s[16:19], s43 offen sc1
    s_waitcnt vmcnt(3)
    v_xor_b32 v8, v6, v8
    v_xor_b32 v9, v6, v9
    v_xor_b32 v10, v6, v10
    v_xor_b32 v11, v6, v11
    v_and_b32 v7, v8, v9
    v_bitop3_b32 v7, v7, v10, v11 bitop3:0x80
    s_waitcnt vmcnt(2)
    v_xor_b32 v12, v6, v12
    v_xor_b32 v13, v6, v13
    v_xor_b32 v14, v6, v14
    v_xor_b32 v15, v6, v15
    v_bitop3_b32 v7, v7, v12, v13 bitop3:0x80
    v_bitop3_b32 v7, v7, v14, v15 bitop3:0x80
    s_waitcnt vmcnt(1)
    v_xor_b32 v16, v6, v16
    v_xor_b32 v17, v6, v17
    v_xor_b32 v18, v6, v18
    v_xor_b32 v19, v6, v19
    v_bitop3_b32 v7, v7, v16, v17 bitop3:0x80
    v_bitop3_b32 v7, v7, v18, v19 bitop3:0x80
    s_waitcnt vmcnt(0)
    v_xor_b32 v20, v6, v20
    v_xor_b32 v21, v6, v21
    v_xor_b32 v22, v6, v22
    v_xor_b32 v23, v6, v23
    v_bitop3_b32 v7, v7, v20, v21 bitop3:0x80
    v_bitop3_b32 v7, v7, v22, v23 bitop3:0x80
    v_and_b32 v7, 65537, v7
    v_cmp_ne_u32 vcc, 65537, v7
    s_add_u32 s50, s50, 1
    s_cbranch_vccz L_rxok_17
    s_sleep 4
    s_cmp_lt_u32 s50, 30000
    s_cbranch_scc1 L_rx4
L_rxok_17:
    s_and_b32 s41, s40, 15
    s_or_b32 s41, s41, s4
    s_cmp_lg_u32 s41, 0
    s_cbranch_scc1 L_ep_18
    v_mov_b32 v165, 0
    v_mov_b32 v166, s98
    buffer_store_dword v166, v165, s[16:19], s34 offen sc1
L_ep_18:
    v_perm_b32 v24, v12, v8, s96
    v_perm_b32 v25, v20, v16, s96
    buffer_store_dwordx2 v[24:25], v4, s[88:91], s94 offen sc1
    v_perm_b32 v26, v12, v8, s97
    v_perm_b32 v27, v20, v16, s97
    s_add_u32 s94, s94, 4096
    buffer_store_dwordx2 v[26:27], v4, s[88:91], s94 offen sc1
    v_perm_b32 v28, v13, v9, s96
    v_perm_b32 v29, v21, v17, s96
    s_add_u32 s94, s94, 4096
    buffer_store_dwordx2 v[28:29], v4, s[88:91], s94 offen sc1
    v_perm_b32 v30, v13, v9, s97
    v_perm_b32 v31, v21, v17, s97
    s_add_u32 s94, s94, 4096
    buffer_store_dwordx2 v[30:31], v4, s[88:91], s94 offen sc1
    v_perm_b32 v32, v14, v10, s96
    v_perm_b32 v33, v22, v18, s96
    s_add_u32 s94, s94, 4096
    buffer_store_dwordx2 v[32:33], v4, s[88:91], s94 offen sc1
    v_perm_b32 v34, v14, v10, s97
    v_perm_b32 v35, v22, v18, s97
    s_add_u32 s94, s94, 4096
    buffer_store_dwordx2 v[34:35], v4, s[88:91], s94 offen sc1
    v_perm_b32 v36, v15, v11, s96
    v_perm_b32 v37, v23, v19, s96
    s_add_u32 s94, s94, 4096
    buffer_store_dwordx2 v[36:37], v4, s[88:91], s94 offen sc1
    v_perm_b32 v38, v15, v11, s97
    v_perm_b32 v39, v23, v19, s97
    s_add_u32 s94, s94, 4096
    buffer_store_dwordx2 v[38:39], v4, s[88:91], s94 offen sc1
    s_endpgm
L_typeB2:
    s_sub_u32 s7, s44, 49248
    s_cmp_eq_u32 s4, 3
    s_cselect_b32 s7, s7, s44
    s_cselect_b32 s21, 8208, 0
    v_and_b32 v160, 7, v1
    v_mul_u32_u24 v160, s21, v160
    buffer_load_dword v94, v160, s[28:31], s7 offen offset:1022
    buffer_load_dword v95, v160, s[32:35], s7 offen offset:1022
    s_waitcnt vmcnt(7) lgkmcnt(0)
    s_barrier
    ds_read_b128 v[28:31], v3 offset:36864
    ds_read_b128 v[32:35], v3 offset:37888
    ds_read_b128 v[36:39], v3 offset:38912
    ds_read_b128 v[40:43], v3 offset:39936
    s_not_b32 s98, s98
    s_bfe_i32 s99, s98, 0x10000
    s_andn2_b32 s100, 0x10001, s99
    s_mov_b32 s101, 0x07060302
    s_mov_b32 s80, 1513920000
    s_mov_b64 s[82:83], 0
    s_waitcnt vmcnt(2)
    ds_read_b64_tr_b16 v[12:13], v2 offset:0
    ds_read_b64_tr_b16 v[14:15], v2 offset:256
    ds_read_b64_tr_b16 v[16:17], v2 offset:1024
    ds_read_b64_tr_b16 v[18:19], v2 offset:1280
    ds_read_b64_tr_b16 v[20:21], v2 offset:2048
    ds_read_b64_tr_b16 v[22:23], v2 offset:2304
    ds_read_b64_tr_b16 v[24:25], v2 offset:3072
    ds_read_b64_tr_b16 v[26:27], v2 offset:3328
    s_movk_i32 s23, 4224
    s_waitcnt lgkmcnt(4)
    v_mfma_f32_32x32x16_bf16 v[96:111], v[12:15], v[28:31], 0
    ds_read_b128 v[44:47], v3 offset:40960
    ds_read_b128 v[48:51], v3 offset:41984
    ds_read_b128 v[52:55], v3 offset:43008
    ds_read_b128 v[56:59], v3 offset:44032
    ds_read_b128 v[60:63], v3 offset:45056
    ds_read_b128 v[64:67], v3 offset:46080
    v_mfma_f32_32x32x16_bf16 v[112:127], v[12:15], v[36:39], 0
    ds_read_b128 v[68:71], v3 offset:47104
    ds_read_b128 v[72:75], v3 offset:48128
    ds_read_b128 v[76:79], v3 offset:49152
    ds_read_b128 v[80:83], v3 offset:50176
    ds_read_b128 v[84:87], v3 offset:51200
    ds_read_b128 v[88:91], v3 offset:52224
    v_mfma_f32_32x32x16_bf16 v[96:111], v[16:19], v[32:35], v[96:111]
    v_and_b32 v5, 1, v1
    v_cvt_f32_u32 v6, v5
    v_mul_f32 v6, 0x3e800000, v6
    v_bfe_u32 v5, v1, 1, 3
    v_cvt_f32_u32 v10, v5
    v_mul_f32 v10, 0x3a000000, v10
    v_mfma_f32_32x32x16_bf16 v[112:127], v[16:19], v[40:43], v[112:127]
    v_lshrrev_b32 v7, 4, v1
    v_lshl_add_u32 v11, v7, 9, s40
    v_cvt_f32_u32 v11, v11
    v_fma_f32 v11, v11, v10, v6
    v_fmamk_f32 v161, v10, 0x43800000, v11
    v_cos_f32 v162, v11
    s_waitcnt lgkmcnt(12)
    v_mfma_f32_32x32x16_bf16 v[128:143], v[20:23], v[28:31], 0
    v_sin_f32 v163, v11
    v_cos_f32 v164, v161
    v_sin_f32 v165, v161
    v_mfma_f32_32x32x16_bf16 v[144:159], v[20:23], v[36:39], 0
    v_cvt_pk_bf16_f32 v92, v162, v163
    v_cvt_pk_bf16_f32 v93, v164, v165
    s_lshl_b32 s21, s4, 12
    v_lshl_add_u32 v10, v5, 6, s21
    s_bfe_u32 s7, s40, 0x10006
    v_and_b32 v5, 1, v1
    v_xor_b32 v5, s7, v5
    v_lshl_add_u32 v10, v5, 5, v10
    v_mfma_f32_32x32x16_bf16 v[128:143], v[24:27], v[32:35], v[128:143]
    v_lshl_add_u32 v10, v7, 3, v10
    v_and_b32 v5, 4, v1
    v_lshlrev_b32 v5, 2, v5
    v_xor_b32 v10, v10, v5
    s_and_b32 s20, s40, 15
    s_lshl_b32 s20, s20, 4
    s_lshr_b32 s21, s40, 4
    s_add_u32 s20, s20, s21
    s_lshl_b32 s20, s20, 6
    s_lshl_b32 s22, s40, 6
    s_add_u32 s22, s22, 17432576
    s_lshl_b32 s21, s4, 17
    s_add_u32 s20, s20, s21
    s_mul_i32 s7, s4, 4224
    s_add_u32 s7, s7, 16384
    v_and_b32 v11, 31, v1
    v_lshl_add_u32 v11, v11, 3, s7
    v_mfma_f32_32x32x16_bf16 v[144:159], v[24:27], v[40:43], v[144:159]
    v_lshl_add_u32 v11, v4, 9, v11
    s_lshl_b32 s21, s4, 4
    v_mov_b32 v8, s21
    s_lshl_b32 s7, s4, 10
    s_add_u32 s7, s7, 16384
    v_and_b32 v5, 15, v1
    v_lshl_add_u32 v5, v5, 3, s7
    v_mad_u32_u24 v9, v7, s23, v5
    v_mov_b32 v6, 1.0
    v_writelane_b32 v6, 0.5, 0
    s_waitcnt lgkmcnt(0)
    v_pk_mul_f32 v[160:161], v[112:113], v[60:61]
    v_pk_mul_f32 v[162:163], v[96:97], v[60:61]
    v_pk_fma_f32 v[160:161], v[96:97], v[44:45], v[160:161]
    v_pk_fma_f32 v[162:163], v[112:113], v[44:45], v[162:163] neg_lo:[0,0,1] neg_hi:[0,0,1]
    v_cvt_pk_bf16_f32 v12, v160, v161
    v_cvt_pk_bf16_f32 v20, v162, v163
    v_pk_mul_f32 v[164:165], v[114:115], v[62:63]
    v_pk_mul_f32 v[166:167], v[98:99], v[62:63]
    v_pk_fma_f32 v[164:165], v[98:99], v[46:47], v[164:165]
    v_pk_fma_f32 v[166:167], v[114:115], v[46:47], v[166:167] neg_lo:[0,0,1] neg_hi:[0,0,1]
    v_pk_add_f32 v[96:97], v[96:97], v[98:99]
    v_cvt_pk_bf16_f32 v13, v164, v165
    v_cvt_pk_bf16_f32 v21, v166, v167
    v_pk_mul_f32 v[160:161], v[116:117], v[64:65]
    v_pk_mul_f32 v[162:163], v[100:101], v[64:65]
    v_pk_fma_f32 v[160:161], v[100:101], v[48:49], v[160:161]
    v_pk_fma_f32 v[162:163], v[116:117], v[48:49], v[162:163] neg_lo:[0,0,1] neg_hi:[0,0,1]
    v_pk_add_f32 v[96:97], v[96:97], v[100:101]
    v_cvt_pk_bf16_f32 v14, v160, v161
    v_cvt_pk_bf16_f32 v22, v162, v163
    v_pk_mul_f32 v[164:165], v[118:119], v[66:67]
    v_pk_mul_f32 v[166:167], v[102:103], v[66:67]
    v_pk_fma_f32 v[164:165], v[102:103], v[50:51], v[164:165]
    v_pk_fma_f32 v[166:167], v[118:119], v[50:51], v[166:167] neg_lo:[0,0,1] neg_hi:[0,0,1]
    v_pk_add_f32 v[96:97], v[96:97], v[102:103]
    v_cvt_pk_bf16_f32 v15, v164, v165
    v_cvt_pk_bf16_f32 v23, v166, v167
    v_pk_mul_f32 v[160:161], v[120:121], v[68:69]
    v_pk_mul_f32 v[162:163], v[104:105], v[68:69]
    v_pk_fma_f32 v[160:161], v[104:105], v[52:53], v[160:161]
    v_pk_fma_f32 v[162:163], v[120:121], v[52:53], v[162:163] neg_lo:[0,0,1] neg_hi:[0,0,1]
    v_pk_add_f32 v[96:97], v[96:97], v[104:105]
    v_cvt_pk_bf16_f32 v16, v160, v161
    v_cvt_pk_bf16_f32 v24, v162, v163
    v_pk_mul_f32 v[164:165], v[122:123], v[70:71]
    v_pk_mul_f32 v[166:167], v[106:107], v[70:71]
    v_pk_fma_f32 v[164:165], v[106:107], v[54:55], v[164:165]
    v_pk_fma_f32 v[166:167], v[122:123], v[54:55], v[166:167] neg_lo:[0,0,1] neg_hi:[0,0,1]
    v_pk_add_f32 v[96:97], v[96:97], v[106:107]
    v_cvt_pk_bf16_f32 v17, v164, v165
    v_cvt_pk_bf16_f32 v25, v166, v167
    v_pk_mul_f32 v[160:161], v[124:125], v[72:73]
    v_pk_mul_f32 v[162:163], v[108:109], v[72:73]
    v_pk_fma_f32 v[160:161], v[108:109], v[56:57], v[160:161]
    v_pk_fma_f32 v[162:163], v[124:125], v[56:57], v[162:163] neg_lo:[0,0,1] neg_hi:[0,0,1]
    v_pk_add_f32 v[96:97], v[96:97], v[108:109]
    v_cvt_pk_bf16_f32 v18, v160, v161
    v_cvt_pk_bf16_f32 v26, v162, v163
    v_pk_mul_f32 v[164:165], v[126:127], v[74:75]
    v_pk_mul_f32 v[166:167], v[110:111], v[74:75]
    v_pk_fma_f32 v[164:165], v[110:111], v[58:59], v[164:165]
    v_pk_fma_f32 v[166:167], v[126:127], v[58:59], v[166:167] neg_lo:[0,0,1] neg_hi:[0,0,1]
    v_pk_add_f32 v[96:97], v[96:97], v[110:111]
    v_cvt_pk_bf16_f32 v19, v164, v165
    v_cvt_pk_bf16_f32 v27, v166, v167
    v_sub_f32 v3, v96, v97
    v_mfma_f32_32x32x16_bf16 v[96:111], v[76:79], v[12:15], 0
    v_mfma_f32_32x32x16_bf16 v[96:111], v[80:83], v[16:19], v[96:111]
    v_mfma_f32_32x32x16_bf16 v[96:111], v[84:87], v[20:23], v[96:111]
    v_mfma_f32_32x32x16_bf16 v[96:111], v[88:91], v[24:27], v[96:111]
    v_pk_mul_f32 v[160:161], v[144:145], v[60:61]
    v_pk_mul_f32 v[162:163], v[128:129], v[60:61]
    v_pk_fma_f32 v[160:161], v[128:129], v[44:45], v[160:161]
    v_pk_fma_f32 v[162:163], v[144:145], v[44:45], v[162:163] neg_lo:[0,0,1] neg_hi:[0,0,1]
    v_cvt_pk_bf16_f32 v28, v160, v161
    v_cvt_pk_bf16_f32 v36, v162, v163
    v_pk_mul_f32 v[164:165], v[146:147], v[62:63]
    v_pk_mul_f32 v[166:167], v[130:131], v[62:63]
    v_pk_fma_f32 v[164:165], v[130:131], v[46:47], v[164:165]
    v_pk_fma_f32 v[166:167], v[146:147], v[46:47], v[166:167] neg_lo:[0,0,1] neg_hi:[0,0,1]
    v_pk_add_f32 v[128:129], v[128:129], v[130:131]
    v_cvt_pk_bf16_f32 v29, v164, v165
    v_cvt_pk_bf16_f32 v37, v166, v167
    v_pk_mul_f32 v[160:161], v[148:149], v[64:65]
    v_pk_mul_f32 v[162:163], v[132:133], v[64:65]
    v_pk_fma_f32 v[160:161], v[132:133], v[48:49], v[160:161]
    v_pk_fma_f32 v[162:163], v[148:149], v[48:49], v[162:163] neg_lo:[0,0,1] neg_hi:[0,0,1]
    v_pk_add_f32 v[128:129], v[128:129], v[132:133]
    v_cvt_pk_bf16_f32 v30, v160, v161
    v_cvt_pk_bf16_f32 v38, v162, v163
    v_pk_mul_f32 v[164:165], v[150:151], v[66:67]
    v_pk_mul_f32 v[166:167], v[134:135], v[66:67]
    v_pk_fma_f32 v[164:165], v[134:135], v[50:51], v[164:165]
    v_pk_fma_f32 v[166:167], v[150:151], v[50:51], v[166:167] neg_lo:[0,0,1] neg_hi:[0,0,1]
    v_pk_add_f32 v[128:129], v[128:129], v[134:135]
    v_cvt_pk_bf16_f32 v31, v164, v165
    v_cvt_pk_bf16_f32 v39, v166, v167
    v_pk_mul_f32 v[160:161], v[152:153], v[68:69]
    v_pk_mul_f32 v[162:163], v[136:137], v[68:69]
    v_pk_fma_f32 v[160:161], v[136:137], v[52:53], v[160:161]
    v_pk_fma_f32 v[162:163], v[152:153], v[52:53], v[162:163] neg_lo:[0,0,1] neg_hi:[0,0,1]
    v_pk_add_f32 v[128:129], v[128:129], v[136:137]
    v_cvt_pk_bf16_f32 v32, v160, v161
    v_cvt_pk_bf16_f32 v40, v162, v163
    v_pk_mul_f32 v[164:165], v[154:155], v[70:71]
    v_pk_mul_f32 v[166:167], v[138:139], v[70:71]
    v_pk_fma_f32 v[164:165], v[138:139], v[54:55], v[164:165]
    v_pk_fma_f32 v[166:167], v[154:155], v[54:55], v[166:167] neg_lo:[0,0,1] neg_hi:[0,0,1]
    v_pk_add_f32 v[128:129], v[128:129], v[138:139]
    v_cvt_pk_bf16_f32 v33, v164, v165
    v_cvt_pk_bf16_f32 v41, v166, v167
    v_pk_mul_f32 v[160:161], v[156:157], v[72:73]
    v_pk_mul_f32 v[162:163], v[140:141], v[72:73]
    v_pk_fma_f32 v[160:161], v[140:141], v[56:57], v[160:161]
    v_pk_fma_f32 v[162:163], v[156:157], v[56:57], v[162:163] neg_lo:[0,0,1] neg_hi:[0,0,1]
    v_pk_add_f32 v[128:129], v[128:129], v[140:141]
    v_cvt_pk_bf16_f32 v34, v160, v161
    v_cvt_pk_bf16_f32 v42, v162, v163
    v_pk_mul_f32 v[164:165], v[158:159], v[74:75]
    v_pk_mul_f32 v[166:167], v[142:143], v[74:75]
    v_pk_fma_f32 v[164:165], v[142:143], v[58:59], v[164:165]
    v_pk_fma_f32 v[166:167], v[158:159], v[58:59], v[166:167] neg_lo:[0,0,1] neg_hi:[0,0,1]
    v_pk_add_f32 v[128:129], v[128:129], v[142:143]
    v_cvt_pk_bf16_f32 v35, v164, v165
    v_cvt_pk_bf16_f32 v43, v166, v167
    v_sub_f32 v4, v128, v129
    v_mfma_f32_32x32x16_bf16 v[128:143], v[76:79], v[28:31], 0
    v_mfma_f32_32x32x16_bf16 v[128:143], v[80:83], v[32:35], v[128:143]
    v_mfma_f32_32x32x16_bf16 v[128:143], v[84:87], v[36:39], v[128:143]
    v_mfma_f32_32x32x16_bf16 v[128:143], v[88:91], v[40:43], v[128:143]
    v_readlane_b32 s24, v3, 32
    v_readlane_b32 s25, v4, 32
    s_nop 0
    v_add_f32 v3, s24, v3
    v_add_f32 v4, s25, v4
    v_cvt_pk_bf16_f32 v160, v3, v4
    s_mov_b64 exec, 1
    ds_write_b32 v8, v160 offset:33280
    s_mov_b64 exec, -1
    v_mul_f32 v96, v6, v96
    v_mul_f32 v97, v6, v97
    v_cvt_pk_bf16_f32 v112, v96, v97
    v_cvt_pk_bf16_f32 v114, v98, v99
    v_cvt_pk_bf16_f32 v116, v100, v101
    v_cvt_pk_bf16_f32 v118, v102, v103
    v_cvt_pk_bf16_f32 v120, v104, v105
    v_cvt_pk_bf16_f32 v122, v106, v107
    v_cvt_pk_bf16_f32 v124, v108, v109
    v_cvt_pk_bf16_f32 v126, v110, v111
    v_mul_f32 v128, v6, v128
    v_mul_f32 v129, v6, v129
    v_cvt_pk_bf16_f32 v113, v128, v129
    ds_write_b64 v11, v[112:113] offset:0
    v_cvt_pk_bf16_f32 v115, v130, v131
    ds_write_b64 v11, v[114:115] offset:256
    v_cvt_pk_bf16_f32 v117, v132, v133
    ds_write_b64 v11, v[116:117] offset:1024
    v_cvt_pk_bf16_f32 v119, v134, v135
    ds_write_b64 v11, v[118:119] offset:1280
    v_cvt_pk_bf16_f32 v121, v136, v137
    ds_write_b64 v11, v[120:121] offset:2048
    v_cvt_pk_bf16_f32 v123, v138, v139
    ds_write_b64 v11, v[122:123] offset:2304
    v_cvt_pk_bf16_f32 v125, v140, v141
    ds_write_b64 v11, v[124:125] offset:3072
    v_cvt_pk_bf16_f32 v127, v142, v143
    ds_write_b64 v11, v[126:127] offset:3328
    s_and_b32 s7, s40, 15
    s_lshr_b32 s7, s7, 1
    s_lshl_b32 s7, s7, 7
    s_add_u32 s23, s7, 16842752
    s_waitcnt lgkmcnt(0)
    s_barrier
    ds_read_b64 v[12:13], v9 offset:0
    ds_read_b64 v[14:15], v9 offset:128
    ds_read_b64 v[16:17], v9 offset:256
    ds_read_b64 v[18:19], v9 offset:384
    ds_read_b64 v[20:21], v9 offset:512
    ds_read_b64 v[22:23], v9 offset:640
    ds_read_b64 v[24:25], v9 offset:768
    ds_read_b64 v[26:27], v9 offset:896
    s_lshl_b32 s7, s4, 12
    v_bfe_u32 v52, v1, 3, 1
    v_xor_b32 v52, v52, v1
    v_lshl_add_u32 v52, v52, 4, s7
    v_bfe_u32 v53, v1, 2, 3
    v_lshlrev_b32 v53, 19, v53
    v_lshrrev_b32 v54, 5, v1
    v_lshl_add_u32 v53, v54, 14, v53
    v_and_b32 v54, 3, v1
    v_lshl_add_u32 v53, v54, 4, v53
    s_waitcnt lgkmcnt(7)
    v_mfma_f32_16x16x16_bf16 v[128:131], v[12:13], v[92:93], 0
    s_waitcnt lgkmcnt(6)
    v_mfma_f32_16x16x16_bf16 v[132:135], v[14:15], v[92:93], 0
    s_waitcnt lgkmcnt(5)
    v_mfma_f32_16x16x16_bf16 v[136:139], v[16:17], v[92:93], 0
    s_waitcnt lgkmcnt(4)
    v_mfma_f32_16x16x16_bf16 v[140:143], v[18:19], v[92:93], 0
    s_waitcnt lgkmcnt(3)
    v_mfma_f32_16x16x16_bf16 v[144:147], v[20:21], v[92:93], 0
    s_waitcnt lgkmcnt(2)
    v_mfma_f32_16x16x16_bf16 v[148:151], v[22:23], v[92:93], 0
    s_waitcnt lgkmcnt(1)
    v_mfma_f32_16x16x16_bf16 v[152:155], v[24:25], v[92:93], 0
    s_waitcnt lgkmcnt(0)
    v_mfma_f32_16x16x16_bf16 v[156:159], v[26:27], v[92:93], 0
    v_mov_b32 v167, 65537
    v_perm_b32 v32, v129, v128, s101
    v_bfi_b32 v32, v167, s99, v32
    v_perm_b32 v33, v131, v130, s101
    v_bfi_b32 v33, v167, s99, v33
    ds_write_b64 v10, v[32:33] offset:0
    v_perm_b32 v34, v133, v132, s101
    v_bfi_b32 v34, v167, s99, v34
    v_perm_b32 v35, v135, v134, s101
    v_bfi_b32 v35, v167, s99, v35
    ds_write_b64 v10, v[34:35] offset:512
    v_perm_b32 v36, v137, v136, s101
    v_bfi_b32 v36, v167, s99, v36
    v_perm_b32 v37, v139, v138, s101
    v_bfi_b32 v37, v167, s99, v37
    ds_write_b64 v10, v[36:37] offset:1024
    v_perm_b32 v38, v141, v140, s101
    v_bfi_b32 v38, v167, s99, v38
    v_perm_b32 v39, v143, v142, s101
    v_bfi_b32 v39, v167, s99, v39
    ds_write_b64 v10, v[38:39] offset:1536
    v_perm_b32 v40, v145, v144, s101
    v_bfi_b32 v40, v167, s99, v40
    v_perm_b32 v41, v147, v146, s101
    v_bfi_b32 v41, v167, s99, v41
    ds_write_b64 v10, v[40:41] offset:2048
    v_perm_b32 v42, v149, v148, s101
    v_bfi_b32 v42, v167, s99, v42
    v_perm_b32 v43, v151, v150, s101
    v_bfi_b32 v43, v167, s99, v43
    ds_write_b64 v10, v[42:43] offset:2560
    v_perm_b32 v44, v153, v152, s101
    v_bfi_b32 v44, v167, s99, v44
    v_perm_b32 v45, v155, v154, s101
    v_bfi_b32 v45, v167, s99, v45
    ds_write_b64 v10, v[44:45] offset:3072
    v_perm_b32 v46, v157, v156, s101
    v_bfi_b32 v46, v167, s99, v46
    v_perm_b32 v47, v159, v158, s101
    v_bfi_b32 v47, v167, s99, v47
    ds_write_b64 v10, v[46:47] offset:3584
    ds_read_b128 v[12:15], v52 offset:0
    ds_read_b128 v[16:19], v52 offset:1024
    ds_read_b128 v[20:23], v52 offset:2048
    ds_read_b128 v[24:27], v52 offset:3072
    s_mul_i32 s7, s4, 4608
    s_add_u32 s23, s23, s7
    v_mul_u32_u24 v165, 1152, v1
    v_mov_b32 v166, 1
    s_mov_b32 s82, 15
    s_mov_b64 exec, s[82:83]
    buffer_atomic_add v166, v165, s[16:19], s23 offen sc0 sc1
    s_mov_b64 exec, -1
L_hs_19:
L_sg1:
    s_waitcnt lgkmcnt(3)
    buffer_store_dwordx4 v[12:15], v53, s[16:19], s20 offen sc1
    s_waitcnt lgkmcnt(2)
    s_add_u32 s20, s20, 32768
    buffer_store_dwordx4 v[16:19], v53, s[16:19], s20 offen sc1
    s_waitcnt lgkmcnt(1)
    s_add_u32 s20, s20, 32768
    buffer_store_dwordx4 v[20:23], v53, s[16:19], s20 offen sc1
    s_waitcnt lgkmcnt(0)
    s_add_u32 s20, s20, 32768
    buffer_store_dwordx4 v[24:27], v53, s[16:19], s20 offen sc1
    s_cmp_lg_u32 s4, 3
    s_cbranch_scc1 L_p1_end
    v_lshrrev_b32 v54, 1, v1
    v_lshlrev_b32 v54, 4, v54
    v_and_b32 v55, 1, v1
    v_lshl_add_u32 v54, v55, 1, v54
    v_lshlrev_b32 v55, 4, v1
    s_mov_b64 exec, 255
    s_waitcnt vmcnt(4)
    ds_write_b16_d16_hi v54, v94 offset:33284
    ds_write_b16_d16_hi v54, v95 offset:33288
    ds_read_b128 v[28:31], v55 offset:33280
    s_mov_b64 exec, 15
    s_waitcnt lgkmcnt(0)
    v_mov_b32 v31, s98
    buffer_store_dwordx4 v[28:31], v55, s[16:19], s22 offen sc1
    s_mov_b64 exec, -1
L_p1_end:
    s_barrier
L_p2:
    s_lshl_b32 s21, s4, 12
    v_lshlrev_b32 v2, 4, v1
    v_add_u32 v8, s21, v2
    s_and_b32 s5, s40, 7
    s_lshr_b32 s6, s40, 3
    s_lshl_b32 s7, s5, 5
    s_add_u32 s7, s7, s6
    s_lshl_b32 s20, s7, 14
    s_add_u32 s20, s20, s21
    s_add_u32 s25, s21, 36864
    s_mov_b32 s46, 131328
    v_add_u32 v3, 0, v1
    v_mul_u32_u24 v4, 171, v3
    v_lshrrev_b32 v4, 9, v4
    v_mul_u32_u24 v3, 12, v3
    v_and_b32 v5, 15, v4
    v_mul_lo_u32 v5, v5, s46
    v_mul_u32_u24 v9, 36, v4
    v_sub_u32 v3, v3, v9
    v_lshrrev_b32 v4, 4, v4
    v_mul_u32_u24 v4, 8208, v4
    v_add3_u32 v156, v3, v4, v5
    v_add_u32 v3, 64, v1
    v_mul_u32_u24 v4, 171, v3
    v_lshrrev_b32 v4, 9, v4
    v_mul_u32_u24 v3, 12, v3
    v_and_b32 v5, 15, v4
    v_mul_lo_u32 v5, v5, s46
    v_mul_u32_u24 v9, 36, v4
    v_sub_u32 v3, v3, v9
    v_lshrrev_b32 v4, 4, v4
    v_mul_u32_u24 v4, 8208, v4
    v_add3_u32 v157, v3, v4, v5
    v_add_u32 v3, 128, v1
    v_mul_u32_u24 v4, 171, v3
    v_lshrrev_b32 v4, 9, v4
    v_mul_u32_u24 v3, 12, v3
    v_and_b32 v5, 15, v4
    v_mul_lo_u32 v5, v5, s46
    v_mul_u32_u24 v9, 36, v4
    v_sub_u32 v3, v3, v9
    v_lshrrev_b32 v4, 4, v4
    v_mul_u32_u24 v4, 8208, v4
    v_add3_u32 v158, v3, v4, v5
    s_mul_i32 s48, s5, 1026
    s_lshl_b32 s47, s6, 5
    s_add_u32 s48, s48, s47
    s_mul_i32 s47, s4, 32832
    s_add_u32 s48, s48, s47
    s_andn2_b32 s48, s48, 3
    s_mul_i32 s47, s4, 6144
    s_add_u32 s47, s47, 28672
    s_lshr_b32 s26, s40, 6
    s_mul_i32 s26, s26, 4
    s_and_b32 s27, s40, 3
    s_add_u32 s26, s26, s27
    s_mul_i32 s26, s26, 1152
    s_lshl_b32 s27, s4, 8
    s_add_u32 s26, s26, s27
    s_add_u32 s26, s26, 16842752
    v_lshlrev_b32 v152, 7, v1
    s_setprio 0
    v_and_b32 v6, 15, v1
    v_lshrrev_b32 v7, 4, v1
    v_cvt_f32_u32 v10, v6
    v_mul_f32 v10, 0x3b800000, v10
    v_lshlrev_b32 v3, 6, v7
    v_cvt_f32_u32 v4, v3
    v_mul_f32 v4, v4, v10
    s_lshl_b32 s7, s4, 2
    v_add_u32 v3, s7, v3
    v_cvt_f32_u32 v9, v3
    v_mul_f32 v9, v9, v10
    v_fmamk_f32 v141, v10, 0x41800000, v9
    v_cos_f32 v142, v9
    v_cos_f32 v143, v141
    v_sin_f32 v144, v9
    v_sin_f32 v145, v141
    s_nop 0
    v_cvt_pk_bf16_f32 v12, -v144, -v145
    v_cvt_pk_bf16_f32 v14, v142, v143
    v_cvt_pk_bf16_f32 v16, v144, v145
    v_fmamk_f32 v140, v10, 0x42000000, v9
    v_fmamk_f32 v141, v10, 0x42400000, v9
    v_cos_f32 v142, v140
    v_cos_f32 v143, v141
    v_sin_f32 v144, v140
    v_sin_f32 v145, v141
    s_nop 0
    v_cvt_pk_bf16_f32 v13, -v144, -v145
    v_cvt_pk_bf16_f32 v15, v142, v143
    v_cvt_pk_bf16_f32 v17, v144, v145
    v_fmamk_f32 v140, v10, 0x3f800000, v9
    v_fmamk_f32 v141, v10, 0x41880000, v9
    v_cos_f32 v142, v140
    v_cos_f32 v143, v141
    v_sin_f32 v144, v140
    v_sin_f32 v145, v141
    s_nop 0
    v_cvt_pk_bf16_f32 v18, -v144, -v145
    v_cvt_pk_bf16_f32 v20, v142, v143
    v_cvt_pk_bf16_f32 v22, v144, v145
    v_fmamk_f32 v140, v10, 0x42040000, v9
    v_fmamk_f32 v141, v10, 0x42440000, v9
    v_cos_f32 v142, v140
    v_cos_f32 v143, v141
    v_sin_f32 v144, v140
    v_sin_f32 v145, v141
    s_nop 0
    v_cvt_pk_bf16_f32 v19, -v144, -v145
    v_cvt_pk_bf16_f32 v21, v142, v143
    v_cvt_pk_bf16_f32 v23, v144, v145
    v_fmamk_f32 v140, v10, 0x40000000, v9
    v_fmamk_f32 v141, v10, 0x41900000, v9
    v_cos_f32 v142, v140
    v_cos_f32 v143, v141
    v_sin_f32 v144, v140
    v_sin_f32 v145, v141
    s_nop 0
    v_cvt_pk_bf16_f32 v24, -v144, -v145
    v_cvt_pk_bf16_f32 v26, v142, v143
    v_cvt_pk_bf16_f32 v28, v144, v145
    v_fmamk_f32 v140, v10, 0x42080000, v9
    v_fmamk_f32 v141, v10, 0x42480000, v9
    v_cos_f32 v142, v140
    v_cos_f32 v143, v141
    v_sin_f32 v144, v140
    v_sin_f32 v145, v141
    s_nop 0
    v_cvt_pk_bf16_f32 v25, -v144, -v145
    v_cvt_pk_bf16_f32 v27, v142, v143
    v_cvt_pk_bf16_f32 v29, v144, v145
    v_lshrrev_b32 v61, 5, v1
    v_mul_u32_u24 v61, 8208, v61
    v_and_b32 v60, 31, v1
    v_lshlrev_b32 v60, 7, v60
    v_min_u32 v60, 1022, v60
    v_add_u32 v61, v60, v61
    s_waitcnt vmcnt(0)
    buffer_load_dword v62, v61, s[28:31], s44 offen nt
    buffer_load_dword v63, v61, s[32:35], s44 offen nt
    v_fmamk_f32 v140, v10, 0x40400000, v9
    v_fmamk_f32 v141, v10, 0x41980000, v9
    v_cos_f32 v142, v140
    v_cos_f32 v143, v141
    v_sin_f32 v144, v140
    v_sin_f32 v145, v141
    s_nop 0
    v_cvt_pk_bf16_f32 v30, -v144, -v145
    v_cvt_pk_bf16_f32 v32, v142, v143
    v_cvt_pk_bf16_f32 v34, v144, v145
    v_fmamk_f32 v140, v10, 0x420c0000, v9
    v_fmamk_f32 v141, v10, 0x424c0000, v9
    v_cos_f32 v142, v140
    v_cos_f32 v143, v141
    v_sin_f32 v144, v140
    v_sin_f32 v145, v141
    s_nop 0
    v_cvt_pk_bf16_f32 v31, -v144, -v145
    v_cvt_pk_bf16_f32 v33, v142, v143
    v_cvt_pk_bf16_f32 v35, v144, v145
    v_fmamk_f32 v141, v10, 0x41800000, v4
    v_cos_f32 v142, v4
    v_cos_f32 v143, v141
    v_sin_f32 v144, v4
    v_sin_f32 v145, v141
    v_mul_f32 v142, 0x3a800000, v142
    v_mul_f32 v143, 0x3a800000, v143
    v_mul_f32 v144, 0x3a800000, v144
    v_mul_f32 v145, 0x3a800000, v145
    v_cvt_pk_bf16_f32 v36, -v144, -v145
    v_cvt_pk_bf16_f32 v38, v142, v143
    v_cvt_pk_bf16_f32 v40, v144, v145
    v_fmamk_f32 v140, v10, 0x42000000, v4
    v_fmamk_f32 v141, v10, 0x42400000, v4
    v_cos_f32 v142, v140
    v_cos_f32 v143, v141
    v_sin_f32 v144, v140
    v_sin_f32 v145, v141
    v_mul_f32 v142, 0x3a800000, v142
    v_mul_f32 v143, 0x3a800000, v143
    v_mul_f32 v144, 0x3a800000, v144
    v_mul_f32 v145, 0x3a800000, v145
    v_cvt_pk_bf16_f32 v37, -v144, -v145
    v_cvt_pk_bf16_f32 v39, v142, v143
    v_cvt_pk_bf16_f32 v41, v144, v145
    s_setprio 2
    s_mov_b64 exec, 3
    v_mov_b32 v153, 0
    buffer_atomic_add v153, v152, s[16:19], s26 offen sc0 sc1
    s_mov_b64 exec, -1
    s_and_b32 s7, s5, 1
    v_add_u32 v10, s7, v6
    v_mul_u32_u24 v3, 43, v10
    v_lshrrev_b32 v3, 8, v3
    v_lshl_add_u32 v10, v10, 1, s47
    v_lshl_add_u32 v10, v3, 2, v10
    v_mul_u32_u24 v3, 192, v7
    v_add_u32 v10, v10, v3
    v_bfe_u32 v3, v1, 2, 2
    v_lshl_add_u32 v3, v7, 2, v3
    v_lshlrev_b32 v3, 6, v3
    v_and_b32 v4, 3, v1
    v_lshl_add_u32 v3, v4, 3, v3
    v_add_u32 v3, s21, v3
    v_and_b32 v4, 1, v7
    v_lshl_add_u32 v3, v4, 5, v3
    v_xor_b32 v4, 32, v3
    v_lshlrev_b32 v5, 12, v7
    v_lshl_add_u32 v5, v6, 4, v5
    s_lshl_b32 s7, s4, 8
    v_add_u32 v5, s7, v5
    v_lshrrev_b32 v11, 2, v1
    v_lshlrev_b32 v11, 18, v11
    v_and_b32 v9, 3, v1
    v_lshl_add_u32 v11, v9, 4, v11
    s_lshl_b32 s24, s40, 6
    s_add_u32 s24, s24, 4194304
    s_lshl_b32 s7, s4, 16
    s_add_u32 s24, s24, s7
    v_mov_b32 v150, 65537
    v_mov_b32 v155, s100
    s_mov_b32 s50, 0
    s_mov_b32 s51, 0
    s_add_u32 s81, s80, 32
L_hw_20:
    s_waitcnt vmcnt(0)
    s_mov_b64 exec, s[82:83]
    v_xor_b32 v166, s80, v166
    v_cmp_le_u32 vcc, 32, v166
    s_nop 0
    s_mov_b64 s[82:83], vcc
    s_cbranch_vccz L_ac_22
    s_mov_b64 exec, vcc
    v_mov_b32 v166, 1
    buffer_atomic_add v166, v165, s[16:19], s23 offen sc0 sc1
L_ac_22:
    s_mov_b64 exec, 3
    v_cmp_ne_u32 vcc, s81, v153
    s_add_u32 s51, s51, 1
    s_or_b64 vcc, vcc, s[82:83]
    s_cbranch_vccz L_hok_21
    s_cmp_gt_u32 s51, 100
    s_cbranch_scc1 L_hok_21
    s_sleep 1
    v_mov_b32 v153, 0
    buffer_atomic_add v153, v152, s[16:19], s26 offen sc0 sc1
    s_branch L_hw_20
L_hok_21:
    s_mov_b64 exec, -1
    s_mov_b32 m0, s21
    s_nop 0
    buffer_load_dwordx4 v2, s[16:19], s20 offen offset:0 sc1 lds
    buffer_load_dwordx4 v2, s[16:19], s20 offen offset:1024 sc1 lds
    buffer_load_dwordx4 v2, s[16:19], s20 offen offset:2048 sc1 lds
    buffer_load_dwordx4 v2, s[16:19], s20 offen offset:3072 sc1 lds
    s_barrier
    s_add_u32 s49, s47, 0
    s_mov_b32 m0, s49
    s_nop 0
    buffer_load_dwordx3 v156, s[28:31], s48 offen lds
    s_add_u32 s49, s47, 1024
    s_mov_b32 m0, s49
    s_nop 0
    buffer_load_dwordx3 v157, s[28:31], s48 offen lds
    s_add_u32 s49, s47, 2048
    s_mov_b32 m0, s49
    s_nop 0
    buffer_load_dwordx3 v158, s[28:31], s48 offen lds
    s_branch L_rx1b
L_rx1:
    s_mov_b32 m0, s21
    s_nop 0
    buffer_load_dwordx4 v2, s[16:19], s20 offen offset:0 sc1 lds
    buffer_load_dwordx4 v2, s[16:19], s20 offen offset:1024 sc1 lds
    buffer_load_dwordx4 v2, s[16:19], s20 offen offset:2048 sc1 lds
    buffer_load_dwordx4 v2, s[16:19], s20 offen offset:3072 sc1 lds
    s_waitcnt vmcnt(0)
L_rx1b:
    s_waitcnt vmcnt(6)
    ds_read_b64_tr_b16 v[76:77], v3 offset:0
    ds_read_b64_tr_b16 v[78:79], v4 offset:0
    s_waitcnt vmcnt(5)
    ds_read_b64_tr_b16 v[80:81], v3 offset:1024
    ds_read_b64_tr_b16 v[82:83], v4 offset:1024
    s_waitcnt vmcnt(4)
    ds_read_b64_tr_b16 v[84:85], v3 offset:2048
    ds_read_b64_tr_b16 v[86:87], v4 offset:2048
    s_waitcnt vmcnt(3)
    ds_read_b64_tr_b16 v[88:89], v3 offset:3072
    ds_read_b64_tr_b16 v[90:91], v4 offset:3072
    s_waitcnt lgkmcnt(6)
    v_xor_b32 v76, v155, v76
    v_xor_b32 v77, v155, v77
    v_xor_b32 v78, v155, v78
    v_xor_b32 v79, v155, v79
    v_and_b32 v151, v76, v77
    v_bitop3_b32 v151, v151, v78, v79 bitop3:0x80
    v_mfma_f32_16x16x32_bf16 v[92:95], v[14:17], v[76:79], 0
    v_mfma_f32_16x16x32_bf16 v[96:99], v[12:15], v[76:79], 0
    s_waitcnt lgkmcnt(4)
    v_xor_b32 v80, v155, v80
    v_xor_b32 v81, v155, v81
    v_xor_b32 v82, v155, v82
    v_xor_b32 v83, v155, v83
    v_bitop3_b32 v151, v151, v80, v81 bitop3:0x80
    v_bitop3_b32 v151, v151, v82, v83 bitop3:0x80
    v_mfma_f32_16x16x32_bf16 v[100:103], v[20:23], v[80:83], 0
    v_mfma_f32_16x16x32_bf16 v[104:107], v[18:21], v[80:83], 0
    s_waitcnt lgkmcnt(2)
    v_xor_b32 v84, v155, v84
    v_xor_b32 v85, v155, v85
    v_xor_b32 v86, v155, v86
    v_xor_b32 v87, v155, v87
    v_bitop3_b32 v151, v151, v84, v85 bitop3:0x80
    v_bitop3_b32 v151, v151, v86, v87 bitop3:0x80
    v_mfma_f32_16x16x32_bf16 v[108:111], v[26:29], v[84:87], 0
    v_mfma_f32_16x16x32_bf16 v[112:115], v[24:27], v[84:87], 0
    s_waitcnt lgkmcnt(0)
    v_xor_b32 v88, v155, v88
    v_xor_b32 v89, v155, v89
    v_xor_b32 v90, v155, v90
    v_xor_b32 v91, v155, v91
    v_bitop3_b32 v151, v151, v88, v89 bitop3:0x80
    v_bitop3_b32 v151, v151, v90, v91 bitop3:0x80
    v_mfma_f32_16x16x32_bf16 v[116:119], v[32:35], v[88:91], 0
    v_mfma_f32_16x16x32_bf16 v[120:123], v[30:33], v[88:91], 0
    v_and_b32 v151, 65537, v151
    v_cmp_ne_u32 vcc, 65537, v151
    s_add_u32 s50, s50, 1
    s_cbranch_vccz L_rxok_23
    s_sleep 4
    s_cmp_lt_u32 s50, 30000
    s_cbranch_scc1 L_rx1
L_rxok_23:
    s_add_u32 s49, s47, 3072
    s_mov_b32 m0, s49
    s_nop 0
    buffer_load_dwordx3 v156, s[32:35], s48 offen lds
    s_add_u32 s49, s47, 4096
    s_mov_b32 m0, s49
    s_nop 0
    buffer_load_dwordx3 v157, s[32:35], s48 offen lds
    s_add_u32 s49, s47, 5120
    s_mov_b32 m0, s49
    s_nop 0
    buffer_load_dwordx3 v158, s[32:35], s48 offen lds
    s_barrier
    v_cvt_pk_bf16_f32 v124, v92, v100
    v_cvt_pk_bf16_f32 v125, v108, v116
    v_cvt_pk_bf16_f32 v126, v96, v104
    v_cvt_pk_bf16_f32 v127, v112, v120
    ds_write_b128 v5, v[124:127] offset:0
    v_cvt_pk_bf16_f32 v128, v93, v101
    v_cvt_pk_bf16_f32 v129, v109, v117
    v_cvt_pk_bf16_f32 v130, v97, v105
    v_cvt_pk_bf16_f32 v131, v113, v121
    ds_write_b128 v5, v[128:131] offset:1024
    v_cvt_pk_bf16_f32 v132, v94, v102
    v_cvt_pk_bf16_f32 v133, v110, v118
    v_cvt_pk_bf16_f32 v134, v98, v106
    v_cvt_pk_bf16_f32 v135, v114, v122
    ds_write_b128 v5, v[132:135] offset:2048
    v_cvt_pk_bf16_f32 v136, v95, v103
    v_cvt_pk_bf16_f32 v137, v111, v119
    v_cvt_pk_bf16_f32 v138, v99, v107
    v_cvt_pk_bf16_f32 v139, v115, v123
    ds_write_b128 v5, v[136:139] offset:3072
    s_waitcnt lgkmcnt(0)
    s_barrier
    ds_read_b128 v[76:79], v8 offset:0
    ds_read_b128 v[80:83], v8 offset:1024
    ds_read_b128 v[84:87], v8 offset:2048
    ds_read_b128 v[88:91], v8 offset:3072
    s_waitcnt lgkmcnt(3)
    v_mfma_f32_16x16x32_bf16 v[92:95], v[38:41], v[76:79], 0
    v_mfma_f32_16x16x32_bf16 v[96:99], v[36:39], v[76:79], 0
    s_waitcnt lgkmcnt(2)
    v_mfma_f32_16x16x32_bf16 v[100:103], v[38:41], v[80:83], 0
    v_mfma_f32_16x16x32_bf16 v[104:107], v[36:39], v[80:83], 0
    s_waitcnt lgkmcnt(1)
    v_mfma_f32_16x16x32_bf16 v[108:111], v[38:41], v[84:87], 0
    v_mfma_f32_16x16x32_bf16 v[112:115], v[36:39], v[84:87], 0
    s_waitcnt lgkmcnt(0)
    v_mfma_f32_16x16x32_bf16 v[116:119], v[38:41], v[88:91], 0
    v_mfma_f32_16x16x32_bf16 v[120:123], v[36:39], v[88:91], 0
    s_barrier
    s_waitcnt vmcnt(0)
    ds_read_u16_d16_hi v44, v10 offset:0
    ds_read_u16_d16_hi v48, v10 offset:3072
    ds_read_u16_d16_hi v45, v10 offset:48
    ds_read_u16_d16_hi v49, v10 offset:3120
    ds_read_u16_d16_hi v46, v10 offset:96
    ds_read_u16_d16_hi v50, v10 offset:3168
    ds_read_u16_d16_hi v47, v10 offset:144
    ds_read_u16_d16_hi v51, v10 offset:3216
    ds_read_u16_d16_hi v52, v10 offset:768
    ds_read_u16_d16_hi v56, v10 offset:3840
    ds_read_u16_d16_hi v53, v10 offset:816
    ds_read_u16_d16_hi v57, v10 offset:3888
    ds_read_u16_d16_hi v54, v10 offset:864
    ds_read_u16_d16_hi v58, v10 offset:3936
    ds_read_u16_d16_hi v55, v10 offset:912
    ds_read_u16_d16_hi v59, v10 offset:3984
    ds_read_u16_d16_hi v60, v10 offset:1536
    ds_read_u16_d16_hi v64, v10 offset:4608
    ds_read_u16_d16_hi v61, v10 offset:1584
    ds_read_u16_d16_hi v65, v10 offset:4656
    ds_read_u16_d16_hi v62, v10 offset:1632
    ds_read_u16_d16_hi v66, v10 offset:4704
    ds_read_u16_d16_hi v63, v10 offset:1680
    ds_read_u16_d16_hi v67, v10 offset:4752
    ds_read_u16_d16_hi v68, v10 offset:2304
    ds_read_u16_d16_hi v72, v10 offset:5376
    ds_read_u16_d16_hi v69, v10 offset:2352
    ds_read_u16_d16_hi v73, v10 offset:5424
    ds_read_u16_d16_hi v70, v10 offset:2400
    ds_read_u16_d16_hi v74, v10 offset:5472
    ds_read_u16_d16_hi v71, v10 offset:2448
    ds_read_u16_d16_hi v75, v10 offset:5520
    s_waitcnt lgkmcnt(15)
    v_mul_f32 v140, v96, v48
    v_mul_f32 v142, v92, v48
    v_mul_f32 v141, v97, v49
    v_mul_f32 v143, v93, v49
    v_fma_f32 v140, v92, v44, -v140
    v_fmac_f32 v142, v96, v44
    v_fma_f32 v141, v93, v45, -v141
    v_fmac_f32 v143, v97, v45
    v_cvt_pk_bf16_f32 v126, v140, v141
    v_cvt_pk_bf16_f32 v124, v142, v143
    v_mul_f32 v144, v98, v50
    v_mul_f32 v146, v94, v50
    v_mul_f32 v145, v99, v51
    v_mul_f32 v147, v95, v51
    v_fma_f32 v144, v94, v46, -v144
    v_fmac_f32 v146, v98, v46
    v_fma_f32 v145, v95, v47, -v145
    v_fmac_f32 v147, v99, v47
    v_cvt_pk_bf16_f32 v127, v144, v145
    v_cvt_pk_bf16_f32 v125, v146, v147
    s_nop 1
    v_mfma_f32_16x16x32_bf16 v[92:95], v[12:15], v[124:127], 0
    v_mfma_f32_16x16x32_bf16 v[96:99], v[14:17], v[124:127], 0
    s_waitcnt lgkmcnt(15)
    v_mul_f32 v140, v104, v56
    v_mul_f32 v142, v100, v56
    v_mul_f32 v141, v105, v57
    v_mul_f32 v143, v101, v57
    v_fma_f32 v140, v100, v52, -v140
    v_fmac_f32 v142, v104, v52
    v_fma_f32 v141, v101, v53, -v141
    v_fmac_f32 v143, v105, v53
    v_cvt_pk_bf16_f32 v130, v140, v141
    v_cvt_pk_bf16_f32 v128, v142, v143
    v_mul_f32 v144, v106, v58
    v_mul_f32 v146, v102, v58
    v_mul_f32 v145, v107, v59
    v_mul_f32 v147, v103, v59
    v_fma_f32 v144, v102, v54, -v144
    v_fmac_f32 v146, v106, v54
    v_fma_f32 v145, v103, v55, -v145
    v_fmac_f32 v147, v107, v55
    v_cvt_pk_bf16_f32 v131, v144, v145
    v_cvt_pk_bf16_f32 v129, v146, v147
    s_nop 1
    v_mfma_f32_16x16x32_bf16 v[100:103], v[18:21], v[128:131], 0
    v_mfma_f32_16x16x32_bf16 v[104:107], v[20:23], v[128:131], 0
    s_waitcnt lgkmcnt(8)
    v_mul_f32 v140, v112, v64
    v_mul_f32 v142, v108, v64
    v_mul_f32 v141, v113, v65
    v_mul_f32 v143, v109, v65
    v_fma_f32 v140, v108, v60, -v140
    v_fmac_f32 v142, v112, v60
    v_fma_f32 v141, v109, v61, -v141
    v_fmac_f32 v143, v113, v61
    v_cvt_pk_bf16_f32 v134, v140, v141
    v_cvt_pk_bf16_f32 v132, v142, v143
    v_mul_f32 v144, v114, v66
    v_mul_f32 v146, v110, v66
    v_mul_f32 v145, v115, v67
    v_mul_f32 v147, v111, v67
    v_fma_f32 v144, v110, v62, -v144
    v_fmac_f32 v146, v114, v62
    v_fma_f32 v145, v111, v63, -v145
    v_fmac_f32 v147, v115, v63
    v_cvt_pk_bf16_f32 v135, v144, v145
    v_cvt_pk_bf16_f32 v133, v146, v147
    s_nop 1
    v_mfma_f32_16x16x32_bf16 v[108:111], v[24:27], v[132:135], 0
    v_mfma_f32_16x16x32_bf16 v[112:115], v[26:29], v[132:135], 0
    s_waitcnt lgkmcnt(0)
    v_mul_f32 v140, v120, v72
    v_mul_f32 v142, v116, v72
    v_mul_f32 v141, v121, v73
    v_mul_f32 v143, v117, v73
    v_fma_f32 v140, v116, v68, -v140
    v_fmac_f32 v142, v120, v68
    v_fma_f32 v141, v117, v69, -v141
    v_fmac_f32 v143, v121, v69
    v_cvt_pk_bf16_f32 v138, v140, v141
    v_cvt_pk_bf16_f32 v136, v142, v143
    v_mul_f32 v144, v122, v74
    v_mul_f32 v146, v118, v74
    v_mul_f32 v145, v123, v75
    v_mul_f32 v147, v119, v75
    v_fma_f32 v144, v118, v70, -v144
    v_fmac_f32 v146, v122, v70
    v_fma_f32 v145, v119, v71, -v145
    v_fmac_f32 v147, v123, v71
    v_cvt_pk_bf16_f32 v139, v144, v145
    v_cvt_pk_bf16_f32 v137, v146, v147
    s_nop 1
    v_mfma_f32_16x16x32_bf16 v[116:119], v[30:33], v[136:139], 0
    v_mfma_f32_16x16x32_bf16 v[120:123], v[32:35], v[136:139], 0
    v_cvt_pk_bf16_f32 v124, v96, v104
    s_nop 6
    v_cvt_pk_bf16_f32 v125, v112, v120
    v_cvt_pk_bf16_f32 v126, v92, v100
    v_cvt_pk_bf16_f32 v127, v108, v116
    ds_write_b128 v5, v[124:127] offset:0
    v_cvt_pk_bf16_f32 v128, v97, v105
    v_cvt_pk_bf16_f32 v129, v113, v121
    v_cvt_pk_bf16_f32 v130, v93, v101
    v_cvt_pk_bf16_f32 v131, v109, v117
    ds_write_b128 v5, v[128:131] offset:1024
    v_cvt_pk_bf16_f32 v132, v98, v106
    v_cvt_pk_bf16_f32 v133, v114, v122
    v_cvt_pk_bf16_f32 v134, v94, v102
    v_cvt_pk_bf16_f32 v135, v110, v118
    ds_write_b128 v5, v[132:135] offset:2048
    v_cvt_pk_bf16_f32 v136, v99, v107
    v_cvt_pk_bf16_f32 v137, v115, v123
    v_cvt_pk_bf16_f32 v138, v95, v103
    v_cvt_pk_bf16_f32 v139, v111, v119
    ds_write_b128 v5, v[136:139] offset:3072
    s_waitcnt lgkmcnt(0)
    s_barrier
    ds_read_b128 v[76:79], v8 offset:0
    ds_read_b128 v[80:83], v8 offset:1024
    ds_read_b128 v[84:87], v8 offset:2048
    ds_read_b128 v[88:91], v8 offset:3072
    s_mov_b32 m0, s25
    s_add_u32 s27, s21, 25600
    buffer_load_dwordx4 v2, s[12:15], s27 offen offset:0 lds
    buffer_load_dwordx4 v2, s[12:15], s27 offen offset:1024 lds
    buffer_load_dwordx4 v2, s[12:15], s27 offen offset:2048 lds
    buffer_load_dwordx4 v2, s[12:15], s27 offen offset:3072 lds
    v_bfe_u32 v4, v1, 1, 2
    v_xor_b32 v4, v4, v7
    v_lshl_add_u32 v3, v6, 6, s21
    v_lshl_add_u32 v3, v4, 4, v3
    v_bfe_u32 v4, v1, 3, 2
    v_xor_b32 v4, v4, v1
    v_lshl_add_u32 v4, v4, 4, s21
    s_lshr_b32 s45, s40, 5
    s_lshl_b32 s45, s45, 7
    s_add_u32 s45, s45, 16908288
    s_waitcnt lgkmcnt(3)
    v_mfma_f32_16x16x32_bf16 v[92:95], v[76:79], v[36:39], 0
    v_mfma_f32_16x16x32_bf16 v[96:99], v[76:79], v[38:41], 0
    s_waitcnt lgkmcnt(2)
    v_mfma_f32_16x16x32_bf16 v[100:103], v[80:83], v[36:39], 0
    v_mfma_f32_16x16x32_bf16 v[104:107], v[80:83], v[38:41], 0
    s_waitcnt lgkmcnt(1)
    v_mfma_f32_16x16x32_bf16 v[108:111], v[84:87], v[36:39], 0
    v_mfma_f32_16x16x32_bf16 v[112:115], v[84:87], v[38:41], 0
    s_waitcnt lgkmcnt(0)
    v_mfma_f32_16x16x32_bf16 v[116:119], v[88:91], v[36:39], 0
    v_mfma_f32_16x16x32_bf16 v[120:123], v[88:91], v[38:41], 0
    v_perm_b32 v124, v93, v92, s101
    v_bfi_b32 v124, v150, s99, v124
    v_perm_b32 v125, v95, v94, s101
    v_bfi_b32 v125, v150, s99, v125
    v_perm_b32 v126, v97, v96, s101
    v_bfi_b32 v126, v150, s99, v126
    v_perm_b32 v127, v99, v98, s101
    v_bfi_b32 v127, v150, s99, v127
    ds_write_b128 v3, v[124:127] offset:16384
    ds_read_b128 v[76:79], v4 offset:16384
    v_perm_b32 v128, v101, v100, s101
    v_bfi_b32 v128, v150, s99, v128
    v_perm_b32 v129, v103, v102, s101
    v_bfi_b32 v129, v150, s99, v129
    v_perm_b32 v130, v105, v104, s101
    v_bfi_b32 v130, v150, s99, v130
    v_perm_b32 v131, v107, v106, s101
    v_bfi_b32 v131, v150, s99, v131
    ds_write_b128 v3, v[128:131] offset:17408
    ds_read_b128 v[80:83], v4 offset:17408
    v_perm_b32 v132, v109, v108, s101
    v_bfi_b32 v132, v150, s99, v132
    v_perm_b32 v133, v111, v110, s101
    v_bfi_b32 v133, v150, s99, v133
    v_perm_b32 v134, v113, v112, s101
    v_bfi_b32 v134, v150, s99, v134
    v_perm_b32 v135, v115, v114, s101
    v_bfi_b32 v135, v150, s99, v135
    ds_write_b128 v3, v[132:135] offset:18432
    ds_read_b128 v[84:87], v4 offset:18432
    v_perm_b32 v136, v117, v116, s101
    v_bfi_b32 v136, v150, s99, v136
    v_perm_b32 v137, v119, v118, s101
    v_bfi_b32 v137, v150, s99, v137
    v_perm_b32 v138, v121, v120, s101
    v_bfi_b32 v138, v150, s99, v138
    v_perm_b32 v139, v123, v122, s101
    v_bfi_b32 v139, v150, s99, v139
    ds_write_b128 v3, v[136:139] offset:19456
    ds_read_b128 v[88:91], v4 offset:19456
    s_waitcnt lgkmcnt(6)
    buffer_store_dwordx4 v[76:79], v11, s[16:19], s24 offen sc1
    s_waitcnt lgkmcnt(4)
    s_add_u32 s24, s24, 16384
    buffer_store_dwordx4 v[80:83], v11, s[16:19], s24 offen sc1
    s_waitcnt lgkmcnt(2)
    s_add_u32 s24, s24, 16384
    buffer_store_dwordx4 v[84:87], v11, s[16:19], s24 offen sc1
    s_waitcnt lgkmcnt(0)
    s_add_u32 s24, s24, 16384
    buffer_store_dwordx4 v[88:91], v11, s[16:19], s24 offen sc1
    s_mul_i32 s7, s4, 4608
    s_add_u32 s45, s45, s7
    v_mul_u32_u24 v152, 1152, v1
    v_mov_b32 v153, 1
    s_mov_b32 s82, 15
    s_mov_b64 exec, s[82:83]
    buffer_atomic_add v153, v152, s[16:19], s45 offen sc0 sc1
    s_mov_b64 exec, -1
L_hs_24:
    s_waitcnt vmcnt(5)
    s_barrier
    v_lshlrev_b32 v2, 4, v1
    s_lshl_b32 s5, s4, 12
    s_lshl_b32 s6, s40, 14
    s_add_u32 s6, s6, 4194304
    s_add_u32 s23, s6, s5
    ds_read_b128 v[16:19], v2 offset:36864
    ds_read_b128 v[20:23], v2 offset:37888
    ds_read_b128 v[24:27], v2 offset:38912
    ds_read_b128 v[28:31], v2 offset:39936
    ds_read_b128 v[32:35], v2 offset:40960
    ds_read_b128 v[36:39], v2 offset:41984
    ds_read_b128 v[40:43], v2 offset:43008
    ds_read_b128 v[44:47], v2 offset:44032
    ds_read_b128 v[48:51], v2 offset:45056
    ds_read_b128 v[52:55], v2 offset:46080
    ds_read_b128 v[56:59], v2 offset:47104
    ds_read_b128 v[60:63], v2 offset:48128
    ds_read_b128 v[64:67], v2 offset:49152
    ds_read_b128 v[68:71], v2 offset:50176
    ds_read_b128 v[72:75], v2 offset:51200
    ds_read_b128 v[76:79], v2 offset:52224
    v_lshrrev_b32 v7, 4, v1
    v_bfe_u32 v3, v1, 1, 3
    v_lshlrev_b32 v3, 8, v3
    v_add_u32 v3, s40, v3
    v_cvt_f32_u32 v10, v3
    v_mul_f32 v10, 0x3a000000, v10
    v_and_b32 v3, 1, v7
    v_and_b32 v4, 1, v1
    v_sub_u32 v3, v3, v4
    v_cvt_f32_i32 v3, v3
    v_mul_f32 v3, 0x3e800000, v3
    v_lshrrev_b32 v4, 5, v1
    v_cvt_f32_u32 v9, v4
    v_mul_f32 v11, v10, v9
    v_fma_f32 v11, v11, 4.0, v3
    v_cos_f32 v104, v11
    v_fmamk_f32 v101, v10, 0x3f800000, v11
    v_cos_f32 v105, v101
    v_fmamk_f32 v102, v10, 0x40000000, v11
    v_cos_f32 v106, v102
    v_fmamk_f32 v103, v10, 0x40400000, v11
    v_cos_f32 v107, v103
    v_cvt_pk_bf16_f32 v12, v104, v105
    v_cvt_pk_bf16_f32 v13, v106, v107
    v_bfe_u32 v3, v1, 2, 2
    v_lshl_add_u32 v3, v4, 2, v3
    v_lshlrev_b32 v3, 6, v3
    v_and_b32 v5, 3, v1
    v_lshl_add_u32 v3, v5, 4, v3
    v_and_b32 v5, 1, v7
    v_lshl_add_u32 v3, v5, 3, v3
    s_lshl_b32 s7, s4, 9
    v_add_u32 v5, s5, v3
    s_and_b32 s27, s2, 15
    s_mul_i32 s27, s27, 1152
    s_add_u32 s27, s27, 16908288
    s_lshl_b32 s26, s4, 8
    v_lshl_add_u32 v156, v1, 7, s26
    s_mov_b64 exec, 3
    v_mov_b32 v157, 0
    buffer_atomic_add v157, v156, s[16:19], s27 offen sc0 sc1
    s_mov_b64 exec, -1
    v_and_b32 v6, 31, v1
    v_and_b32 v8, 1, v1
    v_cvt_f32_u32 v8, v8
    v_fma_f32 v8, v8, -2.0, 1.0
    v_sub_f32 v9, 1.0, v9
    v_mul_f32 v8, v8, v9
    v_and_b32 v10, 15, v1
    v_lshlrev_b32 v10, 4, v10
    v_lshl_add_u32 v10, v7, 12, v10
    v_add_u32 v10, s7, v10
    v_add_u32 v11, s5, v2
    s_add_u32 s22, s5, 17408
    v_bfe_u32 v7, v1, 1, 2
    v_lshlrev_b32 v4, 1, v4
    v_xor_b32 v7, v7, v4
    v_lshl_add_u32 v6, v6, 6, s22
    v_lshl_add_u32 v6, v7, 4, v6
    v_xor_b32 v7, 16, v6
    v_bfe_u32 v4, v1, 3, 2
    v_lshlrev_b32 v4, 4, v4
    v_xor_b32 v4, v4, v2
    v_add_u32 v4, s22, v4
    s_lshl_b32 s20, s40, 12
    s_lshl_b32 s21, s4, 21
    s_add_u32 s20, s20, s21
    s_add_u32 s21, s20, 1048576
    s_lshl_b32 s22, s4, 9
    s_add_u32 s22, s22, s40
    v_bfe_u32 v9, v1, 3, 1
    v_lshl_add_u32 v9, v9, 8, s22
    v_and_b32 v3, 7, v1
    v_mul_u32_u24 v9, v9, v3
    v_cvt_f32_u32 v9, v9
    v_mul_f32 v9, 0x3a000000, v9
    v_cos_f32 v14, v9
    v_sin_f32 v15, v9
    v_lshlrev_b32 v3, 11, v3
    v_cvt_pk_bf16_f32 v9, v14, -v15
    v_mov_b32 v162, s100
    s_lshl_b32 s26, s40, 3
    s_add_u32 s26, s26, 17301504
    s_waitcnt lgkmcnt(0)
    s_mov_b32 m0, s5
    s_mov_b32 s50, 0
    s_mov_b32 s51, 0
    s_add_u32 s81, s80, 32
L_hw_25:
    s_waitcnt vmcnt(0)
    s_mov_b64 exec, s[82:83]
    v_xor_b32 v153, s80, v153
    v_cmp_le_u32 vcc, 32, v153
    s_nop 0
    s_mov_b64 s[82:83], vcc
    s_cbranch_vccz L_ac_27
    s_mov_b64 exec, vcc
    v_mov_b32 v153, 1
    buffer_atomic_add v153, v152, s[16:19], s45 offen sc0 sc1
L_ac_27:
    s_mov_b64 exec, 3
    v_cmp_ne_u32 vcc, s81, v157
    s_add_u32 s51, s51, 1
    s_or_b64 vcc, vcc, s[82:83]
    s_cbranch_vccz L_hok_26
    s_cmp_gt_u32 s51, 100
    s_cbranch_scc1 L_hok_26
    s_sleep 1
    v_mov_b32 v157, 0
    buffer_atomic_add v157, v156, s[16:19], s27 offen sc0 sc1
    s_branch L_hw_25
L_hok_26:
    s_mov_b64 exec, -1
L_rx2:
    buffer_load_dwordx4 v2, s[16:19], s23 offen offset:0 sc1 lds
    buffer_load_dwordx4 v2, s[16:19], s23 offen offset:1024 sc1 lds
    buffer_load_dwordx4 v2, s[16:19], s23 offen offset:2048 sc1 lds
    buffer_load_dwordx4 v2, s[16:19], s23 offen offset:3072 sc1 lds
    s_waitcnt vmcnt(3)
    ds_read_b64_tr_b16 v[80:81], v5 offset:0
    ds_read_b64_tr_b16 v[82:83], v5 offset:512
    s_waitcnt vmcnt(2)
    ds_read_b64_tr_b16 v[84:85], v5 offset:1024
    ds_read_b64_tr_b16 v[86:87], v5 offset:1536
    s_waitcnt vmcnt(1)
    ds_read_b64_tr_b16 v[88:89], v5 offset:2048
    ds_read_b64_tr_b16 v[90:91], v5 offset:2560
    s_waitcnt vmcnt(0)
    ds_read_b64_tr_b16 v[92:93], v5 offset:3072
    ds_read_b64_tr_b16 v[94:95], v5 offset:3584
    s_waitcnt lgkmcnt(6)
    v_xor_b32 v80, v162, v80
    v_xor_b32 v81, v162, v81
    v_xor_b32 v82, v162, v82
    v_xor_b32 v83, v162, v83
    v_and_b32 v160, v80, v81
    v_bitop3_b32 v160, v160, v82, v83 bitop3:0x80
    v_mfma_f32_16x16x16_bf16 v[100:103], v[12:13], v[80:81], 0
    v_mfma_f32_16x16x16_bf16 v[116:119], v[12:13], v[82:83], 0
    s_waitcnt lgkmcnt(4)
    v_xor_b32 v84, v162, v84
    v_xor_b32 v85, v162, v85
    v_xor_b32 v86, v162, v86
    v_xor_b32 v87, v162, v87
    v_bitop3_b32 v160, v160, v84, v85 bitop3:0x80
    v_bitop3_b32 v160, v160, v86, v87 bitop3:0x80
    v_mfma_f32_16x16x16_bf16 v[104:107], v[12:13], v[84:85], 0
    v_mfma_f32_16x16x16_bf16 v[120:123], v[12:13], v[86:87], 0
    s_waitcnt lgkmcnt(2)
    v_xor_b32 v88, v162, v88
    v_xor_b32 v89, v162, v89
    v_xor_b32 v90, v162, v90
    v_xor_b32 v91, v162, v91
    v_bitop3_b32 v160, v160, v88, v89 bitop3:0x80
    v_bitop3_b32 v160, v160, v90, v91 bitop3:0x80
    v_mfma_f32_16x16x16_bf16 v[108:111], v[12:13], v[88:89], 0
    v_mfma_f32_16x16x16_bf16 v[124:127], v[12:13], v[90:91], 0
    s_waitcnt lgkmcnt(0)
    v_xor_b32 v92, v162, v92
    v_xor_b32 v93, v162, v93
    v_xor_b32 v94, v162, v94
    v_xor_b32 v95, v162, v95
    v_bitop3_b32 v160, v160, v92, v93 bitop3:0x80
    v_bitop3_b32 v160, v160, v94, v95 bitop3:0x80
    v_mfma_f32_16x16x16_bf16 v[112:115], v[12:13], v[92:93], 0
    v_mfma_f32_16x16x16_bf16 v[128:131], v[12:13], v[94:95], 0
    v_and_b32 v160, 65537, v160
    v_cmp_ne_u32 vcc, 65537, v160
    s_add_u32 s50, s50, 1
    s_cbranch_vccz L_rxok_28
    s_sleep 4
    s_cmp_lt_u32 s50, 30000
    s_cbranch_scc1 L_rx2
L_rxok_28:
    buffer_load_dwordx2 v[14:15], v3, s[16:19], s26 offen sc1
    v_cvt_pk_bf16_f32 v136, v100, v101
    v_cvt_pk_bf16_f32 v137, v104, v105
    v_cvt_pk_bf16_f32 v138, v108, v109
    v_cvt_pk_bf16_f32 v139, v112, v113
    ds_write_b128 v10, v[136:139] offset:17408
    v_cvt_pk_bf16_f32 v140, v102, v103
    v_cvt_pk_bf16_f32 v141, v106, v107
    v_cvt_pk_bf16_f32 v142, v110, v111
    v_cvt_pk_bf16_f32 v143, v114, v115
    ds_write_b128 v10, v[140:143] offset:19456
    v_cvt_pk_bf16_f32 v144, v116, v117
    v_cvt_pk_bf16_f32 v145, v120, v121
    v_cvt_pk_bf16_f32 v146, v124, v125
    v_cvt_pk_bf16_f32 v147, v128, v129
    ds_write_b128 v10, v[144:147] offset:17664
    v_cvt_pk_bf16_f32 v148, v118, v119
    v_cvt_pk_bf16_f32 v149, v122, v123
    v_cvt_pk_bf16_f32 v150, v126, v127
    v_cvt_pk_bf16_f32 v151, v130, v131
    ds_write_b128 v10, v[148:151] offset:19712
    s_waitcnt lgkmcnt(0)
    s_barrier
    ds_read_b128 v[80:83], v11 offset:17408
    ds_read_b128 v[84:87], v11 offset:18432
    ds_read_b128 v[88:91], v11 offset:19456
    ds_read_b128 v[92:95], v11 offset:20480
    s_waitcnt lgkmcnt(3)
    v_mfma_f32_32x32x16_bf16 v[100:115], v[80:83], v[16:19], 0
    v_mfma_f32_32x32x16_bf16 v[116:131], v[80:83], v[20:23], 0
    s_waitcnt lgkmcnt(2)
    v_mfma_f32_32x32x16_bf16 v[100:115], v[84:87], v[24:27], v[100:115]
    v_mfma_f32_32x32x16_bf16 v[116:131], v[84:87], v[28:31], v[116:131]
    s_waitcnt lgkmcnt(1)
    v_mfma_f32_32x32x16_bf16 v[132:147], v[88:91], v[16:19], 0
    v_mfma_f32_32x32x16_bf16 v[148:163], v[88:91], v[20:23], 0
    s_waitcnt lgkmcnt(0)
    v_mfma_f32_32x32x16_bf16 v[132:147], v[92:95], v[24:27], v[132:147]
    v_mfma_f32_32x32x16_bf16 v[148:163], v[92:95], v[28:31], v[148:163]
    s_nop 5
    v_pk_mul_f32 v[96:97], v[118:119], v[50:51]
    v_pk_mul_f32 v[98:99], v[102:103], v[50:51]
    v_pk_fma_f32 v[96:97], v[102:103], v[34:35], v[96:97] neg_lo:[0,0,1] neg_hi:[0,0,1]
    v_pk_fma_f32 v[98:99], v[118:119], v[34:35], v[98:99]
    v_cvt_pk_bf16_f32 v81, v96, v97
    v_cvt_pk_bf16_f32 v89, v98, v99
    v_pk_mul_f32 v[164:165], v[120:121], v[52:53]
    v_pk_mul_f32 v[166:167], v[104:105], v[52:53]
    v_pk_fma_f32 v[164:165], v[104:105], v[36:37], v[164:165] neg_lo:[0,0,1] neg_hi:[0,0,1]
    v_pk_fma_f32 v[166:167], v[120:121], v[36:37], v[166:167]
    v_cvt_pk_bf16_f32 v82, v164, v165
    v_cvt_pk_bf16_f32 v90, v166, v167
    v_pk_mul_f32 v[96:97], v[122:123], v[54:55]
    v_pk_mul_f32 v[98:99], v[106:107], v[54:55]
    v_pk_fma_f32 v[96:97], v[106:107], v[38:39], v[96:97] neg_lo:[0,0,1] neg_hi:[0,0,1]
    v_pk_fma_f32 v[98:99], v[122:123], v[38:39], v[98:99]
    v_cvt_pk_bf16_f32 v83, v96, v97
    v_cvt_pk_bf16_f32 v91, v98, v99
    v_pk_mul_f32 v[164:165], v[124:125], v[56:57]
    v_pk_mul_f32 v[166:167], v[108:109], v[56:57]
    v_pk_fma_f32 v[164:165], v[108:109], v[40:41], v[164:165] neg_lo:[0,0,1] neg_hi:[0,0,1]
    v_pk_fma_f32 v[166:167], v[124:125], v[40:41], v[166:167]
    v_cvt_pk_bf16_f32 v84, v164, v165
    v_cvt_pk_bf16_f32 v92, v166, v167
    v_pk_mul_f32 v[96:97], v[126:127], v[58:59]
    v_pk_mul_f32 v[98:99], v[110:111], v[58:59]
    v_pk_fma_f32 v[96:97], v[110:111], v[42:43], v[96:97] neg_lo:[0,0,1] neg_hi:[0,0,1]
    v_pk_fma_f32 v[98:99], v[126:127], v[42:43], v[98:99]
    v_cvt_pk_bf16_f32 v85, v96, v97
    v_cvt_pk_bf16_f32 v93, v98, v99
    v_pk_mul_f32 v[164:165], v[128:129], v[60:61]
    v_pk_mul_f32 v[166:167], v[112:113], v[60:61]
    v_pk_fma_f32 v[164:165], v[112:113], v[44:45], v[164:165] neg_lo:[0,0,1] neg_hi:[0,0,1]
    v_pk_fma_f32 v[166:167], v[128:129], v[44:45], v[166:167]
    v_cvt_pk_bf16_f32 v86, v164, v165
    v_cvt_pk_bf16_f32 v94, v166, v167
    v_pk_mul_f32 v[96:97], v[130:131], v[62:63]
    v_pk_mul_f32 v[98:99], v[114:115], v[62:63]
    v_pk_fma_f32 v[96:97], v[114:115], v[46:47], v[96:97] neg_lo:[0,0,1] neg_hi:[0,0,1]
    v_pk_fma_f32 v[98:99], v[130:131], v[46:47], v[98:99]
    v_cvt_pk_bf16_f32 v87, v96, v97
    v_cvt_pk_bf16_f32 v95, v98, v99
    s_mov_b32 s50, 0
    s_branch L_rx5b
L_rx5:
    buffer_load_dwordx2 v[14:15], v3, s[16:19], s26 offen sc1
L_rx5b:
    s_waitcnt vmcnt(0)
    v_cmp_ne_u32 vcc, s98, v15
    v_dot2_f32_bf16 v14, v14, v9, 0
    s_add_u32 s50, s50, 1
    s_cbranch_vccz L_rx5ok
    s_sleep 2
    s_cmp_lt_u32 s50, 30000
    s_cbranch_scc1 L_rx5
L_rx5ok:
    s_nop 1
    v_add_f32 v14, v14, v14 quad_perm:[1,0,3,2] row_mask:0xf bank_mask:0xf
    s_nop 1
    v_add_f32 v14, v14, v14 quad_perm:[2,3,0,1] row_mask:0xf bank_mask:0xf
    s_nop 1
    v_add_f32 v14, v14, v14 row_half_mirror row_mask:0xf bank_mask:0xf
    s_nop 0
    v_readlane_b32 s24, v14, 0
    v_readlane_b32 s25, v14, 8
    s_or_b32 s26, s40, s4
    s_mov_b32 s27, 16777216
    s_cmp_lg_u32 s26, 0
    s_cbranch_scc1 L_ep_29
    v_mov_b32 v10, 0
    v_mov_b32 v11, s98
    buffer_store_dword v11, v10, s[16:19], s27 offen sc1
L_ep_29:
    v_fmac_f32 v100, s24, v8
    v_pk_mul_f32 v[164:165], v[116:117], v[48:49]
    v_pk_mul_f32 v[166:167], v[100:101], v[48:49]
    v_pk_fma_f32 v[164:165], v[100:101], v[32:33], v[164:165] neg_lo:[0,0,1] neg_hi:[0,0,1]
    v_pk_fma_f32 v[166:167], v[116:117], v[32:33], v[166:167]
    v_cvt_pk_bf16_f32 v80, v164, v165
    v_cvt_pk_bf16_f32 v88, v166, v167
    s_nop 0
    v_mfma_f32_32x32x16_bf16 v[100:115], v[80:83], v[64:67], 0
    v_mfma_f32_32x32x16_bf16 v[100:115], v[84:87], v[68:71], v[100:115]
    v_mfma_f32_32x32x16_bf16 v[100:115], v[88:91], v[72:75], v[100:115]
    v_mfma_f32_32x32x16_bf16 v[100:115], v[92:95], v[76:79], v[100:115]
    v_fmac_f32 v132, s25, v8
    v_pk_mul_f32 v[164:165], v[148:149], v[48:49]
    v_pk_mul_f32 v[166:167], v[132:133], v[48:49]
    v_pk_fma_f32 v[164:165], v[132:133], v[32:33], v[164:165] neg_lo:[0,0,1] neg_hi:[0,0,1]
    v_pk_fma_f32 v[166:167], v[148:149], v[32:33], v[166:167]
    v_cvt_pk_bf16_f32 v16, v164, v165
    v_cvt_pk_bf16_f32 v24, v166, v167
    v_pk_mul_f32 v[96:97], v[150:151], v[50:51]
    v_pk_mul_f32 v[98:99], v[134:135], v[50:51]
    v_pk_fma_f32 v[96:97], v[134:135], v[34:35], v[96:97] neg_lo:[0,0,1] neg_hi:[0,0,1]
    v_pk_fma_f32 v[98:99], v[150:151], v[34:35], v[98:99]
    v_cvt_pk_bf16_f32 v17, v96, v97
    v_cvt_pk_bf16_f32 v25, v98, v99
    v_pk_mul_f32 v[164:165], v[152:153], v[52:53]
    v_pk_mul_f32 v[166:167], v[136:137], v[52:53]
    v_pk_fma_f32 v[164:165], v[136:137], v[36:37], v[164:165] neg_lo:[0,0,1] neg_hi:[0,0,1]
    v_pk_fma_f32 v[166:167], v[152:153], v[36:37], v[166:167]
    v_cvt_pk_bf16_f32 v18, v164, v165
    v_cvt_pk_bf16_f32 v26, v166, v167
    v_pk_mul_f32 v[96:97], v[154:155], v[54:55]
    v_pk_mul_f32 v[98:99], v[138:139], v[54:55]
    v_pk_fma_f32 v[96:97], v[138:139], v[38:39], v[96:97] neg_lo:[0,0,1] neg_hi:[0,0,1]
    v_pk_fma_f32 v[98:99], v[154:155], v[38:39], v[98:99]
    v_cvt_pk_bf16_f32 v19, v96, v97
    v_cvt_pk_bf16_f32 v27, v98, v99
    v_pk_mul_f32 v[164:165], v[156:157], v[56:57]
    v_pk_mul_f32 v[166:167], v[140:141], v[56:57]
    v_pk_fma_f32 v[164:165], v[140:141], v[40:41], v[164:165] neg_lo:[0,0,1] neg_hi:[0,0,1]
    v_pk_fma_f32 v[166:167], v[156:157], v[40:41], v[166:167]
    v_cvt_pk_bf16_f32 v20, v164, v165
    v_cvt_pk_bf16_f32 v28, v166, v167
    v_pk_mul_f32 v[96:97], v[158:159], v[58:59]
    v_pk_mul_f32 v[98:99], v[142:143], v[58:59]
    v_pk_fma_f32 v[96:97], v[142:143], v[42:43], v[96:97] neg_lo:[0,0,1] neg_hi:[0,0,1]
    v_pk_fma_f32 v[98:99], v[158:159], v[42:43], v[98:99]
    v_cvt_pk_bf16_f32 v21, v96, v97
    v_cvt_pk_bf16_f32 v29, v98, v99
    v_pk_mul_f32 v[164:165], v[160:161], v[60:61]
    v_pk_mul_f32 v[166:167], v[144:145], v[60:61]
    v_pk_fma_f32 v[164:165], v[144:145], v[44:45], v[164:165] neg_lo:[0,0,1] neg_hi:[0,0,1]
    v_pk_fma_f32 v[166:167], v[160:161], v[44:45], v[166:167]
    v_cvt_pk_bf16_f32 v22, v164, v165
    v_cvt_pk_bf16_f32 v30, v166, v167
    v_pk_mul_f32 v[96:97], v[162:163], v[62:63]
    v_pk_mul_f32 v[98:99], v[146:147], v[62:63]
    v_pk_fma_f32 v[96:97], v[146:147], v[46:47], v[96:97] neg_lo:[0,0,1] neg_hi:[0,0,1]
    v_pk_fma_f32 v[98:99], v[162:163], v[46:47], v[98:99]
    v_cvt_pk_bf16_f32 v23, v96, v97
    v_cvt_pk_bf16_f32 v31, v98, v99
    v_mfma_f32_32x32x16_bf16 v[132:147], v[16:19], v[64:67], 0
    v_mfma_f32_32x32x16_bf16 v[132:147], v[20:23], v[68:71], v[132:147]
    v_mfma_f32_32x32x16_bf16 v[132:147], v[24:27], v[72:75], v[132:147]
    v_mfma_f32_32x32x16_bf16 v[132:147], v[28:31], v[76:79], v[132:147]
    v_cvt_pk_bf16_f32 v116, v100, v101
    v_cvt_pk_bf16_f32 v117, v102, v103
    v_cvt_pk_bf16_f32 v118, v104, v105
    v_cvt_pk_bf16_f32 v119, v106, v107
    v_cvt_pk_bf16_f32 v120, v108, v109
    v_cvt_pk_bf16_f32 v121, v110, v111
    v_cvt_pk_bf16_f32 v122, v112, v113
    v_cvt_pk_bf16_f32 v123, v114, v115
    ds_write_b128 v6, v[116:119] offset:0
    ds_write_b128 v7, v[120:123] offset:0
    ds_read_b128 v[124:127], v4 offset:0
    ds_read_b128 v[128:131], v4 offset:1024
    s_waitcnt lgkmcnt(1)
    buffer_store_dwordx4 v[124:127], v2, s[36:39], s20 offen offset:2048 sc1
    s_waitcnt lgkmcnt(0)
    buffer_store_dwordx4 v[128:131], v2, s[36:39], s20 offen offset:3072 sc1
    v_cvt_pk_bf16_f32 v148, v132, v133
    v_cvt_pk_bf16_f32 v149, v134, v135
    v_cvt_pk_bf16_f32 v150, v136, v137
    v_cvt_pk_bf16_f32 v151, v138, v139
    v_cvt_pk_bf16_f32 v152, v140, v141
    v_cvt_pk_bf16_f32 v153, v142, v143
    v_cvt_pk_bf16_f32 v154, v144, v145
    v_cvt_pk_bf16_f32 v155, v146, v147
    ds_write_b128 v6, v[148:151] offset:2048
    ds_write_b128 v7, v[152:155] offset:2048
    ds_read_b128 v[156:159], v4 offset:2048
    ds_read_b128 v[160:163], v4 offset:3072
    s_waitcnt lgkmcnt(1)
    buffer_store_dwordx4 v[156:159], v2, s[36:39], s21 offen offset:2048 sc1
    s_waitcnt lgkmcnt(0)
    buffer_store_dwordx4 v[160:163], v2, s[36:39], s21 offen offset:3072 sc1
    s_endpgm
L_typeN0:
    s_cmp_lt_u32 s2, 776
    s_cbranch_scc0 L_code_end
L_typeN:
    s_and_b32 s2, s2, 7
    s_mov_b32 s50, 16777216
    s_waitcnt lgkmcnt(0)
    s_load_dword s98, s[76:77], s50
    s_mov_b64 s[16:17], s[76:77]
    s_mov_b32 s18, 268435456
    s_mov_b32 s19, 0x00020000
    s_lshl_b32 s24, s2, 11
    s_add_u32 s24, s24, 17301504
    v_and_b32 v5, 15, v1
    v_lshlrev_b32 v5, 7, v5
    buffer_load_dword v100, v5, s[16:19], s24 offen sc1
    v_lshlrev_b32 v2, 4, v1
    v_lshrrev_b32 v5, 2, v1
    s_lshl_b32 s5, s4, 6
    v_add_u32 v5, s5, v5
    v_and_b32 v6, 3, v1
    v_lshl_add_u32 v6, v6, 9, v5
    v_mul_u32_u24 v6, s2, v6
    v_cvt_f32_u32 v6, v6
    v_mul_f32 v6, 0x3a000000, v6
    v_cvt_f32_u32 v9, s2
    v_mul_f32 v9, 0x3c000000, v9
    v_cos_f32 v104, v6
    v_sin_f32 v112, v6
    v_fmamk_f32 v57, v9, 0x41800000, v6
    v_cos_f32 v105, v57
    v_sin_f32 v113, v57
    v_fmamk_f32 v56, v9, 0x3f800000, v6
    v_cos_f32 v106, v56
    v_sin_f32 v114, v56
    v_fmamk_f32 v57, v9, 0x41880000, v6
    v_cos_f32 v107, v57
    v_sin_f32 v115, v57
    v_fmamk_f32 v56, v9, 0x40000000, v6
    v_cos_f32 v108, v56
    v_sin_f32 v116, v56
    v_fmamk_f32 v57, v9, 0x41900000, v6
    v_cos_f32 v109, v57
    v_sin_f32 v117, v57
    v_fmamk_f32 v56, v9, 0x40400000, v6
    v_cos_f32 v110, v56
    v_sin_f32 v118, v56
    v_fmamk_f32 v57, v9, 0x41980000, v6
    v_cos_f32 v111, v57
    v_sin_f32 v119, v57
    v_lshrrev_b32 v83, 2, v1
    s_lshl_b32 s5, s4, 3
    v_lshl_add_u32 v83, v83, 5, s5
    v_lshrrev_b32 v5, 3, v5
    v_lshlrev_b32 v5, 4, v5
    v_and_b32 v9, 3, v1
    v_lshl_add_u32 v82, v9, 2, v5
    s_lshl_b32 s5, s2, 2
    s_lshl_b32 s30, 15, s5
    s_mov_b32 s31, s30
    s_lshl_b32 s20, s4, 12
    s_add_u32 s20, s20, 17432576
    v_and_b32 v3, 15, v1
    v_lshrrev_b32 v4, 4, v1
    v_cvt_f32_u32 v5, v3
    v_mul_f32 v5, 0x3b800000, v5
    v_lshlrev_b32 v6, 2, v4
    v_cvt_f32_u32 v6, v6
    v_mul_f32 v6, v6, v5
    v_cos_f32 v20, v6
    v_sin_f32 v24, v6
    v_mul_f32 v60, 0x41800000, v6
    v_fmamk_f32 v57, v5, 0x3f800000, v6
    v_cos_f32 v21, v57
    v_sin_f32 v25, v57
    v_mul_f32 v61, 0x41800000, v57
    v_fmamk_f32 v58, v5, 0x40000000, v6
    v_cos_f32 v22, v58
    v_sin_f32 v26, v58
    v_mul_f32 v62, 0x41800000, v58
    v_fmamk_f32 v59, v5, 0x40400000, v6
    v_cos_f32 v23, v59
    v_sin_f32 v27, v59
    v_mul_f32 v63, 0x41800000, v59
    v_cos_f32 v56, v60
    v_sin_f32 v60, v60
    v_cos_f32 v57, v61
    v_sin_f32 v61, v61
    v_cos_f32 v58, v62
    v_sin_f32 v62, v62
    v_cos_f32 v59, v63
    v_sin_f32 v63, v63
    v_mul_f32 v56, 0x3d000000, v56
    v_mul_f32 v57, 0x3d000000, v57
    v_mul_f32 v58, 0x3d000000, v58
    v_mul_f32 v59, 0x3d000000, v59
    v_mul_f32 v60, 0x3d000000, v60
    v_mul_f32 v61, 0x3d000000, v61
    v_mul_f32 v62, 0x3d000000, v62
    v_mul_f32 v63, 0x3d000000, v63
    v_cvt_pk_bf16_f32 v12, -v60, -v61
    v_cvt_pk_bf16_f32 v14, v56, v57
    v_cvt_pk_bf16_f32 v16, v60, v61
    v_cvt_pk_bf16_f32 v13, -v62, -v63
    v_cvt_pk_bf16_f32 v15, v58, v59
    v_cvt_pk_bf16_f32 v17, v62, v63
    v_lshlrev_b32 v8, 5, v3
    v_lshl_add_u32 v8, v4, 3, v8
    v_lshl_add_u32 v10, v4, 6, v3
    v_lshlrev_b32 v10, 1, v10
    v_lshl_add_u32 v7, v4, 6, v3
    v_lshlrev_b32 v7, 3, v7
    v_mov_b32 v40, 0
    v_mov_b32 v41, 0
    v_mov_b32 v42, 0
    v_mov_b32 v43, 0
    v_mov_b32 v44, 0
    v_mov_b32 v45, 0
    v_mov_b32 v46, 0
    v_mov_b32 v47, 0
    v_mov_b32 v80, 65537
    s_waitcnt lgkmcnt(0)
    s_not_b32 s98, s98
    s_bfe_i32 s99, s98, 0x10000
    s_andn2_b32 s100, 0x10001, s99
    s_mov_b32 s101, 0x07060302
    s_mov_b32 s80, 1513920000
    s_mov_b64 s[82:83], 0
    s_mov_b32 s50, 0
    s_and_b32 s26, s2, 3
    s_mul_i32 s26, s26, 1152
    s_add_u32 s26, s26, 16856576
    v_lshlrev_b32 v101, 7, v1
    s_cmp_lg_u32 s4, 0
    s_cbranch_scc1 L_nw3
    s_mov_b64 exec, 255
    v_mov_b32 v102, 0
    buffer_atomic_add v102, v101, s[16:19], s26 offen sc0 sc1
    s_mov_b64 exec, -1
    s_mov_b32 s51, 0
    s_add_u32 s81, s80, 32
L_hw_30:
    s_waitcnt vmcnt(0)
    s_mov_b64 exec, 255
    v_cmp_ne_u32 vcc, s81, v102
    s_add_u32 s51, s51, 1
    s_cbranch_vccz L_hok_31
    s_cmp_gt_u32 s51, 100
    s_cbranch_scc1 L_hok_31
    s_sleep 2
    v_mov_b32 v102, 0
    buffer_atomic_add v102, v101, s[16:19], s26 offen sc0 sc1
    s_branch L_hw_30
L_hok_31:
    s_mov_b64 exec, -1
L_nw3:
    s_barrier
    s_setprio 3
L_nrx:
    buffer_load_dwordx4 v[84:87], v2, s[16:19], s20 offen offset:0 sc1
    buffer_load_dwordx4 v[88:91], v2, s[16:19], s20 offen offset:1024 sc1
    buffer_load_dwordx4 v[92:95], v2, s[16:19], s20 offen offset:2048 sc1
    buffer_load_dwordx4 v[96:99], v2, s[16:19], s20 offen offset:3072 sc1
    s_waitcnt vmcnt(3)
    v_xor_b32 v81, s98, v87
    v_lshlrev_b32 v56, 16, v84
    v_and_b32 v57, 0xffff0000, v84
    v_mul_f32 v32, v56, v104
    v_mul_f32 v36, v56, v112
    v_fmac_f32 v32, v57, v105
    v_fmac_f32 v36, v57, v113
    s_waitcnt vmcnt(2)
    v_bitop3_b32 v81, v81, v91, s98 bitop3:0xf6
    v_lshlrev_b32 v56, 16, v88
    v_and_b32 v57, 0xffff0000, v88
    v_mul_f32 v33, v56, v106
    v_mul_f32 v37, v56, v114
    v_fmac_f32 v33, v57, v107
    v_fmac_f32 v37, v57, v115
    s_waitcnt vmcnt(1)
    v_bitop3_b32 v81, v81, v95, s98 bitop3:0xf6
    v_lshlrev_b32 v56, 16, v92
    v_and_b32 v57, 0xffff0000, v92
    v_mul_f32 v34, v56, v108
    v_mul_f32 v38, v56, v116
    v_fmac_f32 v34, v57, v109
    v_fmac_f32 v38, v57, v117
    s_waitcnt vmcnt(0)
    v_bitop3_b32 v81, v81, v99, s98 bitop3:0xf6
    v_lshlrev_b32 v56, 16, v96
    v_and_b32 v57, 0xffff0000, v96
    v_mul_f32 v35, v56, v110
    v_mul_f32 v39, v56, v118
    v_fmac_f32 v35, v57, v111
    v_fmac_f32 v39, v57, v119
    v_cmp_ne_u32 vcc, 0, v81
    s_add_u32 s50, s50, 1
    s_cbranch_vccz L_nrxok
    s_sleep 4
    s_cmp_lt_u32 s50, 30000
    s_cbranch_scc1 L_nrx
L_nrxok:
    s_mov_b64 exec, s[30:31]
    ds_write_b32 v82, v85 offset:1024
    ds_write_b32 v82, v86 offset:1536
    ds_write_b32 v82, v89 offset:1056
    ds_write_b32 v82, v90 offset:1568
    ds_write_b32 v82, v93 offset:1088
    ds_write_b32 v82, v94 offset:1600
    ds_write_b32 v82, v97 offset:1120
    ds_write_b32 v82, v98 offset:1632
    s_mov_b64 exec, -1
    v_add_f32 v32, v32, v32 quad_perm:[1,0,3,2] row_mask:0xf bank_mask:0xf
    v_add_f32 v33, v33, v33 quad_perm:[1,0,3,2] row_mask:0xf bank_mask:0xf
    v_add_f32 v34, v34, v34 quad_perm:[1,0,3,2] row_mask:0xf bank_mask:0xf
    v_add_f32 v35, v35, v35 quad_perm:[1,0,3,2] row_mask:0xf bank_mask:0xf
    v_add_f32 v36, v36, v36 quad_perm:[1,0,3,2] row_mask:0xf bank_mask:0xf
    v_add_f32 v37, v37, v37 quad_perm:[1,0,3,2] row_mask:0xf bank_mask:0xf
    v_add_f32 v38, v38, v38 quad_perm:[1,0,3,2] row_mask:0xf bank_mask:0xf
    v_add_f32 v39, v39, v39 quad_perm:[1,0,3,2] row_mask:0xf bank_mask:0xf
    v_add_f32 v32, v32, v32 quad_perm:[2,3,0,1] row_mask:0xf bank_mask:0xf
    v_add_f32 v33, v33, v33 quad_perm:[2,3,0,1] row_mask:0xf bank_mask:0xf
    v_add_f32 v34, v34, v34 quad_perm:[2,3,0,1] row_mask:0xf bank_mask:0xf
    v_add_f32 v35, v35, v35 quad_perm:[2,3,0,1] row_mask:0xf bank_mask:0xf
    v_add_f32 v36, v36, v36 quad_perm:[2,3,0,1] row_mask:0xf bank_mask:0xf
    v_add_f32 v37, v37, v37 quad_perm:[2,3,0,1] row_mask:0xf bank_mask:0xf
    v_add_f32 v38, v38, v38 quad_perm:[2,3,0,1] row_mask:0xf bank_mask:0xf
    v_add_f32 v39, v39, v39 quad_perm:[2,3,0,1] row_mask:0xf bank_mask:0xf
    v_mul_f32 v32, 0.5, v32
    v_mul_f32 v36, -0.5, v36
    v_mul_f32 v33, 0.5, v33
    v_mul_f32 v37, -0.5, v37
    v_mul_f32 v34, 0.5, v34
    v_mul_f32 v38, -0.5, v38
    v_mul_f32 v35, 0.5, v35
    v_mul_f32 v39, -0.5, v39
    v_cvt_pk_bf16_f32 v56, v32, v33
    v_cvt_pk_bf16_f32 v58, v36, v37
    v_cvt_pk_bf16_f32 v57, v34, v35
    v_cvt_pk_bf16_f32 v59, v38, v39
    ds_write_b64 v83, v[56:57]
    ds_write_b64 v83, v[58:59] offset:512
    s_waitcnt lgkmcnt(0)
    s_barrier
    s_cmp_eq_u32 s4, 0
    s_cbranch_scc1 L_n_go
    s_endpgm
L_n_go:
    ds_read_b64 v[28:29], v8
    ds_read_b64 v[30:31], v8 offset:512
    ds_read_u16_d16_hi v40, v10 offset:1024
    ds_read_u16_d16_hi v44, v10 offset:1536
    ds_read_u16_d16_hi v41, v10 offset:1056
    ds_read_u16_d16_hi v45, v10 offset:1568
    ds_read_u16_d16_hi v42, v10 offset:1088
    ds_read_u16_d16_hi v46, v10 offset:1600
    ds_read_u16_d16_hi v43, v10 offset:1120
    ds_read_u16_d16_hi v47, v10 offset:1632
    s_waitcnt lgkmcnt(0)
    v_mfma_f32_16x16x32_bf16 v[32:35], v[28:31], v[14:17], 0
    v_mfma_f32_16x16x32_bf16 v[36:39], v[28:31], v[12:15], 0
    s_nop 7
    v_mul_f32 v56, v36, v24
    v_mul_f32 v60, v32, v24
    v_mul_f32 v57, v37, v25
    v_mul_f32 v61, v33, v25
    v_mul_f32 v58, v38, v26
    v_mul_f32 v62, v34, v26
    v_mul_f32 v59, v39, v27
    v_mul_f32 v63, v35, v27
    v_fma_f32 v56, v32, v20, v56
    v_fma_f32 v60, v36, v20, -v60
    v_fma_f32 v57, v33, v21, v57
    v_fma_f32 v61, v37, v21, -v61
    v_fma_f32 v58, v34, v22, v58
    v_fma_f32 v62, v38, v22, -v62
    v_fma_f32 v59, v35, v23, v59
    v_fma_f32 v63, v39, v23, -v63
    v_cvt_pk_bf16_f32 v48, v56, v57
    v_cvt_pk_bf16_f32 v50, v60, v61
    v_cvt_pk_bf16_f32 v49, v58, v59
    v_cvt_pk_bf16_f32 v51, v62, v63
    s_nop 1
    v_mfma_f32_16x16x32_bf16 v[32:35], v[14:17], v[48:51], 0
    v_mfma_f32_16x16x32_bf16 v[36:39], v[12:15], v[48:51], 0
    s_nop 7
    v_mul_f32 v56, v36, v44
    v_mul_f32 v60, v32, v44
    v_mul_f32 v57, v37, v45
    v_mul_f32 v61, v33, v45
    v_mul_f32 v58, v38, v46
    v_mul_f32 v62, v34, v46
    v_mul_f32 v59, v39, v47
    v_mul_f32 v63, v35, v47
    v_fma_f32 v56, v32, v40, -v56
    v_fma_f32 v60, v36, v40, v60
    v_fma_f32 v57, v33, v41, -v57
    v_fma_f32 v61, v37, v41, v61
    v_fma_f32 v58, v34, v42, -v58
    v_fma_f32 v62, v38, v42, v62
    v_fma_f32 v59, v35, v43, -v59
    v_fma_f32 v63, v39, v43, v63
    v_cvt_pk_bf16_f32 v50, v56, v57
    v_cvt_pk_bf16_f32 v48, v60, v61
    v_cvt_pk_bf16_f32 v51, v58, v59
    v_cvt_pk_bf16_f32 v49, v62, v63
    s_nop 1
    v_mfma_f32_16x16x32_bf16 v[32:35], v[48:51], v[12:15], 0
    v_mfma_f32_16x16x32_bf16 v[36:39], v[48:51], v[14:17], 0
    s_nop 7
    v_mul_f32 v56, v36, v24
    v_mul_f32 v60, v32, v24
    v_mul_f32 v57, v37, v25
    v_mul_f32 v61, v33, v25
    v_mul_f32 v58, v38, v26
    v_mul_f32 v62, v34, v26
    v_mul_f32 v59, v39, v27
    v_mul_f32 v63, v35, v27
    v_fma_f32 v56, v32, v20, -v56
    v_fma_f32 v60, v36, v20, v60
    v_fma_f32 v57, v33, v21, -v57
    v_fma_f32 v61, v37, v21, v61
    v_fma_f32 v58, v34, v22, -v58
    v_fma_f32 v62, v38, v22, v62
    v_fma_f32 v59, v35, v23, -v59
    v_fma_f32 v63, v39, v23, v63
    v_cvt_pk_bf16_f32 v50, v56, v57
    v_cvt_pk_bf16_f32 v48, v60, v61
    v_cvt_pk_bf16_f32 v51, v58, v59
    v_cvt_pk_bf16_f32 v49, v62, v63
    s_nop 1
    v_mfma_f32_16x16x32_bf16 v[32:35], v[12:15], v[48:51], 0
    v_mfma_f32_16x16x32_bf16 v[36:39], v[14:17], v[48:51], 0
    v_mov_b32 v65, s98
    s_nop 6
    v_cvt_pk_bf16_f32 v64, v32, v36
    buffer_store_dwordx2 v[64:65], v7, s[16:19], s24 offen offset:0 sc1
    v_mov_b32 v67, s98
    v_cvt_pk_bf16_f32 v66, v33, v37
    buffer_store_dwordx2 v[66:67], v7, s[16:19], s24 offen offset:128 sc1
    v_mov_b32 v69, s98
    v_cvt_pk_bf16_f32 v68, v34, v38
    buffer_store_dwordx2 v[68:69], v7, s[16:19], s24 offen offset:256 sc1
    v_mov_b32 v71, s98
    v_cvt_pk_bf16_f32 v70, v35, v39
    buffer_store_dwordx2 v[70:71], v7, s[16:19], s24 offen offset:384 sc1
    s_endpgm
L_code_end:
    s_endpgm
.p2align 8
.type L_tab,@object
L_tab:
.long 0x3f803f80,0x3f803f80,0x3f803f80,0x3f803f80,0x3f7b3f80,0x3f553f6d,0x3f0e3f35,0x3e483ec4
.long 0x3f6d3f80,0x3ec43f35,0xbec4248d,0xbf6dbf35,0x3f553f80,0xbe483ec4,0xbf7bbf35,0xbf0ebf6d
.long 0x3f353f80,0xbf35248d,0xbf35bf80,0x3f35a554,0x3f0e3f80,0xbf7bbec4,0x3e48bf35,0x3f553f6d
.long 0x3ec43f80,0xbf6dbf35,0x3f6da554,0xbec43f35,0x3e483f80,0xbf0ebf6d,0x3f553f35,0xbf7bbec4
.long 0x248d3f80,0xa554bf80,0x248d3f80,0xa554bf80,0xbe483f80,0x3f0ebf6d,0xbf553f35,0x3f7bbec4
.long 0xbec43f80,0x3f6dbf35,0xbf6d248d,0x3ec43f35,0xbf0e3f80,0x3f7bbec4,0xbe48bf35,0xbf553f6d
.long 0xbf353f80,0x3f35a554,0x3f35bf80,0xbf35248d,0xbf553f80,0x3e483ec4,0x3f7bbf35,0x3f0ebf6d
.long 0xbf6d3f80,0xbec43f35,0x3ec4a554,0x3f6dbf35,0xbf7b3f80,0xbf553f6d,0xbf0e3f35,0xbe483ec4
.long 0xbf803f80,0xbf803f80,0xbf803f80,0xbf803f80,0xbf7b3f80,0xbf553f6d,0xbf0e3f35,0xbe483ec4
.long 0xbf6d3f80,0xbec43f35,0x3ec4248d,0x3f6dbf35,0xbf553f80,0x3e483ec4,0x3f7bbf35,0x3f0ebf6d
.long 0xbf353f80,0x3f35248d,0x3f35bf80,0xbf35a554,0xbf0e3f80,0x3f7bbec4,0xbe48bf35,0xbf553f6d
.long 0xbec43f80,0x3f6dbf35,0xbf6da554,0x3ec43f35,0xbe483f80,0x3f0ebf6d,0xbf553f35,0x3f7bbec4
.long 0xa5543f80,0x248dbf80,0xa5543f80,0x248dbf80,0x3e483f80,0xbf0ebf6d,0x3f553f35,0xbf7bbec4
.long 0x3ec43f80,0xbf6dbf35,0x3f6d248d,0xbec43f35,0x3f0e3f80,0xbf7bbec4,0x3e48bf35,0x3f553f6d
.long 0x3f353f80,0xbf35a554,0xbf35bf80,0x3f35248d,0x3f553f80,0xbe483ec4,0xbf7bbf35,0xbf0ebf6d
.long 0x3f6d3f80,0x3ec43f35,0xbec4a554,0xbf6dbf35,0x3f7b3f80,0x3f553f6d,0x3f0e3f35,0x3e483ec4
.long 0x3f803f80,0x3f803f80,0x3f803f80,0x3f803f80,0xbe48248d,0xbf0ebec4,0xbf55bf35,0xbf7bbf6d
.long 0xbf6dbf80,0xbec4bf35,0x3ec4a554,0x3f6d3f35,0x3f0ea554,0x3f7b3f6d,0x3e483f35,0xbf55bec4
.long 0x3f353f80,0xbf35248d,0xbf35bf80,0x3f35a554,0xbf55248d,0xbe48bf6d,0x3f7b3f35,0xbf0e3ec4
.long 0xbec4bf80,0x3f6d3f35,0xbf6d248d,0x3ec4bf35,0x3f7ba554,0xbf553ec4,0x3f0ebf35,0xbe483f6d
.long 0x248d3f80,0xa554bf80,0x248d3f80,0xa554bf80,0xbf7b248d,0x3f553ec4,0xbf0ebf35,0x3e483f6d
.long 0x3ec4bf80,0xbf6d3f35,0x3f6da554,0xbec4bf35,0x3f55a554,0x3e48bf6d,0xbf7b3f35,0x3f0e3ec4
.long 0xbf353f80,0x3f35a554,0x3f35bf80,0xbf35248d,0xbf0e248d,0xbf7b3f6d,0xbe483f35,0x3f55bec4
.long 0x3f6dbf80,0x3ec4bf35,0xbec4248d,0xbf6d3f35,0x3e48a554,0x3f0ebec4,0x3f55bf35,0x3f7bbf6d
.long 0xbf803f80,0xbf803f80,0xbf803f80,0xbf803f80,0x3e48248d,0x3f0ebec4,0x3f55bf35,0x3f7bbf6d
.long 0x3f6dbf80,0x3ec4bf35,0xbec4a554,0xbf6d3f35,0xbf0ea554,0xbf7b3f6d,0xbe483f35,0x3f55bec4
.long 0xbf353f80,0x3f35248d,0x3f35bf80,0xbf35a554,0x3f55248d,0x3e48bf6d,0xbf7b3f35,0x3f0e3ec4
.long 0x3ec4bf80,0xbf6d3f35,0x3f6d248d,0xbec4bf35,0xbf7ba554,0x3f553ec4,0xbf0ebf35,0x3e483f6d
.long 0xa5543f80,0x248dbf80,0xa5543f80,0x248dbf80,0x3f7b248d,0xbf553ec4,0x3f0ebf35,0xbe483f6d
.long 0xbec4bf80,0x3f6d3f35,0xbf6da554,0x3ec4bf35,0xbf55a554,0xbe48bf6d,0x3f7b3f35,0xbf0e3ec4
.long 0x3f353f80,0xbf35a554,0xbf35bf80,0x3f35248d,0x3f0e248d,0x3f7b3f6d,0x3e483f35,0xbf55bec4
.long 0xbf6dbf80,0xbec4bf35,0x3ec4248d,0x3f6d3f35,0xbe48a554,0xbf0ebec4,0xbf55bf35,0xbf7bbf6d
.long 0x3f803f80,0x3f803f80,0x3f803f80,0x3f803f80,0xbf7bbf80,0xbf55bf6d,0xbf0ebf35,0xbe48bec4
.long 0x3f6d3f80,0x3ec43f35,0xbec4248d,0xbf6dbf35,0xbf55bf80,0x3e48bec4,0x3f7b3f35,0x3f0e3f6d
.long 0x3f353f80,0xbf35248d,0xbf35bf80,0x3f35a554,0xbf0ebf80,0x3f7b3ec4,0xbe483f35,0xbf55bf6d
.long 0x3ec43f80,0xbf6dbf35,0x3f6da554,0xbec43f35,0xbe48bf80,0x3f0e3f6d,0xbf55bf35,0x3f7b3ec4
.long 0x248d3f80,0xa554bf80,0x248d3f80,0xa554bf80,0x3e48bf80,0xbf0e3f6d,0x3f55bf35,0xbf7b3ec4
.long 0xbec43f80,0x3f6dbf35,0xbf6d248d,0x3ec43f35,0x3f0ebf80,0xbf7b3ec4,0x3e483f35,0x3f55bf6d
.long 0xbf353f80,0x3f35a554,0x3f35bf80,0xbf35248d,0x3f55bf80,0xbe48bec4,0xbf7b3f35,0xbf0e3f6d
.long 0xbf6d3f80,0xbec43f35,0x3ec4a554,0x3f6dbf35,0x3f7bbf80,0x3f55bf6d,0x3f0ebf35,0x3e48bec4
.long 0xbf803f80,0xbf803f80,0xbf803f80,0xbf803f80,0x3f7bbf80,0x3f55bf6d,0x3f0ebf35,0x3e48bec4
.long 0xbf6d3f80,0xbec43f35,0x3ec4248d,0x3f6dbf35,0x3f55bf80,0xbe48bec4,0xbf7b3f35,0xbf0e3f6d
.long 0xbf353f80,0x3f35248d,0x3f35bf80,0xbf35a554,0x3f0ebf80,0xbf7b3ec4,0x3e483f35,0x3f55bf6d
.long 0xbec43f80,0x3f6dbf35,0xbf6da554,0x3ec43f35,0x3e48bf80,0xbf0e3f6d,0x3f55bf35,0xbf7b3ec4
.long 0xa5543f80,0x248dbf80,0xa5543f80,0x248dbf80,0xbe48bf80,0x3f0e3f6d,0xbf55bf35,0x3f7b3ec4
.long 0x3ec43f80,0xbf6dbf35,0x3f6d248d,0xbec43f35,0xbf0ebf80,0x3f7b3ec4,0xbe483f35,0xbf55bf6d
.long 0x3f353f80,0xbf35a554,0xbf35bf80,0x3f35248d,0xbf55bf80,0x3e48bec4,0x3f7b3f35,0x3f0e3f6d
.long 0x3f6d3f80,0x3ec43f35,0xbec4a554,0xbf6dbf35,0xbf7bbf80,0xbf55bf6d,0xbf0ebf35,0xbe48bec4
.long 0x3f803f80,0x3f803f80,0x3f803f80,0x3f803f80,0x3e48a554,0x3f0e3ec4,0x3f553f35,0x3f7b3f6d
.long 0xbf6dbf80,0xbec4bf35,0x3ec4a554,0x3f6d3f35,0xbf0e248d,0xbf7bbf6d,0xbe48bf35,0x3f553ec4
.long 0x3f353f80,0xbf35248d,0xbf35bf80,0x3f35a554,0x3f55a554,0x3e483f6d,0xbf7bbf35,0x3f0ebec4
.long 0xbec4bf80,0x3f6d3f35,0xbf6d248d,0x3ec4bf35,0xbf7b248d,0x3f55bec4,0xbf0e3f35,0x3e48bf6d
.long 0x248d3f80,0xa554bf80,0x248d3f80,0xa554bf80,0x3f7ba554,0xbf55bec4,0x3f0e3f35,0xbe48bf6d
.long 0x3ec4bf80,0xbf6d3f35,0x3f6da554,0xbec4bf35,0xbf55248d,0xbe483f6d,0x3f7bbf35,0xbf0ebec4
.long 0xbf353f80,0x3f35a554,0x3f35bf80,0xbf35248d,0x3f0ea554,0x3f7bbf6d,0x3e48bf35,0xbf553ec4
.long 0x3f6dbf80,0x3ec4bf35,0xbec4248d,0xbf6d3f35,0xbe48248d,0xbf0e3ec4,0xbf553f35,0xbf7b3f6d
.long 0xbf803f80,0xbf803f80,0xbf803f80,0xbf803f80,0xbe48a554,0xbf0e3ec4,0xbf553f35,0xbf7b3f6d
.long 0x3f6dbf80,0x3ec4bf35,0xbec4a554,0xbf6d3f35,0x3f0e248d,0x3f7bbf6d,0x3e48bf35,0xbf553ec4
.long 0xbf353f80,0x3f35248d,0x3f35bf80,0xbf35a554,0xbf55a554,0xbe483f6d,0x3f7bbf35,0xbf0ebec4
.long 0x3ec4bf80,0xbf6d3f35,0x3f6d248d,0xbec4bf35,0x3f7b248d,0xbf55bec4,0x3f0e3f35,0xbe48bf6d
.long 0xa5543f80,0x248dbf80,0xa5543f80,0x248dbf80,0xbf7ba554,0x3f55bec4,0xbf0e3f35,0x3e48bf6d
.long 0xbec4bf80,0x3f6d3f35,0xbf6da554,0x3ec4bf35,0x3f55248d,0x3e483f6d,0xbf7bbf35,0x3f0ebec4
.long 0x3f353f80,0xbf35a554,0xbf35bf80,0x3f35248d,0xbf0ea554,0xbf7bbf6d,0xbe48bf35,0x3f553ec4
.long 0xbf6dbf80,0xbec4bf35,0x3ec4248d,0x3f6d3f35,0x3e48248d,0x3f0e3ec4,0x3f553f35,0x3f7b3f6d
.long 0x80008000,0x80008000,0x80008000,0x80008000,0xbe488000,0xbf0ebec4,0xbf55bf35,0xbf7bbf6d
.long 0xbec48000,0xbf6dbf35,0xbf6dbf80,0xbec4bf35,0xbf0e8000,0xbf7bbf6d,0xbe48bf35,0x3f553ec4
.long 0xbf358000,0xbf35bf80,0x3f35a50d,0x3f353f80,0xbf558000,0xbe48bf6d,0x3f7b3f35,0xbf0e3ec4
.long 0xbf6d8000,0x3ec4bf35,0x3ec43f80,0xbf6dbf35,0xbf7b8000,0x3f55bec4,0xbf0e3f35,0x3e48bf6d
.long 0xbf808000,0x3f80a50d,0xbf808000,0x3f80a50d,0xbf7b8000,0x3f553ec4,0xbf0ebf35,0x3e483f6d
.long 0xbf6d8000,0x3ec43f35,0x3ec4bf80,0xbf6d3f35,0xbf558000,0xbe483f6d,0x3f7bbf35,0xbf0ebec4
.long 0xbf358000,0xbf353f80,0x3f35a50d,0x3f35bf80,0xbf0e8000,0xbf7b3f6d,0xbe483f35,0x3f55bec4
.long 0xbec48000,0xbf6d3f35,0xbf6d3f80,0xbec43f35,0xbe488000,0xbf0e3ec4,0xbf553f35,0xbf7b3f6d
.long 0xa50d8000,0xa50d8000,0xa50d8000,0xa50d8000,0x3e488000,0x3f0ebec4,0x3f55bf35,0x3f7bbf6d
.long 0x3ec48000,0x3f6dbf35,0x3f6dbf80,0x3ec4bf35,0x3f0e8000,0x3f7bbf6d,0x3e48bf35,0xbf553ec4
.long 0x3f358000,0x3f35bf80,0xbf35a50d,0xbf353f80,0x3f558000,0x3e48bf6d,0xbf7b3f35,0x3f0e3ec4
.long 0x3f6d8000,0xbec4bf35,0xbec43f80,0x3f6dbf35,0x3f7b8000,0xbf55bec4,0x3f0e3f35,0xbe48bf6d
.long 0x3f808000,0xbf80a50d,0x3f808000,0xbf80a50d,0x3f7b8000,0xbf553ec4,0x3f0ebf35,0xbe483f6d
.long 0x3f6d8000,0xbec43f35,0xbec4bf80,0x3f6d3f35,0x3f558000,0x3e483f6d,0xbf7bbf35,0x3f0ebec4
.long 0x3f358000,0x3f353f80,0xbf35a50d,0xbf35bf80,0x3f0e8000,0x3f7b3f6d,0x3e483f35,0xbf55bec4
.long 0x3ec48000,0x3f6d3f35,0x3f6d3f80,0x3ec43f35,0x3e488000,0x3f0e3ec4,0x3f553f35,0x3f7b3f6d
.long 0x80008000,0x80008000,0x80008000,0x80008000,0xbf7bbf80,0xbf55bf6d,0xbf0ebf35,0xbe48bec4
.long 0x3ec4a50d,0x3f6d3f35,0x3f6d3f80,0x3ec43f35,0x3f553f80,0xbe483ec4,0xbf7bbf35,0xbf0ebf6d
.long 0xbf358000,0xbf35bf80,0x3f35a50d,0x3f353f80,0xbf0ebf80,0x3f7b3ec4,0xbe483f35,0xbf55bf6d
.long 0x3f6da50d,0xbec43f35,0xbec4bf80,0x3f6d3f35,0x3e483f80,0xbf0ebf6d,0x3f553f35,0xbf7bbec4
.long 0xbf808000,0x3f80a50d,0xbf808000,0x3f80a50d,0x3e48bf80,0xbf0e3f6d,0x3f55bf35,0xbf7b3ec4
.long 0x3f6da50d,0xbec4bf35,0xbec43f80,0x3f6dbf35,0xbf0e3f80,0x3f7bbec4,0xbe48bf35,0xbf553f6d
.long 0xbf358000,0xbf353f80,0x3f35a50d,0x3f35bf80,0x3f55bf80,0xbe48bec4,0xbf7b3f35,0xbf0e3f6d
.long 0x3ec4a50d,0x3f6dbf35,0x3f6dbf80,0x3ec4bf35,0xbf7b3f80,0xbf553f6d,0xbf0e3f35,0xbe483ec4
.long 0xa50d8000,0xa50d8000,0xa50d8000,0xa50d8000,0x3f7bbf80,0x3f55bf6d,0x3f0ebf35,0x3e48bec4
.long 0xbec4a50d,0xbf6d3f35,0xbf6d3f80,0xbec43f35,0xbf553f80,0x3e483ec4,0x3f7bbf35,0x3f0ebf6d
.long 0x3f358000,0x3f35bf80,0xbf35a50d,0xbf353f80,0x3f0ebf80,0xbf7b3ec4,0x3e483f35,0x3f55bf6d
.long 0xbf6da50d,0x3ec43f35,0x3ec4bf80,0xbf6d3f35,0xbe483f80,0x3f0ebf6d,0xbf553f35,0x3f7bbec4
.long 0x3f808000,0xbf80a50d,0x3f808000,0xbf80a50d,0xbe48bf80,0x3f0e3f6d,0xbf55bf35,0x3f7b3ec4
.long 0xbf6da50d,0x3ec4bf35,0x3ec43f80,0xbf6dbf35,0x3f0e3f80,0xbf7bbec4,0x3e48bf35,0x3f553f6d
.long 0x3f358000,0x3f353f80,0xbf35a50d,0xbf35bf80,0xbf55bf80,0x3e48bec4,0x3f7b3f35,0x3f0e3f6d
.long 0xbec4a50d,0xbf6dbf35,0xbf6dbf80,0xbec4bf35,0x3f7b3f80,0x3f553f6d,0x3f0e3f35,0x3e483ec4
.long 0x80008000,0x80008000,0x80008000,0x80008000,0x3e48a50d,0x3f0e3ec4,0x3f553f35,0x3f7b3f6d
.long 0xbec48000,0xbf6dbf35,0xbf6dbf80,0xbec4bf35,0x3f0ea50d,0x3f7b3f6d,0x3e483f35,0xbf55bec4
.long 0xbf358000,0xbf35bf80,0x3f35a50d,0x3f353f80,0x3f55a50d,0x3e483f6d,0xbf7bbf35,0x3f0ebec4
.long 0xbf6d8000,0x3ec4bf35,0x3ec43f80,0xbf6dbf35,0x3f7ba50d,0xbf553ec4,0x3f0ebf35,0xbe483f6d
.long 0xbf808000,0x3f80a50d,0xbf808000,0x3f80a50d,0x3f7ba50d,0xbf55bec4,0x3f0e3f35,0xbe48bf6d
.long 0xbf6d8000,0x3ec43f35,0x3ec4bf80,0xbf6d3f35,0x3f55a50d,0x3e48bf6d,0xbf7b3f35,0x3f0e3ec4
.long 0xbf358000,0xbf353f80,0x3f35a50d,0x3f35bf80,0x3f0ea50d,0x3f7bbf6d,0x3e48bf35,0xbf553ec4
.long 0xbec48000,0xbf6d3f35,0xbf6d3f80,0xbec43f35,0x3e48a50d,0x3f0ebec4,0x3f55bf35,0x3f7bbf6d
.long 0xa50d8000,0xa50d8000,0xa50d8000,0xa50d8000,0xbe48a50d,0xbf0e3ec4,0xbf553f35,0xbf7b3f6d
.long 0x3ec48000,0x3f6dbf35,0x3f6dbf80,0x3ec4bf35,0xbf0ea50d,0xbf7b3f6d,0xbe483f35,0x3f55bec4
.long 0x3f358000,0x3f35bf80,0xbf35a50d,0xbf353f80,0xbf55a50d,0xbe483f6d,0x3f7bbf35,0xbf0ebec4
.long 0x3f6d8000,0xbec4bf35,0xbec43f80,0x3f6dbf35,0xbf7ba50d,0x3f553ec4,0xbf0ebf35,0x3e483f6d
.long 0x3f808000,0xbf80a50d,0x3f808000,0xbf80a50d,0xbf7ba50d,0x3f55bec4,0xbf0e3f35,0x3e48bf6d
.long 0x3f6d8000,0xbec43f35,0xbec4bf80,0x3f6d3f35,0xbf55a50d,0xbe48bf6d,0x3f7b3f35,0xbf0e3ec4
.long 0x3f358000,0x3f353f80,0xbf35a50d,0xbf35bf80,0xbf0ea50d,0xbf7bbf6d,0xbe48bf35,0x3f553ec4
.long 0x3ec48000,0x3f6d3f35,0x3f6d3f80,0x3ec43f35,0xbe48a50d,0xbf0ebec4,0xbf55bf35,0xbf7bbf6d
.long 0x80008000,0x80008000,0x80008000,0x80008000,0x3f7b3f80,0x3f553f6d,0x3f0e3f35,0x3e483ec4
.long 0x3ec4a50d,0x3f6d3f35,0x3f6d3f80,0x3ec43f35,0xbf55bf80,0x3e48bec4,0x3f7b3f35,0x3f0e3f6d
.long 0xbf358000,0xbf35bf80,0x3f35a50d,0x3f353f80,0x3f0e3f80,0xbf7bbec4,0x3e48bf35,0x3f553f6d
.long 0x3f6da50d,0xbec43f35,0xbec4bf80,0x3f6d3f35,0xbe48bf80,0x3f0e3f6d,0xbf55bf35,0x3f7b3ec4
.long 0xbf808000,0x3f80a50d,0xbf808000,0x3f80a50d,0xbe483f80,0x3f0ebf6d,0xbf553f35,0x3f7bbec4
.long 0x3f6da50d,0xbec4bf35,0xbec43f80,0x3f6dbf35,0x3f0ebf80,0xbf7b3ec4,0x3e483f35,0x3f55bf6d
.long 0xbf358000,0xbf353f80,0x3f35a50d,0x3f35bf80,0xbf553f80,0x3e483ec4,0x3f7bbf35,0x3f0ebf6d
.long 0x3ec4a50d,0x3f6dbf35,0x3f6dbf80,0x3ec4bf35,0x3f7bbf80,0x3f55bf6d,0x3f0ebf35,0x3e48bec4
.long 0xa50d8000,0xa50d8000,0xa50d8000,0xa50d8000,0xbf7b3f80,0xbf553f6d,0xbf0e3f35,0xbe483ec4
.long 0xbec4a50d,0xbf6d3f35,0xbf6d3f80,0xbec43f35,0x3f55bf80,0xbe48bec4,0xbf7b3f35,0xbf0e3f6d
.long 0x3f358000,0x3f35bf80,0xbf35a50d,0xbf353f80,0xbf0e3f80,0x3f7bbec4,0xbe48bf35,0xbf553f6d
.long 0xbf6da50d,0x3ec43f35,0x3ec4bf80,0xbf6d3f35,0x3e48bf80,0xbf0e3f6d,0x3f55bf35,0xbf7b3ec4
.long 0x3f808000,0xbf80a50d,0x3f808000,0xbf80a50d,0x3e483f80,0xbf0ebf6d,0x3f553f35,0xbf7bbec4
.long 0xbf6da50d,0x3ec4bf35,0x3ec43f80,0xbf6dbf35,0xbf0ebf80,0x3f7b3ec4,0xbe483f35,0xbf55bf6d
.long 0x3f358000,0x3f353f80,0xbf35a50d,0xbf35bf80,0x3f553f80,0xbe483ec4,0xbf7bbf35,0xbf0ebf6d
.long 0xbec4a50d,0xbf6dbf35,0xbf6dbf80,0xbec4bf35,0xbf7bbf80,0xbf55bf6d,0xbf0ebf35,0xbe48bec4
.long 0x3f800000,0x3f800000,0x3f800000,0x3f800000,0x3f800000,0x3f7ffec4,0x3f7ffb11,0x3f7ff4e6
.long 0x3f800000,0x3f7ffb11,0x3f7fec43,0x3f7fd397,0x3f800000,0x3f7ff4e6,0x3f7fd397,0x3f7f9c18
.long 0x3f800000,0x3f7fec43,0x3f7fb10f,0x3f7f4e6d,0x3f800000,0x3f7fe129,0x3f7f84ab,0x3f7eea9d
.long 0x3f800000,0x3f7fd397,0x3f7f4e6d,0x3f7e70b0,0x3f800000,0x3f7fc38f,0x3f7f0e58,0x3f7de0b1
.long 0x3f800000,0x3f7fb10f,0x3f7ec46d,0x3f7d3aac,0x3f800000,0x3f7f9c18,0x3f7e70b0,0x3f7c7eb0
.long 0x3f800000,0x3f7f84ab,0x3f7e1324,0x3f7baccd,0x3f800000,0x3f7f6ac7,0x3f7dabcc,0x3f7ac516
.long 0x3f800000,0x3f7f4e6d,0x3f7d3aac,0x3f79c79d,0x3f800000,0x3f7f2f9d,0x3f7cbfc9,0x3f78b47b
.long 0x3f800000,0x3f7f0e58,0x3f7c3b28,0x3f778bc5,0x3f800000,0x3f7eea9d,0x3f7baccd,0x3f764d97
.long 0x3f800000,0x3f7ec46d,0x3f7b14be,0x3f74fa0b,0x3f800000,0x3f7e9bc9,0x3f7a7302,0x3f73913f
.long 0x3f800000,0x3f7e70b0,0x3f79c79d,0x3f721352,0x3f800000,0x3f7e4323,0x3f791298,0x3f708066
.long 0x3f800000,0x3f7e1324,0x3f7853f8,0x3f6ed89e,0x3f800000,0x3f7de0b1,0x3f778bc5,0x3f6d1c1d
.long 0x3f800000,0x3f7dabcc,0x3f76ba07,0x3f6b4b0c,0x3f800000,0x3f7d7474,0x3f75dec6,0x3f696591
.long 0x3f800000,0x3f7d3aac,0x3f74fa0b,0x3f676bd8,0x3f800000,0x3f7cfe73,0x3f740bdd,0x3f655e0b
.long 0x3f800000,0x3f7cbfc9,0x3f731447,0x3f633c5a,0x3f800000,0x3f7c7eb0,0x3f721352,0x3f6106f2
.long 0x3f800000,0x3f7c3b28,0x3f710908,0x3f5ebe05,0x3f800000,0x3f7bf531,0x3f6ff573,0x3f5c61c7
.long 0x3f800000,0x3f7baccd,0x3f6ed89e,0x3f59f26a,0x3f800000,0x3f7b61fc,0x3f6db293,0x3f577026
.long 0x3f800000,0x3f800000,0x3f800000,0x3f800000,0x3f7fec43,0x3f7fe129,0x3f7fd397,0x3f7fc38f
.long 0x3f7fb10f,0x3f7f84ab,0x3f7f4e6d,0x3f7f0e58,0x3f7f4e6d,0x3f7eea9d,0x3f7e70b0,0x3f7de0b1
.long 0x3f7ec46d,0x3f7e1324,0x3f7d3aac,0x3f7c3b28,0x3f7e1324,0x3f7cfe73,0x3f7baccd,0x3f7a1e84
.long 0x3f7d3aac,0x3f7baccd,0x3f79c79d,0x3f778bc5,0x3f7c3b28,0x3f7a1e84,0x3f778bc5,0x3f748422
.long 0x3f7b14be,0x3f7853f8,0x3f74fa0b,0x3f710908,0x3f79c79d,0x3f764d97,0x3f721352,0x3f6d1c1d
.long 0x3f7853f8,0x3f740bdd,0x3f6ed89e,0x3f68bf3c,0x3f76ba07,0x3f718f57,0x3f6b4b0c,0x3f63f473
.long 0x3f74fa0b,0x3f6ed89e,0x3f676bd8,0x3f5ebe05,0x3f731447,0x3f6be858,0x3f633c5a,0x3f591e6a
.long 0x3f710908,0x3f68bf3c,0x3f5ebe05,0x3f531849,0x3f6ed89e,0x3f655e0b,0x3f59f26a,0x3f4cae79
.long 0x3f6c835e,0x3f61c598,0x3f54db31,0x3f45e403,0x3f6a09a7,0x3f5df6be,0x3f4f7a1f,0x3f3ebc1b
.long 0x3f676bd8,0x3f59f26a,0x3f49d112,0x3f373a23,0x3f64aa59,0x3f55b993,0x3f43e200,0x3f2f61a5
.long 0x3f61c598,0x3f514d3d,0x3f3daef9,0x3f273656,0x3f5ebe05,0x3f4cae79,0x3f373a23,0x3f1ebc12
.long 0x3f5b941a,0x3f47de65,0x3f3085bb,0x3f15f6d9,0x3f584853,0x3f42de29,0x3f299415,0x3f0cead0
.long 0x3f54db31,0x3f3daef9,0x3f226799,0x3f039c3d,0x3f514d3d,0x3f385216,0x3f1b02c6,0x3ef41f07
.long 0x3f4d9f02,0x3f32c8c9,0x3f13682a,0x3ee0924f,0x3f49d112,0x3f2d1469,0x3f0b9a6b,0x3ecc9b8b
.long 0x3f45e403,0x3f273656,0x3f039c3d,0x3eb8442a,0x3f41d870,0x3f212ff9,0x3ef6e0cb,0x3ea395c5
.long 0x3f3daef9,0x3f1b02c6,0x3ee63375,0x3e8e9a22,0x3f396842,0x3f14b039,0x3ed53641,0x3e72b651
.long 0x3f800000,0x3f800000,0x3f800000,0x3f800000,0x3f7fb10f,0x3f7f9c18,0x3f7f84ab,0x3f7f6ac7
.long 0x3f7ec46d,0x3f7e70b0,0x3f7e1324,0x3f7dabcc,0x3f7d3aac,0x3f7c7eb0,0x3f7baccd,0x3f7ac516
.long 0x3f7b14be,0x3f79c79d,0x3f7853f8,0x3f76ba07,0x3f7853f8,0x3f764d97,0x3f740bdd,0x3f718f57
.long 0x3f74fa0b,0x3f721352,0x3f6ed89e,0x3f6b4b0c,0x3f710908,0x3f6d1c1d,0x3f68bf3c,0x3f63f473
.long 0x3f6c835e,0x3f676bd8,0x3f61c598,0x3f5b941a,0x3f676bd8,0x3f6106f2,0x3f59f26a,0x3f5233c6
.long 0x3f61c598,0x3f59f26a,0x3f514d3d,0x3f47de65,0x3f5b941a,0x3f5233c6,0x3f47de65,0x3f3ca003
.long 0x3f54db31,0x3f49d112,0x3f3daef9,0x3f3085bb,0x3f4d9f02,0x3f40d0da,0x3f32c8c9,0x3f239da9
.long 0x3f45e403,0x3f373a23,0x3f273656,0x3f15f6d9,0x3f3daef9,0x3f2d1469,0x3f1b02c6,0x3f07a136
.long 0x3f3504f3,0x3f226799,0x3f0e39da,0x3ef15aea,0x3f2beb4a,0x3f173c07,0x3f00e7e4,0x3ed25a09
.long 0x3f226799,0x3f0b9a6b,0x3ee63375,0x3eb263ef,0x3f187fc0,0x3eff17b2,0x3ec9b953,0x3e919ddd
.long 0x3f0e39da,0x3ee63375,0x3eac7cd4,0x3e605c13,0x3f039c3d,0x3ecc9b8b,0x3e8e9a22,0x3e1c76de
.long 0x3ef15aea,0x3eb263ef,0x3e605c13,0x3dafb680,0x3edae880,0x3e97a117,0x3e22abb6,0x3c96c9b6
.long 0x3ec3ef15,0x3e78cfcc,0x3dc8bd36,0xbd48fb30,0x3eac7cd4,0x3e419b37,0x3d16c32c,0xbdee3876
.long 0x3e94a031,0x3e09cf86,0xbcc90ab0,0xbe3b6ecf,0x3e78cfcc,0x3da3308c,0xbdafb680,0xbe7ee6e1
.long 0x3e47c5c2,0x3cc90ab0,0xbe164083,0xbea09ae5,0x3e164083,0xbcfb49ba,0xbe541501,0xbec1071e
.long 0x3dc8bd36,0xbdafb680,0xbe888e93,0xbee0924f,0x3d48fb30,0xbe1008b7,0xbea68f12,0xbeff17b2
.long 0x3f800000,0x3f800000,0x3f800000,0x3f800000,0x3f7f4e6d,0x3f7f2f9d,0x3f7f0e58,0x3f7eea9d
.long 0x3f7d3aac,0x3f7cbfc9,0x3f7c3b28,0x3f7baccd,0x3f79c79d,0x3f78b47b,0x3f778bc5,0x3f764d97
.long 0x3f74fa0b,0x3f731447,0x3f710908,0x3f6ed89e,0x3f6ed89e,0x3f6be858,0x3f68bf3c,0x3f655e0b
.long 0x3f676bd8,0x3f633c5a,0x3f5ebe05,0x3f59f26a,0x3f5ebe05,0x3f591e6a,0x3f531849,0x3f4cae79
.long 0x3f54db31,0x3f4d9f02,0x3f45e403,0x3f3daef9,0x3f49d112,0x3f40d0da,0x3f373a23,0x3f2d1469
.long 0x3f3daef9,0x3f32c8c9,0x3f273656,0x3f1b02c6,0x3f3085bb,0x3f239da9,0x3f15f6d9,0x3f07a136
.long 0x3f226799,0x3f13682a,0x3f039c3d,0x3ee63375,0x3f13682a,0x3f0242b1,0x3ee0924f,0x3ebb31a0
.long 0x3f039c3d,0x3ee0924f,0x3eb8442a,0x3e8e9a22,0x3ee63375,0x3ebb31a0,0x3e8e9a22,0x3e419b37
.long 0x3ec3ef15,0x3e94a031,0x3e47c5c2,0x3dc8bd36,0x3ea09ae5,0x3e5a3997,0x3de1bc2e,0x3bc90f88
.long 0x3e78cfcc,0x3e09cf86,0x3cc90ab0,0xbdafb680,0x3e2f10a2,0x3d621469,0xbd7b2b74,0xbe354098
.long 0x3dc8bd36,0xbcc90ab0,0xbe164083,0xbe888e93,0x3cc90ab0,0xbdd53db9,0xbe6c9a7f,0xbeb554ec
.long 0xbd48fb30,0xbe3b6ecf,0xbea09ae5,0xbee0924f,0xbdfab273,0xbe8586ce,0xbec9b953,0xbf04f484
.long 0xbe47c5c2,0xbeac7cd4,0xbef15aea,0xbf187fc0,0xbe888e93,0xbed25a09,0xbf0b9a6b,0xbf2ac082
.long 0xbeac7cd4,0xbef6e0cb,0xbf1d7fd1,0xbf3b8f3b,0xbecf7bca,0xbf0cead0,0xbf2e3bde,0xbf4ac77f
.long 0xbef15aea,0xbf1d7fd1,0xbf3daef9,0xbf584853,0xbf08f59b,0xbf2d1469,0xbf4bbbf8,0xbf63f473
.long 0xbf187fc0,0xbf3b8f3b,0xbf584853,0xbf6db293,0xbf273656,0xbf48d8b3,0xbf633c5a,0xbf756d97
.long 0x3f800000,0x3f800000,0x3f800000,0x3f800000,0x3f7ec46d,0x3f7e9bc9,0x3f7e70b0,0x3f7e4323
.long 0x3f7b14be,0x3f7a7302,0x3f79c79d,0x3f791298,0x3f74fa0b,0x3f73913f,0x3f721352,0x3f708066
.long 0x3f6c835e,0x3f6a09a7,0x3f676bd8,0x3f64aa59,0x3f61c598,0x3f5df6be,0x3f59f26a,0x3f55b993
.long 0x3f54db31,0x3f4f7a1f,0x3f49d112,0x3f43e200,0x3f45e403,0x3f3ebc1b,0x3f373a23,0x3f2f61a5
.long 0x3f3504f3,0x3f2beb4a,0x3f226799,0x3f187fc0,0x3f226799,0x3f173c07,0x3f0b9a6b,0x3eff17b2
.long 0x3f0e39da,0x3f00e7e4,0x3ee63375,0x3ec9b953,0x3ef15aea,0x3ed25a09,0x3eb263ef,0x3e919ddd
.long 0x3ec3ef15,0x3ea09ae5,0x3e78cfcc,0x3e2f10a2,0x3e94a031,0x3e5a3997,0x3e09cf86,0x3d621469
.long 0x3e47c5c2,0x3de1bc2e,0x3cc90ab0,0xbd7b2b74,0x3dc8bd36,0x3bc90f88,0xbdafb680,0xbe354098
.long 0x248d3132,0xbdc8bd36,0xbe47c5c2,0xbe94a031,0xbdc8bd36,0xbe4dee60,0xbe9aa086,0xbecc9b8b
.long 0xbe47c5c2,0xbe9aa086,0xbecf7bca,0xbf00e7e4,0xbe94a031,0xbecc9b8b,0xbf00e7e4,0xbf19c200
.long 0xbec3ef15,0xbefc5d27,0xbf187fc0,0xbf3085bb,0xbef15aea,0xbf14b039,0xbf2e3bde,0xbf44e3f5
.long 0xbf0e39da,0xbf299415,0xbf41d870,0xbf5695e5,0xbf226799,0xbf3ca003,0xbf531849,0xbf655e0b
.long 0xbf3504f3,0xbf4d9f02,0xbf61c598,0xbf710908,0xbf45e403,0xbf5c61c7,0xbf6db293,0xbf796e4e
.long 0xbf54db31,0xbf68bf3c,0xbf76ba07,0xbf7e70b0,0xbf61c598,0xbf7294f8,0xbf7cbfc9,0xbf7ffec4
.long 0xbf6c835e,0xbf79c79d,0xbf7fb10f,0xbf7e1324,0xbf74fa0b,0xbf7e4323,0xbf7f84ab,0xbf78b47b
.long 0xbf7b14be,0xbf7ffb11,0xbf7c3b28,0xbf6ff573,0xbf7ec46d,0xbf7eea9d,0xbf75dec6,0xbf63f473
.long 0x3f800000,0x3f800000,0x3f800000,0x3f800000,0x3f7e1324,0x3f7de0b1,0x3f7dabcc,0x3f7d7474
.long 0x3f7853f8,0x3f778bc5,0x3f76ba07,0x3f75dec6,0x3f6ed89e,0x3f6d1c1d,0x3f6b4b0c,0x3f696591
.long 0x3f61c598,0x3f5ebe05,0x3f5b941a,0x3f584853,0x3f514d3d,0x3f4cae79,0x3f47de65,0x3f42de29
.long 0x3f3daef9,0x3f373a23,0x3f3085bb,0x3f299415,0x3f273656,0x3f1ebc12,0x3f15f6d9,0x3f0cead0
.long 0x3f0e39da,0x3f039c3d,0x3ef15aea,0x3edae880,0x3ee63375,0x3ecc9b8b,0x3eb263ef,0x3e97a117
.long 0x3eac7cd4,0x3e8e9a22,0x3e605c13,0x3e22abb6,0x3e605c13,0x3e1c76de,0x3dafb680,0x3c96c9b6
.long 0x3dc8bd36,0x3cc90ab0,0xbd48fb30,0xbdfab273,0xbcc90ab0,0xbdd53db9,0xbe3b6ecf,0xbe8586ce
.long 0xbe164083,0xbe6c9a7f,0xbea09ae5,0xbec9b953,0xbe888e93,0xbeb554ec,0xbee0924f,0xbf04f484
.long 0xbec3ef15,0xbef15aea,0xbf0e39da,0xbf226799,0xbefc5d27,0xbf14b039,0xbf299415,0xbf3ca003
.long 0xbf187fc0,0xbf2e3bde,0xbf41d870,0xbf531849,0xbf3085bb,0xbf44e3f5,0xbf5695e5,0xbf655e0b
.long 0xbf45e403,0xbf584853,0xbf676bd8,0xbf731447,0xbf584853,0xbf6816a8,0xbf740bdd,0xbf7bf531
.long 0xbf676bd8,0xbf740bdd,0xbf7c3b28,0xbf7fd397,0xbf731447,0xbf7bf531,0xbf7fd397,0xbf7e9bc9
.long 0xbf7b14be,0xbf7fb10f,0xbf7ec46d,0xbf7853f8,0xbf7f4e6d,0xbf7f2f9d,0xbf791298,0xbf6d1c1d
.long 0xbf7fb10f,0xbf7a7302,0xbf6ed89e,0xbf5d2d53,0xbf7c3b28,0xbf718f57,0xbf604621,0xbf48d8b3
.long 0xbf74fa0b,0xbf64aa59,0xbf4d9f02,0xbf3085bb,0xbf6a09a7,0xbf53fac3,0xbf373a23,0xbf14b039
.long 0xbf5b941a,0xbf3fc767,0xbf1d7fd1,0xbeebcbbb,0xbf49d112,0xbf286605,0xbf00e7e4,0xbea986c4
.long 0x3f800000,0x3f800000,0x3f800000,0x3f800000,0x3f7d3aac,0x3f7cfe73,0x3f7cbfc9,0x3f7c7eb0
.long 0x3f74fa0b,0x3f740bdd,0x3f731447,0x3f721352,0x3f676bd8,0x3f655e0b,0x3f633c5a,0x3f6106f2
.long 0x3f54db31,0x3f514d3d,0x3f4d9f02,0x3f49d112,0x3f3daef9,0x3f385216,0x3f32c8c9,0x3f2d1469
.long 0x3f226799,0x3f1b02c6,0x3f13682a,0x3f0b9a6b,0x3f039c3d,0x3ef41f07,0x3ee0924f,0x3ecc9b8b
.long 0x3ec3ef15,0x3eac7cd4,0x3e94a031,0x3e78cfcc,0x3e78cfcc,0x3e419b37,0x3e09cf86,0x3da3308c
.long 0x3dc8bd36,0x3d16c32c,0xbcc90ab0,0xbdafb680,0xbd48fb30,0xbdee3876,0xbe3b6ecf,0xbe7ee6e1
.long 0xbe47c5c2,0xbe888e93,0xbeac7cd4,0xbecf7bca,0xbeac7cd4,0xbed25a09,0xbef6e0cb,0xbf0cead0
.long 0xbef15aea,0xbf0b9a6b,0xbf1d7fd1,0xbf2e3bde,0xbf187fc0,0xbf2ac082,0xbf3b8f3b,0xbf4ac77f
.long 0xbf3504f3,0xbf45e403,0xbf54db31,0xbf61c598,0xbf4d9f02,0xbf5c61c7,0xbf68bf3c,0xbf7294f8
.long 0xbf61c598,0xbf6db293,0xbf76ba07,0xbf7cbfc9,0xbf710908,0xbf796e4e,0xbf7e70b0,0xbf7ffec4
.long 0xbf7b14be,0xbf7f4e6d,0xbf7fb10f,0xbf7c3b28,0xbf7fb10f,0xbf7f2f9d,0xbf7a7302,0xbf718f57
.long 0xbf7ec46d,0xbf791298,0xbf6ed89e,0xbf604621,0xbf7853f8,0xbf6d1c1d,0xbf5d2d53,0xbf48d8b3
.long 0xbf6c835e,0xbf5b941a,0xbf45e403,0xbf2beb4a,0xbf5b941a,0xbf44e3f5,0xbf299415,0xbf0a48ad
.long 0xbf45e403,0xbf299415,0xbf08f59b,0xbec9b953,0xbf2beb4a,0xbf0a48ad,0xbec9b953,0xbe72b651
.long 0xbf0e39da,0xbecf7bca,0xbe78cfcc,0xbd96a905,0xbedae880,0xbe8586ce,0xbdafb680,0x3dbc3ac3
.long 0xbe94a031,0xbde1bc2e,0x3d96a905,0x3e827dc0,0xbe164083,0x3d2fe007,0x3e6c9a7f,0x3ed25a09
.long 0x3f800000,0x3f800000,0x3f800000,0x3f800000,0x3f7c3b28,0x3f7bf531,0x3f7baccd,0x3f7b61fc
.long 0x3f710908,0x3f6ff573,0x3f6ed89e,0x3f6db293,0x3f5ebe05,0x3f5c61c7,0x3f59f26a,0x3f577026
.long 0x3f45e403,0x3f41d870,0x3f3daef9,0x3f396842,0x3f273656,0x3f212ff9,0x3f1b02c6,0x3f14b039
.long 0x3f039c3d,0x3ef6e0cb,0x3ee63375,0x3ed53641,0x3eb8442a,0x3ea395c5,0x3e8e9a22,0x3e72b651
.long 0x3e47c5c2,0x3e164083,0x3dc8bd36,0x3d48fb30,0x3cc90ab0,0xbcfb49ba,0xbdafb680,0xbe1008b7
.long 0xbe164083,0xbe541501,0xbe888e93,0xbea68f12,0xbea09ae5,0xbec1071e,0xbee0924f,0xbeff17b2
.long 0xbef15aea,0xbf08f59b,0xbf187fc0,0xbf273656,0xbf1d7fd1,0xbf2d1469,0xbf3b8f3b,0xbf48d8b3
.long 0xbf3daef9,0xbf4bbbf8,0xbf584853,0xbf633c5a,0xbf584853,0xbf63f473,0xbf6db293,0xbf756d97
.long 0xbf6c835e,0xbf74fa0b,0xbf7b14be,0xbf7ec46d,0xbf79c79d,0xbf7e4323,0xbf7ffb11,0xbf7eea9d
.long 0xbf7fb10f,0xbf7f84ab,0xbf7c3b28,0xbf75dec6,0xbf7e1324,0xbf78b47b,0xbf6ff573,0xbf63f473
.long 0xbf74fa0b,0xbf6a09a7,0xbf5b941a,0xbf49d112,0xbf64aa59,0xbf53fac3,0xbf3fc767,0xbf286605
.long 0xbf4d9f02,0xbf373a23,0xbf1d7fd1,0xbf00e7e4,0xbf3085bb,0xbf14b039,0xbeebcbbb,0xbea986c4
.long 0xbf0e39da,0xbedae880,0xbe94a031,0xbe164083,0xbecf7bca,0xbe8586ce,0xbde1bc2e,0x3d2fe007
.long 0xbe78cfcc,0xbdafb680,0x3d96a905,0x3e6c9a7f,0xbd96a905,0x3dbc3ac3,0x3e827dc0,0x3ed25a09
.long 0x3dc8bd36,0x3e888e93,0x3edae880,0x3f13682a,0x3e888e93,0x3eddbe79,0x3f15f6d9,0x3f385216
.long 0x3edae880,0x3f15f6d9,0x3f396842,0x3f5695e5,0x3f13682a,0x3f385216,0x3f5695e5,0x3f6d1c1d
.long 0x0,0x0,0x0,0x0,0x0,0x3bc90f88,0x3c490e90,0x3c96c9b6
.long 0x0,0x3c490e90,0x3cc90ab0,0x3d16c32c,0x0,0x3c96c9b6,0x3d16c32c,0x3d621469
.long 0x0,0x3cc90ab0,0x3d48fb30,0x3d96a905,0x0,0x3cfb49ba,0x3d7b2b74,0x3dbc3ac3
.long 0x0,0x3d16c32c,0x3d96a905,0x3de1bc2e,0x0,0x3d2fe007,0x3dafb680,0x3e039502
.long 0x0,0x3d48fb30,0x3dc8bd36,0x3e164083,0x0,0x3d621469,0x3de1bc2e,0x3e28defc
.long 0x0,0x3d7b2b74,0x3dfab273,0x3e3b6ecf,0x0,0x3d8a200a,0x3e09cf86,0x3e4dee60
.long 0x0,0x3d96a905,0x3e164083,0x3e605c13,0x0,0x3da3308c,0x3e22abb6,0x3e72b651
.long 0x0,0x3dafb680,0x3e2f10a2,0x3e827dc0,0x0,0x3dbc3ac3,0x3e3b6ecf,0x3e8b9507
.long 0x0,0x3dc8bd36,0x3e47c5c2,0x3e94a031,0x0,0x3dd53db9,0x3e541501,0x3e9d9e78
.long 0x0,0x3de1bc2e,0x3e605c13,0x3ea68f12,0x0,0x3dee3876,0x3e6c9a7f,0x3eaf713a
.long 0x0,0x3dfab273,0x3e78cfcc,0x3eb8442a,0x0,0x3e039502,0x3e827dc0,0x3ec1071e
.long 0x0,0x3e09cf86,0x3e888e93,0x3ec9b953,0x0,0x3e1008b7,0x3e8e9a22,0x3ed25a09
.long 0x0,0x3e164083,0x3e94a031,0x3edae880,0x0,0x3e1c76de,0x3e9aa086,0x3ee363fa
.long 0x0,0x3e22abb6,0x3ea09ae5,0x3eebcbbb,0x0,0x3e28defc,0x3ea68f12,0x3ef41f07
.long 0x0,0x3e2f10a2,0x3eac7cd4,0x3efc5d27,0x0,0x3e354098,0x3eb263ef,0x3f0242b1
.long 0x0,0x3e3b6ecf,0x3eb8442a,0x3f064b82,0x0,0x3e419b37,0x3ebe1d4a,0x3f0a48ad
.long 0x0,0x0,0x0,0x0,0x3cc90ab0,0x3cfb49ba,0x3d16c32c,0x3d2fe007
.long 0x3d48fb30,0x3d7b2b74,0x3d96a905,0x3dafb680,0x3d96a905,0x3dbc3ac3,0x3de1bc2e,0x3e039502
.long 0x3dc8bd36,0x3dfab273,0x3e164083,0x3e2f10a2,0x3dfab273,0x3e1c76de,0x3e3b6ecf,0x3e5a3997
.long 0x3e164083,0x3e3b6ecf,0x3e605c13,0x3e827dc0,0x3e2f10a2,0x3e5a3997,0x3e827dc0,0x3e97a117
.long 0x3e47c5c2,0x3e78cfcc,0x3e94a031,0x3eac7cd4,0x3e605c13,0x3e8b9507,0x3ea68f12,0x3ec1071e
.long 0x3e78cfcc,0x3e9aa086,0x3eb8442a,0x3ed53641,0x3e888e93,0x3ea986c4,0x3ec9b953,0x3ee900b7
.long 0x3e94a031,0x3eb8442a,0x3edae880,0x3efc5d27,0x3ea09ae5,0x3ec6d529,0x3eebcbbb,0x3f07a136
.long 0x3eac7cd4,0x3ed53641,0x3efc5d27,0x3f10d3cd,0x3eb8442a,0x3ee363fa,0x3f064b82,0x3f19c200
.long 0x3ec3ef15,0x3ef15aea,0x3f0e39da,0x3f226799,0x3ecf7bca,0x3eff17b2,0x3f15f6d9,0x3f2ac082
.long 0x3edae880,0x3f064b82,0x3f1d7fd1,0x3f32c8c9,0x3ee63375,0x3f0cead0,0x3f24d225,0x3f3a7ca4
.long 0x3ef15aea,0x3f13682a,0x3f2beb4a,0x3f41d870,0x3efc5d27,0x3f19c200,0x3f32c8c9,0x3f48d8b3
.long 0x3f039c3d,0x3f1ff6cb,0x3f396842,0x3f4f7a1f,0x3f08f59b,0x3f26050a,0x3f3fc767,0x3f55b993
.long 0x3f0e39da,0x3f2beb4a,0x3f45e403,0x3f5b941a,0x3f13682a,0x3f31a81d,0x3f4bbbf8,0x3f6106f2
.long 0x3f187fc0,0x3f373a23,0x3f514d3d,0x3f660f88,0x3f1d7fd1,0x3f3ca003,0x3f5695e5,0x3f6aab7b
.long 0x3f226799,0x3f41d870,0x3f5b941a,0x3f6ed89e,0x3f273656,0x3f46e22a,0x3f604621,0x3f7294f8
.long 0x3f2beb4a,0x3f4bbbf8,0x3f64aa59,0x3f75dec6,0x3f3085bb,0x3f5064af,0x3f68bf3c,0x3f78b47b
.long 0x0,0x0,0x0,0x0,0x3d48fb30,0x3d621469,0x3d7b2b74,0x3d8a200a
.long 0x3dc8bd36,0x3de1bc2e,0x3dfab273,0x3e09cf86,0x3e164083,0x3e28defc,0x3e3b6ecf,0x3e4dee60
.long 0x3e47c5c2,0x3e605c13,0x3e78cfcc,0x3e888e93,0x3e78cfcc,0x3e8b9507,0x3e9aa086,0x3ea986c4
.long 0x3e94a031,0x3ea68f12,0x3eb8442a,0x3ec9b953,0x3eac7cd4,0x3ec1071e,0x3ed53641,0x3ee900b7
.long 0x3ec3ef15,0x3edae880,0x3ef15aea,0x3f039c3d,0x3edae880,0x3ef41f07,0x3f064b82,0x3f121eb0
.long 0x3ef15aea,0x3f064b82,0x3f13682a,0x3f1ff6cb,0x3f039c3d,0x3f121eb0,0x3f1ff6cb,0x3f2d1469
.long 0x3f0e39da,0x3f1d7fd1,0x3f2beb4a,0x3f396842,0x3f187fc0,0x3f286605,0x3f373a23,0x3f44e3f5
.long 0x3f226799,0x3f32c8c9,0x3f41d870,0x3f4f7a1f,0x3f2beb4a,0x3f3ca003,0x3f4bbbf8,0x3f591e6a
.long 0x3f3504f3,0x3f45e403,0x3f54db31,0x3f61c598,0x3f3daef9,0x3f4e8d90,0x3f5d2d53,0x3f696591
.long 0x3f45e403,0x3f5695e5,0x3f64aa59,0x3f6ff573,0x3f4d9f02,0x3f5df6be,0x3f6b4b0c,0x3f756d97
.long 0x3f54db31,0x3f64aa59,0x3f710908,0x3f79c79d,0x3f5b941a,0x3f6aab7b,0x3f75dec6,0x3f7cfe73
.long 0x3f61c598,0x3f6ff573,0x3f79c79d,0x3f7f0e58,0x3f676bd8,0x3f748422,0x3f7cbfc9,0x3f7ff4e6
.long 0x3f6c835e,0x3f7853f8,0x3f7ec46d,0x3f7fb10f,0x3f710908,0x3f7b61fc,0x3f7fd397,0x3f7e4323
.long 0x3f74fa0b,0x3f7dabcc,0x3f7fec43,0x3f7baccd,0x3f7853f8,0x3f7f2f9d,0x3f7f0e58,0x3f77f110
.long 0x3f7b14be,0x3f7fec43,0x3f7d3aac,0x3f731447,0x3f7d3aac,0x3f7fe129,0x3f7a7302,0x3f6d1c1d
.long 0x3f7ec46d,0x3f7f0e58,0x3f76ba07,0x3f660f88,0x3f7fb10f,0x3f7d7474,0x3f721352,0x3f5df6be
.long 0x0,0x0,0x0,0x0,0x3d96a905,0x3da3308c,0x3dafb680,0x3dbc3ac3
.long 0x3e164083,0x3e22abb6,0x3e2f10a2,0x3e3b6ecf,0x3e605c13,0x3e72b651,0x3e827dc0,0x3e8b9507
.long 0x3e94a031,0x3ea09ae5,0x3eac7cd4,0x3eb8442a,0x3eb8442a,0x3ec6d529,0x3ed53641,0x3ee363fa
.long 0x3edae880,0x3eebcbbb,0x3efc5d27,0x3f064b82,0x3efc5d27,0x3f07a136,0x3f10d3cd,0x3f19c200
.long 0x3f0e39da,0x3f187fc0,0x3f226799,0x3f2beb4a,0x3f1d7fd1,0x3f286605,0x3f32c8c9,0x3f3ca003
.long 0x3f2beb4a,0x3f373a23,0x3f41d870,0x3f4bbbf8,0x3f396842,0x3f44e3f5,0x3f4f7a1f,0x3f591e6a
.long 0x3f45e403,0x3f514d3d,0x3f5b941a,0x3f64aa59,0x3f514d3d,0x3f5c61c7,0x3f660f88,0x3f6e46be
.long 0x3f5b941a,0x3f660f88,0x3f6ed89e,0x3f75dec6,0x3f64aa59,0x3f6e46be,0x3f75dec6,0x3f7b61fc
.long 0x3f6c835e,0x3f74fa0b,0x3f7b14be,0x3f7ec46d,0x3f731447,0x3f7a1e84,0x3f7e70b0,0x3f7ffec4
.long 0x3f7853f8,0x3f7dabcc,0x3f7fec43,0x3f7f0e58,0x3f7c3b28,0x3f7f9c18,0x3f7f84ab,0x3f7bf531
.long 0x3f7ec46d,0x3f7fec43,0x3f7d3aac,0x3f76ba07,0x3f7fec43,0x3f7e9bc9,0x3f791298,0x3f6f6830
.long 0x3f7fb10f,0x3f7baccd,0x3f731447,0x3f660f88,0x3f7e1324,0x3f772417,0x3f6b4b0c,0x3f5ac450
.long 0x3f7b14be,0x3f710908,0x3f61c598,0x3f4d9f02,0x3f76ba07,0x3f696591,0x3f5695e5,0x3f3ebc1b
.long 0x3f710908,0x3f604621,0x3f49d112,0x3f2e3bde,0x3f6a09a7,0x3f55b993,0x3f3b8f3b,0x3f1c420c
.long 0x3f61c598,0x3f49d112,0x3f2beb4a,0x3f08f59b,0x3f584853,0x3f3ca003,0x3f1b02c6,0x3ee900b7
.long 0x3f4d9f02,0x3f2e3bde,0x3f08f59b,0x3ebe1d4a,0x3f41d870,0x3f1ebc12,0x3eebcbbb,0x3e919ddd
.long 0x0,0x0,0x0,0x0,0x3dc8bd36,0x3dd53db9,0x3de1bc2e,0x3dee3876
.long 0x3e47c5c2,0x3e541501,0x3e605c13,0x3e6c9a7f,0x3e94a031,0x3e9d9e78,0x3ea68f12,0x3eaf713a
.long 0x3ec3ef15,0x3ecf7bca,0x3edae880,0x3ee63375,0x3ef15aea,0x3eff17b2,0x3f064b82,0x3f0cead0
.long 0x3f0e39da,0x3f15f6d9,0x3f1d7fd1,0x3f24d225,0x3f226799,0x3f2ac082,0x3f32c8c9,0x3f3a7ca4
.long 0x3f3504f3,0x3f3daef9,0x3f45e403,0x3f4d9f02,0x3f45e403,0x3f4e8d90,0x3f5695e5,0x3f5df6be
.long 0x3f54db31,0x3f5d2d53,0x3f64aa59,0x3f6b4b0c,0x3f61c598,0x3f696591,0x3f6ff573,0x3f756d97
.long 0x3f6c835e,0x3f731447,0x3f7853f8,0x3f7c3b28,0x3f74fa0b,0x3f7a1e84,0x3f7dabcc,0x3f7f9c18
.long 0x3f7b14be,0x3f7e70b0,0x3f7fec43,0x3f7f84ab,0x3f7ec46d,0x3f7ffec4,0x3f7f0e58,0x3f7bf531
.long 0x3f800000,0x3f7ec46d,0x3f7b14be,0x3f74fa0b,0x3f7ec46d,0x3f7ac516,0x3f740bdd,0x3f6aab7b
.long 0x3f7b14be,0x3f740bdd,0x3f6a09a7,0x3f5d2d53,0x3f74fa0b,0x3f6aab7b,0x3f5d2d53,0x3f4cae79
.long 0x3f6c835e,0x3f5ebe05,0x3f4d9f02,0x3f396842,0x3f61c598,0x3f5064af,0x3f3b8f3b,0x3f239da9
.long 0x3f54db31,0x3f3fc767,0x3f273656,0x3f0b9a6b,0x3f45e403,0x3f2d1469,0x3f10d3cd,0x3ee363fa
.long 0x3f3504f3,0x3f187fc0,0x3ef15aea,0x3eac7cd4,0x3f226799,0x3f0242b1,0x3ebe1d4a,0x3e667c66
.long 0x3f0e39da,0x3ed53641,0x3e888e93,0x3de1bc2e,0x3ef15aea,0x3ea395c5,0x3e22abb6,0xbbc90f88
.long 0x3ec3ef15,0x3e605c13,0x3d48fb30,0xbdfab273,0x3e94a031,0x3dee3876,0xbd7b2b74,0xbe72b651
.long 0x3e47c5c2,0x3c490e90,0xbe2f10a2,0xbeb263ef,0x3dc8bd36,0xbdbc3ac3,0xbe8e9a22,0xbee900b7
.long 0x0,0x0,0x0,0x0,0x3dfab273,0x3e039502,0x3e09cf86,0x3e1008b7
.long 0x3e78cfcc,0x3e827dc0,0x3e888e93,0x3e8e9a22,0x3eb8442a,0x3ec1071e,0x3ec9b953,0x3ed25a09
.long 0x3ef15aea,0x3efc5d27,0x3f039c3d,0x3f08f59b,0x3f13682a,0x3f19c200,0x3f1ff6cb,0x3f26050a
.long 0x3f2beb4a,0x3f32c8c9,0x3f396842,0x3f3fc767,0x3f41d870,0x3f48d8b3,0x3f4f7a1f,0x3f55b993
.long 0x3f54db31,0x3f5b941a,0x3f61c598,0x3f676bd8,0x3f64aa59,0x3f6aab7b,0x3f6ff573,0x3f748422
.long 0x3f710908,0x3f75dec6,0x3f79c79d,0x3f7cbfc9,0x3f79c79d,0x3f7cfe73,0x3f7f0e58,0x3f7ff4e6
.long 0x3f7ec46d,0x3f7fec43,0x3f7fb10f,0x3f7e1324,0x3f7fec43,0x3f7e9bc9,0x3f7baccd,0x3f772417
.long 0x3f7d3aac,0x3f791298,0x3f731447,0x3f6b4b0c,0x3f76ba07,0x3f6f6830,0x3f660f88,0x3f5ac450
.long 0x3f6c835e,0x3f61c598,0x3f54db31,0x3f45e403,0x3f5ebe05,0x3f5064af,0x3f3fc767,0x3f2d1469
.long 0x3f4d9f02,0x3f3b8f3b,0x3f273656,0x3f10d3cd,0x3f396842,0x3f239da9,0x3f0b9a6b,0x3ee363fa
.long 0x3f226799,0x3f08f59b,0x3edae880,0x3ea09ae5,0x3f08f59b,0x3ed8106b,0x3e9aa086,0x3e354098
.long 0x3edae880,0x3e9aa086,0x3e2f10a2,0x3d16c32c,0x3ea09ae5,0x3e354098,0x3d16c32c,0xbdd53db9
.long 0x3e47c5c2,0x3d48fb30,0xbdc8bd36,0xbe78cfcc,0x3d96a905,0xbda3308c,0xbe6c9a7f,0xbec1071e
.long 0xbd48fb30,0xbe541501,0xbeb8442a,0xbf00e7e4,0xbe2f10a2,0xbea986c4,0xbef6e0cb,0xbf1ebc12
.long 0xbe94a031,0xbee63375,0xbf187fc0,0xbf396842,0xbecf7bca,0xbf0f8784,0xbf32c8c9,0xbf5064af
.long 0xbf039c3d,0xbf299415,0xbf49d112,0xbf633c5a,0xbf1d7fd1,0xbf40d0da,0xbf5d2d53,0xbf718f57
.long 0x0,0x0,0x0,0x0,0x3e164083,0x3e1c76de,0x3e22abb6,0x3e28defc
.long 0x3e94a031,0x3e9aa086,0x3ea09ae5,0x3ea68f12,0x3edae880,0x3ee363fa,0x3eebcbbb,0x3ef41f07
.long 0x3f0e39da,0x3f13682a,0x3f187fc0,0x3f1d7fd1,0x3f2beb4a,0x3f31a81d,0x3f373a23,0x3f3ca003
.long 0x3f45e403,0x3f4bbbf8,0x3f514d3d,0x3f5695e5,0x3f5b941a,0x3f6106f2,0x3f660f88,0x3f6aab7b
.long 0x3f6c835e,0x3f710908,0x3f74fa0b,0x3f7853f8,0x3f7853f8,0x3f7b61fc,0x3f7dabcc,0x3f7f2f9d
.long 0x3f7ec46d,0x3f7fd397,0x3f7fec43,0x3f7f0e58,0x3f7fb10f,0x3f7e4323,0x3f7baccd,0x3f77f110
.long 0x3f7b14be,0x3f76ba07,0x3f710908,0x3f6a09a7,0x3f710908,0x3f696591,0x3f604621,0x3f55b993
.long 0x3f61c598,0x3f5695e5,0x3f49d112,0x3f3b8f3b,0x3f4d9f02,0x3f3ebc1b,0x3f2e3bde,0x3f1c420c
.long 0x3f3504f3,0x3f226799,0x3f0e39da,0x3ef15aea,0x3f187fc0,0x3f0242b1,0x3ed53641,0x3ea395c5
.long 0x3ef15aea,0x3ebe1d4a,0x3e888e93,0x3e22abb6,0x3eac7cd4,0x3e667c66,0x3de1bc2e,0xbbc90f88
.long 0x3e47c5c2,0x3d96a905,0xbd48fb30,0xbe2f10a2,0x3d48fb30,0xbda3308c,0xbe541501,0xbea986c4
.long 0xbdc8bd36,0xbe6c9a7f,0xbeb8442a,0xbef6e0cb,0xbe78cfcc,0xbec1071e,0xbf00e7e4,0xbf1ebc12
.long 0xbec3ef15,0xbf039c3d,0xbf226799,0xbf3daef9,0xbf039c3d,0xbf239da9,0xbf3fc767,0xbf577026
.long 0xbf226799,0xbf3fc767,0xbf584853,0xbf6b4b0c,0xbf3daef9,0xbf577026,0xbf6b4b0c,0xbf78b47b
.long 0xbf54db31,0xbf6a09a7,0xbf7853f8,0xbf7f4e6d,0xbf676bd8,0xbf772417,0xbf7f0e58,0xbf7eea9d
.long 0xbf74fa0b,0xbf7e70b0,0xbf7f4e6d,0xbf778bc5,0xbf7d3aac,0xbf7fc38f,0xbf791298,0xbf696591
.long 0x0,0x0,0x0,0x0,0x3e2f10a2,0x3e354098,0x3e3b6ecf,0x3e419b37
.long 0x3eac7cd4,0x3eb263ef,0x3eb8442a,0x3ebe1d4a,0x3efc5d27,0x3f0242b1,0x3f064b82,0x3f0a48ad
.long 0x3f226799,0x3f273656,0x3f2beb4a,0x3f3085bb,0x3f41d870,0x3f46e22a,0x3f4bbbf8,0x3f5064af
.long 0x3f5b941a,0x3f604621,0x3f64aa59,0x3f68bf3c,0x3f6ed89e,0x3f7294f8,0x3f75dec6,0x3f78b47b
.long 0x3f7b14be,0x3f7d3aac,0x3f7ec46d,0x3f7fb10f,0x3f7fec43,0x3f7fe129,0x3f7f0e58,0x3f7d7474
.long 0x3f7d3aac,0x3f7a7302,0x3f76ba07,0x3f721352,0x3f731447,0x3f6d1c1d,0x3f660f88,0x3f5df6be
.long 0x3f61c598,0x3f584853,0x3f4d9f02,0x3f41d870,0x3f49d112,0x3f3ca003,0x3f2e3bde,0x3f1ebc12
.long 0x3f2beb4a,0x3f1b02c6,0x3f08f59b,0x3eebcbbb,0x3f08f59b,0x3ee900b7,0x3ebe1d4a,0x3e919ddd
.long 0x3ec3ef15,0x3e94a031,0x3e47c5c2,0x3dc8bd36,0x3e605c13,0x3dee3876,0x3c490e90,0xbdbc3ac3
.long 0x3d48fb30,0xbd7b2b74,0xbe2f10a2,0xbe8e9a22,0xbdfab273,0xbe72b651,0xbeb263ef,0xbee900b7
.long 0xbe94a031,0xbecf7bca,0xbf039c3d,0xbf1d7fd1,0xbee63375,0xbf0f8784,0xbf299415,0xbf40d0da
.long 0xbf187fc0,0xbf32c8c9,0xbf49d112,0xbf5d2d53,0xbf396842,0xbf5064af,0xbf633c5a,0xbf718f57
.long 0xbf54db31,0xbf676bd8,0xbf74fa0b,0xbf7d3aac,0xbf6a09a7,0xbf772417,0xbf7e70b0,0xbf7fc38f
.long 0xbf7853f8,0xbf7f0e58,0xbf7f4e6d,0xbf791298,0xbf7f4e6d,0xbf7eea9d,0xbf778bc5,0xbf696591
.long 0xbf7ec46d,0xbf76ba07,0xbf676bd8,0xbf514d3d,0xbf76ba07,0xbf66becc,0xbf4f7a1f,0xbf31a81d
.long 0xbf676bd8,0xbf4f7a1f,0xbf3085bb,0xbf0b9a6b,0xbf514d3d,0xbf31a81d,0xbf0b9a6b,0xbec1071e
.long 0x3f803f80,0x3f803f80,0x3f803f80,0x3f803f80,0x248d248d,0x248d248d,0x248d248d,0x248d248d
.long 0x3f7b3f80,0x3f553f6d,0xbe48248d,0xbf0ebec4,0xbe48248d,0xbf0ebec4,0xbf7bbf80,0xbf55bf6d
.long 0x3f6d3f80,0x3ec43f35,0xbf6dbf80,0xbec4bf35,0xbec4248d,0xbf6dbf35,0x3ec4a554,0x3f6d3f35
.long 0x3f553f80,0xbe483ec4,0x3f0ea554,0x3f7b3f6d,0xbf0e248d,0xbf7bbf6d,0x3f553f80,0xbe483ec4
.long 0x3f353f80,0xbf35248d,0x3f353f80,0xbf35248d,0xbf35248d,0xbf35bf80,0xbf35248d,0xbf35bf80
.long 0x3f0e3f80,0xbf7bbec4,0xbf55248d,0xbe48bf6d,0xbf55248d,0xbe48bf6d,0xbf0ebf80,0x3f7b3ec4
.long 0x3ec43f80,0xbf6dbf35,0xbec4bf80,0x3f6d3f35,0xbf6d248d,0x3ec4bf35,0x3f6da554,0xbec43f35
.long 0x3e483f80,0xbf0ebf6d,0x3f7ba554,0xbf553ec4,0xbf7b248d,0x3f55bec4,0x3e483f80,0xbf0ebf6d
.long 0x248d3f80,0xa554bf80,0x248d3f80,0xa554bf80,0xbf80248d,0x3f80a554,0xbf80248d,0x3f80a554
.long 0xbe483f80,0x3f0ebf6d,0xbf7b248d,0x3f553ec4,0xbf7b248d,0x3f553ec4,0x3e48bf80,0xbf0e3f6d
.long 0xbec43f80,0x3f6dbf35,0x3ec4bf80,0xbf6d3f35,0xbf6d248d,0x3ec43f35,0x3f6da554,0xbec4bf35
.long 0xbf0e3f80,0x3f7bbec4,0x3f55a554,0x3e48bf6d,0xbf55248d,0xbe483f6d,0xbf0e3f80,0x3f7bbec4
.long 0xbf353f80,0x3f35a554,0xbf353f80,0x3f35a554,0xbf35248d,0xbf353f80,0xbf35248d,0xbf353f80
.long 0xbf553f80,0x3e483ec4,0xbf0e248d,0xbf7b3f6d,0xbf0e248d,0xbf7b3f6d,0x3f55bf80,0xbe48bec4
.long 0xbf6d3f80,0xbec43f35,0x3f6dbf80,0x3ec4bf35,0xbec4248d,0xbf6d3f35,0x3ec4a554,0x3f6dbf35
.long 0xbf7b3f80,0xbf553f6d,0x3e48a554,0x3f0ebec4,0xbe48248d,0xbf0e3ec4,0xbf7b3f80,0xbf553f6d
.long 0x3f803f80,0x3f803f80,0x3f803f80,0x3f803f80,0x248d248d,0x248d248d,0x248d248d,0x248d248d
.long 0x3f0e3f35,0x3e483ec4,0xbf55bf35,0xbf7bbf6d,0xbf55bf35,0xbf7bbf6d,0xbf0ebf35,0xbe48bec4
.long 0xbec4248d,0xbf6dbf35,0x3ec4a554,0x3f6d3f35,0xbf6dbf80,0xbec4bf35,0x3f6d3f80,0x3ec43f35
.long 0xbf7bbf35,0xbf0ebf6d,0x3e483f35,0xbf55bec4,0xbe48bf35,0x3f553ec4,0xbf7bbf35,0xbf0ebf6d
.long 0xbf35bf80,0x3f35a554,0xbf35bf80,0x3f35a554,0x3f35a554,0x3f353f80,0x3f35a554,0x3f353f80
.long 0x3e48bf35,0x3f553f6d,0x3f7b3f35,0xbf0e3ec4,0x3f7b3f35,0xbf0e3ec4,0xbe483f35,0xbf55bf6d
.long 0x3f6da554,0xbec43f35,0xbf6d248d,0x3ec4bf35,0x3ec43f80,0xbf6dbf35,0xbec4bf80,0x3f6d3f35
.long 0x3f553f35,0xbf7bbec4,0x3f0ebf35,0xbe483f6d,0xbf0e3f35,0x3e48bf6d,0x3f553f35,0xbf7bbec4
.long 0x248d3f80,0xa554bf80,0x248d3f80,0xa554bf80,0xbf80248d,0x3f80a554,0xbf80248d,0x3f80a554
.long 0xbf553f35,0x3f7bbec4,0xbf0ebf35,0x3e483f6d,0xbf0ebf35,0x3e483f6d,0x3f55bf35,0xbf7b3ec4
.long 0xbf6d248d,0x3ec43f35,0x3f6da554,0xbec4bf35,0x3ec4bf80,0xbf6d3f35,0xbec43f80,0x3f6dbf35
.long 0xbe48bf35,0xbf553f6d,0xbf7b3f35,0x3f0e3ec4,0x3f7bbf35,0xbf0ebec4,0xbe48bf35,0xbf553f6d
.long 0x3f35bf80,0xbf35248d,0x3f35bf80,0xbf35248d,0x3f35a554,0x3f35bf80,0x3f35a554,0x3f35bf80
.long 0x3f7bbf35,0x3f0ebf6d,0xbe483f35,0x3f55bec4,0xbe483f35,0x3f55bec4,0xbf7b3f35,0xbf0e3f6d
.long 0x3ec4a554,0x3f6dbf35,0xbec4248d,0xbf6d3f35,0xbf6d3f80,0xbec43f35,0x3f6dbf80,0x3ec4bf35
.long 0xbf0e3f35,0xbe483ec4,0x3f55bf35,0x3f7bbf6d,0xbf553f35,0xbf7b3f6d,0xbf0e3f35,0xbe483ec4
.long 0x3f803f80,0x3f803f80,0x3f803f80,0x3f803f80,0x248d248d,0x248d248d,0x248d248d,0x248d248d
.long 0xbf7bbf80,0xbf55bf6d,0x3e48a554,0x3f0e3ec4,0x3e48a554,0x3f0e3ec4,0x3f7b3f80,0x3f553f6d
.long 0x3f6d3f80,0x3ec43f35,0xbf6dbf80,0xbec4bf35,0xbec4248d,0xbf6dbf35,0x3ec4a554,0x3f6d3f35
.long 0xbf55bf80,0x3e48bec4,0xbf0e248d,0xbf7bbf6d,0x3f0ea554,0x3f7b3f6d,0xbf55bf80,0x3e48bec4
.long 0x3f353f80,0xbf35248d,0x3f353f80,0xbf35248d,0xbf35248d,0xbf35bf80,0xbf35248d,0xbf35bf80
.long 0xbf0ebf80,0x3f7b3ec4,0x3f55a554,0x3e483f6d,0x3f55a554,0x3e483f6d,0x3f0e3f80,0xbf7bbec4
.long 0x3ec43f80,0xbf6dbf35,0xbec4bf80,0x3f6d3f35,0xbf6d248d,0x3ec4bf35,0x3f6da554,0xbec43f35
.long 0xbe48bf80,0x3f0e3f6d,0xbf7b248d,0x3f55bec4,0x3f7ba554,0xbf553ec4,0xbe48bf80,0x3f0e3f6d
.long 0x248d3f80,0xa554bf80,0x248d3f80,0xa554bf80,0xbf80248d,0x3f80a554,0xbf80248d,0x3f80a554
.long 0x3e48bf80,0xbf0e3f6d,0x3f7ba554,0xbf55bec4,0x3f7ba554,0xbf55bec4,0xbe483f80,0x3f0ebf6d
.long 0xbec43f80,0x3f6dbf35,0x3ec4bf80,0xbf6d3f35,0xbf6d248d,0x3ec43f35,0x3f6da554,0xbec4bf35
.long 0x3f0ebf80,0xbf7b3ec4,0xbf55248d,0xbe483f6d,0x3f55a554,0x3e48bf6d,0x3f0ebf80,0xbf7b3ec4
.long 0xbf353f80,0x3f35a554,0xbf353f80,0x3f35a554,0xbf35248d,0xbf353f80,0xbf35248d,0xbf353f80
.long 0x3f55bf80,0xbe48bec4,0x3f0ea554,0x3f7bbf6d,0x3f0ea554,0x3f7bbf6d,0xbf553f80,0x3e483ec4
.long 0xbf6d3f80,0xbec43f35,0x3f6dbf80,0x3ec4bf35,0xbec4248d,0xbf6d3f35,0x3ec4a554,0x3f6dbf35
.long 0x3f7bbf80,0x3f55bf6d,0xbe48248d,0xbf0e3ec4,0x3e48a554,0x3f0ebec4,0x3f7bbf80,0x3f55bf6d
.long 0x3f803f80,0x3f803f80,0x3f803f80,0x3f803f80,0x248d248d,0x248d248d,0x248d248d,0x248d248d
.long 0xbf0ebf35,0xbe48bec4,0x3f553f35,0x3f7b3f6d,0x3f553f35,0x3f7b3f6d,0x3f0e3f35,0x3e483ec4
.long 0xbec4248d,0xbf6dbf35,0x3ec4a554,0x3f6d3f35,0xbf6dbf80,0xbec4bf35,0x3f6d3f80,0x3ec43f35
.long 0x3f7b3f35,0x3f0e3f6d,0xbe48bf35,0x3f553ec4,0x3e483f35,0xbf55bec4,0x3f7b3f35,0x3f0e3f6d
.long 0xbf35bf80,0x3f35a554,0xbf35bf80,0x3f35a554,0x3f35a554,0x3f353f80,0x3f35a554,0x3f353f80
.long 0xbe483f35,0xbf55bf6d,0xbf7bbf35,0x3f0ebec4,0xbf7bbf35,0x3f0ebec4,0x3e48bf35,0x3f553f6d
.long 0x3f6da554,0xbec43f35,0xbf6d248d,0x3ec4bf35,0x3ec43f80,0xbf6dbf35,0xbec4bf80,0x3f6d3f35
.long 0xbf55bf35,0x3f7b3ec4,0xbf0e3f35,0x3e48bf6d,0x3f0ebf35,0xbe483f6d,0xbf55bf35,0x3f7b3ec4
.long 0x248d3f80,0xa554bf80,0x248d3f80,0xa554bf80,0xbf80248d,0x3f80a554,0xbf80248d,0x3f80a554
.long 0x3f55bf35,0xbf7b3ec4,0x3f0e3f35,0xbe48bf6d,0x3f0e3f35,0xbe48bf6d,0xbf553f35,0x3f7bbec4
.long 0xbf6d248d,0x3ec43f35,0x3f6da554,0xbec4bf35,0x3ec4bf80,0xbf6d3f35,0xbec43f80,0x3f6dbf35
.long 0x3e483f35,0x3f55bf6d,0x3f7bbf35,0xbf0ebec4,0xbf7b3f35,0x3f0e3ec4,0x3e483f35,0x3f55bf6d
.long 0x3f35bf80,0xbf35248d,0x3f35bf80,0xbf35248d,0x3f35a554,0x3f35bf80,0x3f35a554,0x3f35bf80
.long 0xbf7b3f35,0xbf0e3f6d,0x3e48bf35,0xbf553ec4,0x3e48bf35,0xbf553ec4,0x3f7bbf35,0x3f0ebf6d
.long 0x3ec4a554,0x3f6dbf35,0xbec4248d,0xbf6d3f35,0xbf6d3f80,0xbec43f35,0x3f6dbf80,0x3ec4bf35
.long 0x3f0ebf35,0x3e48bec4,0xbf553f35,0xbf7b3f6d,0x3f55bf35,0x3f7bbf6d,0x3f0ebf35,0x3e48bec4
.long 0x0,0x0,0x0,0x0,0x3f803f80,0x3f803f80,0x3f803f80,0x3f803f80
.long 0x3e480000,0x3f0e3ec4,0x3f7b3f80,0x3f553f6d,0x3f7b3f80,0x3f553f6d,0xbe48250d,0xbf0ebec4
.long 0x3ec40000,0x3f6d3f35,0xbec4250d,0xbf6dbf35,0x3f6d3f80,0x3ec43f35,0xbf6dbf80,0xbec4bf35
.long 0x3f0e0000,0x3f7b3f6d,0xbf55bf80,0x3e48bec4,0x3f553f80,0xbe483ec4,0x3f0ea58d,0x3f7b3f6d
.long 0x3f350000,0x3f353f80,0x3f350000,0x3f353f80,0x3f353f80,0xbf35250d,0x3f353f80,0xbf35250d
.long 0x3f550000,0x3e483f6d,0x3f0e3f80,0xbf7bbec4,0x3f0e3f80,0xbf7bbec4,0xbf55250d,0xbe48bf6d
.long 0x3f6d0000,0xbec43f35,0xbf6d250d,0x3ec4bf35,0x3ec43f80,0xbf6dbf35,0xbec4bf80,0x3f6d3f35
.long 0x3f7b0000,0xbf553ec4,0xbe48bf80,0x3f0e3f6d,0x3e483f80,0xbf0ebf6d,0x3f7ba58d,0xbf553ec4
.long 0x3f800000,0xbf80250d,0x3f800000,0xbf80250d,0x250d3f80,0xa58dbf80,0x250d3f80,0xa58dbf80
.long 0x3f7b0000,0xbf55bec4,0xbe483f80,0x3f0ebf6d,0xbe483f80,0x3f0ebf6d,0xbf7b250d,0x3f553ec4
.long 0x3f6d0000,0xbec4bf35,0xbf6d250d,0x3ec43f35,0xbec43f80,0x3f6dbf35,0x3ec4bf80,0xbf6d3f35
.long 0x3f550000,0x3e48bf6d,0x3f0ebf80,0xbf7b3ec4,0xbf0e3f80,0x3f7bbec4,0x3f55a58d,0x3e48bf6d
.long 0x3f350000,0x3f35bf80,0x3f350000,0x3f35bf80,0xbf353f80,0x3f35a58d,0xbf353f80,0x3f35a58d
.long 0x3f0e0000,0x3f7bbf6d,0xbf553f80,0x3e483ec4,0xbf553f80,0x3e483ec4,0xbf0e250d,0xbf7b3f6d
.long 0x3ec40000,0x3f6dbf35,0xbec4250d,0xbf6d3f35,0xbf6d3f80,0xbec43f35,0x3f6dbf80,0x3ec4bf35
.long 0x3e480000,0x3f0ebec4,0x3f7bbf80,0x3f55bf6d,0xbf7b3f80,0xbf553f6d,0x3e48a58d,0x3f0ebec4
.long 0x0,0x0,0x0,0x0,0x3f803f80,0x3f803f80,0x3f803f80,0x3f803f80
.long 0x3f553f35,0x3f7b3f6d,0x3f0e3f35,0x3e483ec4,0x3f0e3f35,0x3e483ec4,0xbf55bf35,0xbf7bbf6d
.long 0x3f6d3f80,0x3ec43f35,0xbf6dbf80,0xbec4bf35,0xbec4250d,0xbf6dbf35,0x3ec4a58d,0x3f6d3f35
.long 0x3e483f35,0xbf55bec4,0x3f7b3f35,0x3f0e3f6d,0xbf7bbf35,0xbf0ebf6d,0x3e483f35,0xbf55bec4
.long 0xbf35250d,0xbf35bf80,0xbf35250d,0xbf35bf80,0xbf35bf80,0x3f35a58d,0xbf35bf80,0x3f35a58d
.long 0xbf7bbf35,0x3f0ebec4,0x3e48bf35,0x3f553f6d,0x3e48bf35,0x3f553f6d,0x3f7b3f35,0xbf0e3ec4
.long 0xbec4bf80,0x3f6d3f35,0x3ec43f80,0xbf6dbf35,0x3f6da58d,0xbec43f35,0xbf6d250d,0x3ec4bf35
.long 0x3f0ebf35,0xbe483f6d,0xbf55bf35,0x3f7b3ec4,0x3f553f35,0xbf7bbec4,0x3f0ebf35,0xbe483f6d
.long 0x3f800000,0xbf80250d,0x3f800000,0xbf80250d,0x250d3f80,0xa58dbf80,0x250d3f80,0xa58dbf80
.long 0x3f0e3f35,0xbe48bf6d,0xbf553f35,0x3f7bbec4,0xbf553f35,0x3f7bbec4,0xbf0ebf35,0x3e483f6d
.long 0xbec43f80,0x3f6dbf35,0x3ec4bf80,0xbf6d3f35,0xbf6d250d,0x3ec43f35,0x3f6da58d,0xbec4bf35
.long 0xbf7b3f35,0x3f0e3ec4,0x3e483f35,0x3f55bf6d,0xbe48bf35,0xbf553f6d,0xbf7b3f35,0x3f0e3ec4
.long 0xbf35250d,0xbf353f80,0xbf35250d,0xbf353f80,0x3f35bf80,0xbf35250d,0x3f35bf80,0xbf35250d
.long 0x3e48bf35,0xbf553ec4,0x3f7bbf35,0x3f0ebf6d,0x3f7bbf35,0x3f0ebf6d,0xbe483f35,0x3f55bec4
.long 0x3f6dbf80,0x3ec4bf35,0xbf6d3f80,0xbec43f35,0x3ec4a58d,0x3f6dbf35,0xbec4250d,0xbf6d3f35
.long 0x3f55bf35,0x3f7bbf6d,0x3f0ebf35,0x3e48bec4,0xbf0e3f35,0xbe483ec4,0x3f55bf35,0x3f7bbf6d
.long 0x0,0x0,0x0,0x0,0x3f803f80,0x3f803f80,0x3f803f80,0x3f803f80
.long 0xbe48250d,0xbf0ebec4,0xbf7bbf80,0xbf55bf6d,0xbf7bbf80,0xbf55bf6d,0x3e48a58d,0x3f0e3ec4
.long 0x3ec40000,0x3f6d3f35,0xbec4250d,0xbf6dbf35,0x3f6d3f80,0x3ec43f35,0xbf6dbf80,0xbec4bf35
.long 0xbf0e250d,0xbf7bbf6d,0x3f553f80,0xbe483ec4,0xbf55bf80,0x3e48bec4,0xbf0e250d,0xbf7bbf6d
.long 0x3f350000,0x3f353f80,0x3f350000,0x3f353f80,0x3f353f80,0xbf35250d,0x3f353f80,0xbf35250d
.long 0xbf55250d,0xbe48bf6d,0xbf0ebf80,0x3f7b3ec4,0xbf0ebf80,0x3f7b3ec4,0x3f55a58d,0x3e483f6d
.long 0x3f6d0000,0xbec43f35,0xbf6d250d,0x3ec4bf35,0x3ec43f80,0xbf6dbf35,0xbec4bf80,0x3f6d3f35
.long 0xbf7b250d,0x3f55bec4,0x3e483f80,0xbf0ebf6d,0xbe48bf80,0x3f0e3f6d,0xbf7b250d,0x3f55bec4
.long 0x3f800000,0xbf80250d,0x3f800000,0xbf80250d,0x250d3f80,0xa58dbf80,0x250d3f80,0xa58dbf80
.long 0xbf7b250d,0x3f553ec4,0x3e48bf80,0xbf0e3f6d,0x3e48bf80,0xbf0e3f6d,0x3f7ba58d,0xbf55bec4
.long 0x3f6d0000,0xbec4bf35,0xbf6d250d,0x3ec43f35,0xbec43f80,0x3f6dbf35,0x3ec4bf80,0xbf6d3f35
.long 0xbf55250d,0xbe483f6d,0xbf0e3f80,0x3f7bbec4,0x3f0ebf80,0xbf7b3ec4,0xbf55250d,0xbe483f6d
.long 0x3f350000,0x3f35bf80,0x3f350000,0x3f35bf80,0xbf353f80,0x3f35a58d,0xbf353f80,0x3f35a58d
.long 0xbf0e250d,0xbf7b3f6d,0x3f55bf80,0xbe48bec4,0x3f55bf80,0xbe48bec4,0x3f0ea58d,0x3f7bbf6d
.long 0x3ec40000,0x3f6dbf35,0xbec4250d,0xbf6d3f35,0xbf6d3f80,0xbec43f35,0x3f6dbf80,0x3ec4bf35
.long 0xbe48250d,0xbf0e3ec4,0xbf7b3f80,0xbf553f6d,0x3f7bbf80,0x3f55bf6d,0xbe48250d,0xbf0e3ec4
.long 0x0,0x0,0x0,0x0,0x3f803f80,0x3f803f80,0x3f803f80,0x3f803f80
.long 0xbf55bf35,0xbf7bbf6d,0xbf0ebf35,0xbe48bec4,0xbf0ebf35,0xbe48bec4,0x3f553f35,0x3f7b3f6d
.long 0x3f6d3f80,0x3ec43f35,0xbf6dbf80,0xbec4bf35,0xbec4250d,0xbf6dbf35,0x3ec4a58d,0x3f6d3f35
.long 0xbe48bf35,0x3f553ec4,0xbf7bbf35,0xbf0ebf6d,0x3f7b3f35,0x3f0e3f6d,0xbe48bf35,0x3f553ec4
.long 0xbf35250d,0xbf35bf80,0xbf35250d,0xbf35bf80,0xbf35bf80,0x3f35a58d,0xbf35bf80,0x3f35a58d
.long 0x3f7b3f35,0xbf0e3ec4,0xbe483f35,0xbf55bf6d,0xbe483f35,0xbf55bf6d,0xbf7bbf35,0x3f0ebec4
.long 0xbec4bf80,0x3f6d3f35,0x3ec43f80,0xbf6dbf35,0x3f6da58d,0xbec43f35,0xbf6d250d,0x3ec4bf35
.long 0xbf0e3f35,0x3e48bf6d,0x3f553f35,0xbf7bbec4,0xbf55bf35,0x3f7b3ec4,0xbf0e3f35,0x3e48bf6d
.long 0x3f800000,0xbf80250d,0x3f800000,0xbf80250d,0x250d3f80,0xa58dbf80,0x250d3f80,0xa58dbf80
.long 0xbf0ebf35,0x3e483f6d,0x3f55bf35,0xbf7b3ec4,0x3f55bf35,0xbf7b3ec4,0x3f0e3f35,0xbe48bf6d
.long 0xbec43f80,0x3f6dbf35,0x3ec4bf80,0xbf6d3f35,0xbf6d250d,0x3ec43f35,0x3f6da58d,0xbec4bf35
.long 0x3f7bbf35,0xbf0ebec4,0xbe48bf35,0xbf553f6d,0x3e483f35,0x3f55bf6d,0x3f7bbf35,0xbf0ebec4
.long 0xbf35250d,0xbf353f80,0xbf35250d,0xbf353f80,0x3f35bf80,0xbf35250d,0x3f35bf80,0xbf35250d
.long 0xbe483f35,0x3f55bec4,0xbf7b3f35,0xbf0e3f6d,0xbf7b3f35,0xbf0e3f6d,0x3e48bf35,0xbf553ec4
.long 0x3f6dbf80,0x3ec4bf35,0xbf6d3f80,0xbec43f35,0x3ec4a58d,0x3f6dbf35,0xbec4250d,0xbf6d3f35
.long 0xbf553f35,0xbf7b3f6d,0xbf0e3f35,0xbe483ec4,0x3f0ebf35,0x3e48bec4,0xbf553f35,0xbf7b3f6d
.long 0x0,0x0,0x0,0x0,0x0,0x0,0x0,0x0
.long 0x0,0x0,0x0,0x0,0x0,0x0,0x0,0x0
.long 0x0,0x0,0x0,0x0,0x0,0x0,0x0,0x0
.long 0x0,0x0,0x0,0x0,0x0,0x0,0x0,0x0
.long 0x0,0x0,0x0,0x0,0x0,0x0,0x0,0x0
.long 0x0,0x0,0x0,0x0,0x0,0x0,0x0,0x0
.long 0x0,0x0,0x0,0x0,0x0,0x0,0x0,0x0
.long 0x0,0x0,0x0,0x0,0x0,0x0,0x0,0x0
.long 0x0,0x3f800000,0x3f803f80,0x0,0x0,0x0,0x3f803f80,0x3f80
.long 0x0,0x0,0x3f800000,0x3f803f80,0x0,0x0,0x0,0x3f803f80
.long 0x0,0x0,0x0,0x3f800000,0x0,0x0,0x0,0x0
.long 0x0,0x0,0x0,0x0,0x0,0x0,0x0,0x0
.long 0x0,0x0,0x0,0x0,0x0,0x0,0x0,0x0
.long 0x0,0x0,0x0,0x0,0x0,0x0,0x0,0x0
.long 0x0,0x0,0x0,0x0,0x0,0x0,0x0,0x0
.long 0x0,0x0,0x0,0x0,0x0,0x0,0x0,0x0
.long 0x0,0x0,0x0,0x0,0x0,0x0,0x0,0x0
.long 0x0,0x0,0x0,0x0,0x3f80,0x0,0x0,0x0
.long 0x3f803f80,0x0,0x0,0x0,0x3f803f80,0x3f80,0x0,0x0
.long 0x3f800000,0x3f803f80,0x0,0x0,0x0,0x3f803f80,0x3f80,0x0
.long 0x0,0x3f800000,0x3f803f80,0x0,0x0,0x0,0x3f803f80,0x3f80
.long 0x0,0x0,0x3f800000,0x3f803f80,0x0,0x0,0x0,0x3f803f80
.long 0x0,0x0,0x0,0x3f800000,0x0,0x0,0x0,0x0
.long 0x0,0x0,0x0,0x0,0x0,0x0,0x0,0x0
.long 0x0,0x0,0x0,0x0,0x0,0x0,0x0,0x0
.long 0x0,0x0,0x0,0x0,0x0,0x0,0x0,0x0
.long 0x0,0x0,0x0,0x0,0x0,0x0,0x0,0x0
.long 0x0,0x0,0x0,0x0,0x0,0x0,0x0,0x0
.long 0x0,0x0,0x0,0x0,0x0,0x0,0x0,0x0
.long 0x0,0x0,0x0,0x0,0x3f80,0x0,0x0,0x0
.long 0x3f803f80,0x0,0x0,0x0,0x3f803f80,0x3f80,0x0,0x0
.long 0x3f800000,0x3f803f80,0x0,0x0,0x0,0x3f803f80,0x3f80,0x0
.long 0x0,0x0,0x0,0x3f803f80,0x0,0x0,0x0,0x3f800000
.long 0x0,0x0,0x0,0x0,0x0,0x0,0x0,0x0
.long 0x0,0x0,0x0,0x0,0x0,0x0,0x0,0x0
.long 0x0,0x0,0x0,0x0,0x0,0x0,0x0,0x0
.long 0x0,0x0,0x0,0x0,0x0,0x0,0x0,0x0
.long 0x0,0x0,0x0,0x0,0x0,0x0,0x0,0x0
.long 0x0,0x0,0x0,0x0,0x0,0x0,0x0,0x0
.long 0x0,0x0,0x0,0x0,0x0,0x0,0x0,0x0
.long 0x3f803f80,0x3f80,0x0,0x0,0x3f803f80,0x3f803f80,0x0,0x0
.long 0x3f803f80,0x3f803f80,0x3f80,0x0,0x3f800000,0x3f803f80,0x3f803f80,0x0
.long 0x0,0x3f803f80,0x3f803f80,0x3f80,0x0,0x3f800000,0x3f803f80,0x3f803f80
.long 0x0,0x0,0x3f803f80,0x3f803f80,0x0,0x0,0x3f800000,0x3f803f80
.long 0x0,0x0,0x0,0x3f803f80,0x0,0x0,0x0,0x3f800000
.long 0x0,0x0,0x0,0x0,0x0,0x0,0x0,0x0
.long 0x0,0x0,0x0,0x0,0x0,0x0,0x0,0x0
.long 0x0,0x0,0x0,0x0,0x0,0x0,0x0,0x0
.long 0x0,0x0,0x0,0x0,0x0,0x0,0x0,0x0
.long 0x0,0x0,0x0,0x0,0x0,0x0,0x0,0x0
.long 0x0,0x0,0x0,0x0,0x0,0x0,0x0,0x0
.long 0x3f80,0x0,0x0,0x0,0x3f803f80,0x0,0x0,0x0
.long 0x3f803f80,0x3f80,0x0,0x0,0x3f803f80,0x3f803f80,0x0,0x0
.long 0x3f803f80,0x3f803f80,0x3f80,0x0,0x3f800000,0x3f803f80,0x3f803f80,0x0
.long 0x0,0x3f803f80,0x3f803f80,0x3f80,0x0,0x3f800000,0x3f803f80,0x3f803f80
.long 0x0,0x0,0x3f803f80,0x3f803f80,0x0,0x0,0x3f800000,0x3f803f80
.long 0x0,0x0,0x0,0x0,0x0,0x0,0x0,0x0
.long 0x0,0x0,0x0,0x0,0x0,0x0,0x0,0x0
.long 0x0,0x0,0x0,0x0,0x0,0x0,0x0,0x0
.long 0x0,0x0,0x0,0x0,0x0,0x0,0x0,0x0
.long 0x0,0x0,0x0,0x0,0x0,0x0,0x0,0x0
.long 0x0,0x0,0x0,0x0,0x0,0x0,0x0,0x0
.long 0x0,0x0,0x0,0x0,0x0,0x0,0x0,0x0
.long 0x3f80,0x0,0x0,0x0,0x3f803f80,0x0,0x0,0x0
.long 0x0,0x0,0x3f800000,0x3f803f80,0x0,0x0,0x0,0x3f803f80
.long 0x0,0x0,0x0,0x3f800000,0x0,0x0,0x0,0x0
.long 0x0,0x0,0x0,0x0,0x0,0x0,0x0,0x0
.long 0x0,0x0,0x0,0x0,0x0,0x0,0x0,0x0
.long 0x0,0x0,0x0,0x0,0x0,0x0,0x0,0x0
.long 0x0,0x0,0x0,0x0,0x0,0x0,0x0,0x0
.long 0x0,0x0,0x0,0x0,0x0,0x0,0x0,0x0
.long 0x0,0x0,0x0,0x0,0x0,0x0,0x0,0x0
.long 0x3f803f80,0x3f803f80,0x0,0x0,0x3f803f80,0x3f803f80,0x3f80,0x0
.long 0x3f803f80,0x3f803f80,0x3f803f80,0x0,0x3f803f80,0x3f803f80,0x3f803f80,0x3f80
.long 0x3f800000,0x3f803f80,0x3f803f80,0x3f803f80,0x0,0x3f803f80,0x3f803f80,0x3f803f80
.long 0x0,0x3f800000,0x3f803f80,0x3f803f80,0x0,0x0,0x3f803f80,0x3f803f80
.long 0x0,0x0,0x3f800000,0x3f803f80,0x0,0x0,0x0,0x3f803f80
.long 0x0,0x0,0x0,0x3f800000,0x0,0x0,0x0,0x0
.long 0x0,0x0,0x0,0x0,0x0,0x0,0x0,0x0
.long 0x0,0x0,0x0,0x0,0x0,0x0,0x0,0x0
.long 0x0,0x0,0x0,0x0,0x0,0x0,0x0,0x0
.long 0x0,0x0,0x0,0x0,0x0,0x0,0x0,0x0
.long 0x0,0x0,0x0,0x0,0x3f80,0x0,0x0,0x0
.long 0x3f803f80,0x0,0x0,0x0,0x3f803f80,0x3f80,0x0,0x0
.long 0x3f803f80,0x3f803f80,0x0,0x0,0x3f803f80,0x3f803f80,0x3f80,0x0
.long 0x3f803f80,0x3f803f80,0x3f803f80,0x0,0x3f803f80,0x3f803f80,0x3f803f80,0x3f80
.long 0x3f800000,0x3f803f80,0x3f803f80,0x3f803f80,0x0,0x3f803f80,0x3f803f80,0x3f803f80
.long 0x0,0x3f800000,0x3f803f80,0x3f803f80,0x0,0x0,0x3f803f80,0x3f803f80
.long 0x0,0x0,0x0,0x0,0x0,0x0,0x0,0x0
.long 0x0,0x0,0x0,0x0,0x0,0x0,0x0,0x0
.long 0x0,0x0,0x0,0x0,0x0,0x0,0x0,0x0
.long 0x0,0x0,0x0,0x0,0x0,0x0,0x0,0x0
.long 0x0,0x0,0x0,0x0,0x0,0x0,0x0,0x0
.long 0x0,0x0,0x0,0x0,0x0,0x0,0x0,0x0
.long 0x0,0x0,0x0,0x0,0x3f80,0x0,0x0,0x0
.long 0x3f803f80,0x0,0x0,0x0,0x3f803f80,0x3f80,0x0,0x0
.long 0x0,0x0,0x3f803f80,0x3f803f80,0x0,0x0,0x3f800000,0x3f803f80
.long 0x0,0x0,0x0,0x3f803f80,0x0,0x0,0x0,0x3f800000
.long 0x0,0x0,0x0,0x0,0x0,0x0,0x0,0x0
.long 0x0,0x0,0x0,0x0,0x0,0x0,0x0,0x0
.long 0x0,0x0,0x0,0x0,0x0,0x0,0x0,0x0
.long 0x0,0x0,0x0,0x0,0x0,0x0,0x0,0x0
.long 0x0,0x0,0x0,0x0,0x0,0x0,0x0,0x0
.long 0x0,0x0,0x0,0x0,0x0,0x0,0x0,0x0
.long 0x3f803f80,0x3f803f80,0x3f80,0x0,0x3f803f80,0x3f803f80,0x3f803f80,0x0
.long 0x3f803f80,0x3f803f80,0x3f803f80,0x3f80,0x3f803f80,0x3f803f80,0x3f803f80,0x3f803f80
.long 0x3f803f80,0x3f803f80,0x3f803f80,0x3f803f80,0x3f800000,0x3f803f80,0x3f803f80,0x3f803f80
.long 0x0,0x3f803f80,0x3f803f80,0x3f803f80,0x0,0x3f800000,0x3f803f80,0x3f803f80
.long 0x0,0x0,0x3f803f80,0x3f803f80,0x0,0x0,0x3f800000,0x3f803f80
.long 0x0,0x0,0x0,0x3f803f80,0x0,0x0,0x0,0x3f800000
.long 0x0,0x0,0x0,0x0,0x0,0x0,0x0,0x0
.long 0x0,0x0,0x0,0x0,0x0,0x0,0x0,0x0
.long 0x0,0x0,0x0,0x0,0x0,0x0,0x0,0x0
.long 0x0,0x0,0x0,0x0,0x0,0x0,0x0,0x0
.long 0x3f80,0x0,0x0,0x0,0x3f803f80,0x0,0x0,0x0
.long 0x3f803f80,0x3f80,0x0,0x0,0x3f803f80,0x3f803f80,0x0,0x0
.long 0x3f803f80,0x3f803f80,0x3f80,0x0,0x3f803f80,0x3f803f80,0x3f803f80,0x0
.long 0x3f803f80,0x3f803f80,0x3f803f80,0x3f80,0x3f803f80,0x3f803f80,0x3f803f80,0x3f803f80
.long 0x3f803f80,0x3f803f80,0x3f803f80,0x3f803f80,0x3f800000,0x3f803f80,0x3f803f80,0x3f803f80
.long 0x0,0x3f803f80,0x3f803f80,0x3f803f80,0x0,0x3f800000,0x3f803f80,0x3f803f80
.long 0x0,0x0,0x0,0x0,0x0,0x0,0x0,0x0
.long 0x0,0x0,0x0,0x0,0x0,0x0,0x0,0x0
.long 0x0,0x0,0x0,0x0,0x0,0x0,0x0,0x0
.long 0x0,0x0,0x0,0x0,0x0,0x0,0x0,0x0
.long 0x0,0x0,0x0,0x0,0x0,0x0,0x0,0x0
.long 0x0,0x0,0x0,0x0,0x0,0x0,0x0,0x0
.long 0x3f80,0x0,0x0,0x0,0x3f803f80,0x0,0x0,0x0
.long 0x3f803f80,0x3f80,0x0,0x0,0x3f803f80,0x3f803f80,0x0,0x0
.long 0x0,0x0,0x0,0x0,0x0,0x0,0x0,0x0
.long 0x0,0x0,0x0,0x0,0x0,0x0,0x0,0x0
.long 0x0,0x0,0x0,0x0,0x0,0x0,0x0,0x0
.long 0x0,0x0,0x0,0x0,0x0,0x0,0x0,0x0
.long 0x0,0x0,0x0,0x0,0x0,0x0,0x0,0x0
.long 0x0,0x0,0x0,0x0,0xffff,0x0,0x0,0x0
.long 0xffffffff,0x0,0x0,0x0,0xffff0000,0xffff,0x0,0x0
.long 0x0,0xffffffff,0x0,0x0,0x0,0xffff0000,0xffff,0x0
.long 0x0,0x0,0x0,0x0,0x0,0x0,0x0,0x0
.long 0x0,0x0,0x0,0x0,0xffff,0x0,0x0,0x0
.long 0xffffffff,0x0,0x0,0x0,0xffff0000,0xffff,0x0,0x0
.long 0x0,0xffffffff,0x0,0x0,0x0,0xffff0000,0xffff,0x0
.long 0x0,0x0,0xffffffff,0x0,0x0,0x0,0xffff0000,0xffff
.long 0x0,0x0,0x0,0xffffffff,0x0,0x0,0x0,0xffff0000
.long 0x0,0x0,0x0,0x0,0x0,0x0,0x0,0x0
.long 0x0,0x0,0x0,0x0,0x0,0x0,0x0,0x0
.long 0x0,0x0,0xffffffff,0x0,0x0,0x0,0xffff0000,0xffff
.long 0x0,0x0,0x0,0xffffffff,0x0,0x0,0x0,0xffff0000
.long 0x0,0x0,0x0,0x0,0x0,0x0,0x0,0x0
.long 0x0,0x0,0x0,0x0,0x0,0x0,0x0,0x0
.long 0x0,0x0,0x0,0x0,0x0,0x0,0x0,0x0
.long 0x0,0x0,0x0,0x0,0x0,0x0,0x0,0x0
.long 0x0,0x0,0x0,0x0,0x0,0x0,0x0,0x0
.long 0x0,0x0,0x0,0x0,0x0,0x0,0x0,0x0
.long 0x0,0x0,0x0,0x0,0x0,0x0,0x0,0x0
.long 0x0,0x0,0x0,0x0,0x0,0x0,0x0,0x0
.long 0x0,0x0,0x0,0x0,0x0,0x0,0x0,0x0
.long 0x0,0x0,0x0,0x0,0x0,0x0,0x0,0x0
.long 0x0,0x0,0x0,0x0,0x0,0x0,0x0,0x0
.long 0x0,0x0,0x0,0x0,0x0,0x0,0x0,0x0
.long 0x0,0x0,0x0,0x0,0x0,0x0,0x0,0x0
.long 0x0,0x0,0x0,0x0,0x0,0x0,0x0,0x0
.long 0x910,0x7b0,0x510,0x440,0x44c,0x800,0x4c,0x4c0
.long 0x90c,0x880,0x50c,0x550,0x448,0x910,0x48,0x5d0
.long 0x908,0x990,0x508,0x660,0x444,0xa20,0x44,0x6e0
.long 0x904,0xaa0,0x504,0x770,0x440,0xb30,0x40,0x7f0
.long 0x900,0xbb0,0x500,0x840,0x43c,0xc00,0x3c,0x8c0
.long 0x8fc,0xc80,0x4fc,0x950,0x438,0xd10,0x38,0x9d0
.long 0x8f8,0xd90,0x4f8,0xa60,0x434,0xe20,0x34,0xae0
.long 0x8f4,0xea0,0x4f4,0xb70,0x430,0xf30,0x30,0xbf0
.long 0x900,0x7f0,0x500,0x400,0x43c,0x840,0x3c,0x480
.long 0x8fc,0x8c0,0x4fc,0x510,0x438,0x950,0x38,0x590
.long 0x8f8,0x9d0,0x4f8,0x620,0x434,0xa60,0x34,0x6a0
.long 0x8f4,0xae0,0x4f4,0x730,0x430,0xb70,0x30,0x7b0
.long 0x8f0,0xbf0,0x4f0,0x800,0x42c,0xc40,0x2c,0x880
.long 0x8ec,0xcc0,0x4ec,0x910,0x428,0xd50,0x28,0x990
.long 0x8e8,0xdd0,0x4e8,0xa20,0x424,0xe60,0x24,0xaa0
.long 0x8e4,0xee0,0x4e4,0xb30,0x420,0xf70,0x20,0xbb0
.long 0x8f0,0x800,0x4f0,0x3f0,0x42c,0x880,0x2c,0x440
.long 0x8ec,0x910,0x4ec,0x4c0,0x428,0x990,0x28,0x550
.long 0x8e8,0xa20,0x4e8,0x5d0,0x424,0xaa0,0x24,0x660
.long 0x8e4,0xb30,0x4e4,0x6e0,0x420,0xbb0,0x20,0x770
.long 0x8e0,0xc00,0x4e0,0x7f0,0x41c,0xc80,0x1c,0x840
.long 0x8dc,0xd10,0x4dc,0x8c0,0x418,0xd90,0x18,0x950
.long 0x8d8,0xe20,0x4d8,0x9d0,0x414,0xea0,0x14,0xa60
.long 0x8d4,0xf30,0x4d4,0xae0,0x410,0xfb0,0x10,0xb70
.long 0x8e0,0x840,0x4e0,0x3b0,0x41c,0x8c0,0x1c,0x400
.long 0x8dc,0x950,0x4dc,0x480,0x418,0x9d0,0x18,0x510
.long 0x8d8,0xa60,0x4d8,0x590,0x414,0xae0,0x14,0x620
.long 0x8d4,0xb70,0x4d4,0x6a0,0x410,0xbf0,0x10,0x730
.long 0x8d0,0xc40,0x4d0,0x7b0,0x40c,0xcc0,0xc,0x800
.long 0x8cc,0xd50,0x4cc,0x880,0x408,0xdd0,0x8,0x910
.long 0x8c8,0xe60,0x4c8,0x990,0x404,0xee0,0x4,0xa20
.long 0x8c4,0xf70,0x4c4,0xaa0,0x400,0xff0,0x0,0xb30
.long 0x370,0x260,0x150,0x800,0x3f0,0x2e0,0x1d0,0x880
.long 0x440,0x370,0x260,0x910,0x4c0,0x3f0,0x2e0,0x990
.long 0x550,0x440,0x370,0xa20,0x5d0,0x4c0,0x3f0,0xaa0
.long 0x660,0x550,0x440,0xb30,0x6e0,0x5d0,0x4c0,0xbb0
.long 0x770,0x660,0x550,0xc00,0x7f0,0x6e0,0x5d0,0xc80
.long 0x840,0x770,0x660,0xd10,0x8c0,0x7f0,0x6e0,0xd90
.long 0x950,0x840,0x770,0xe20,0x9d0,0x8c0,0x7f0,0xea0
.long 0xa60,0x950,0x840,0xf30,0xae0,0x9d0,0x8c0,0xfb0
.long 0x330,0x220,0x110,0x808,0x3b0,0x2a0,0x190,0x888
.long 0x400,0x330,0x220,0x918,0x480,0x3b0,0x2a0,0x998
.long 0x510,0x400,0x330,0xa28,0x590,0x480,0x3b0,0xaa8
.long 0x620,0x510,0x400,0xb38,0x6a0,0x590,0x480,0xbb8
.long 0x730,0x620,0x510,0xc08,0x7b0,0x6a0,0x590,0xc88
.long 0x800,0x730,0x620,0xd18,0x880,0x7b0,0x6a0,0xd98
.long 0x910,0x800,0x730,0xe28,0x990,0x880,0x7b0,0xea8
.long 0xa20,0x910,0x800,0xf38,0xaa0,0x990,0x880,0xfb8
.long 0x2e0,0x1d0,0xc0,0x840,0x370,0x260,0x150,0x8c0
.long 0x3f0,0x2e0,0x1d0,0x950,0x440,0x370,0x260,0x9d0
.long 0x4c0,0x3f0,0x2e0,0xa60,0x550,0x440,0x370,0xae0
.long 0x5d0,0x4c0,0x3f0,0xb70,0x660,0x550,0x440,0xbf0
.long 0x6e0,0x5d0,0x4c0,0xc40,0x770,0x660,0x550,0xcc0
.long 0x7f0,0x6e0,0x5d0,0xd50,0x840,0x770,0x660,0xdd0
.long 0x8c0,0x7f0,0x6e0,0xe60,0x950,0x840,0x770,0xee0
.long 0x9d0,0x8c0,0x7f0,0xf70,0xa60,0x950,0x840,0xff0
.long 0x2a0,0x190,0x80,0x848,0x330,0x220,0x110,0x8c8
.long 0x3b0,0x2a0,0x190,0x958,0x400,0x330,0x220,0x9d8
.long 0x480,0x3b0,0x2a0,0xa68,0x510,0x400,0x330,0xae8
.long 0x590,0x480,0x3b0,0xb78,0x620,0x510,0x400,0xbf8
.long 0x6a0,0x590,0x480,0xc48,0x730,0x620,0x510,0xcc8
.long 0x7b0,0x6a0,0x590,0xd58,0x800,0x730,0x620,0xdd8
.long 0x880,0x7b0,0x6a0,0xe68,0x910,0x800,0x730,0xee8
.long 0x990,0x880,0x7b0,0xf78,0xa20,0x910,0x800,0xff8
.long 0x9b8,0xb7c,0x770,0x770,0x9b0,0xb78,0x7b0,0x7f0
.long 0x9a8,0xb74,0x7f0,0x840,0x9a0,0xb70,0x800,0x8c0
.long 0x998,0xb6c,0x840,0x950,0x990,0xb68,0x880,0x9d0
.long 0x988,0xb64,0x8c0,0xa60,0x980,0xb60,0x910,0xae0
.long 0x978,0xb5c,0x950,0xb70,0x970,0xb58,0x990,0xbf0
.long 0x968,0xb54,0x9d0,0xc40,0x960,0xb50,0xa20,0xcc0
.long 0x958,0xb4c,0xa60,0xd50,0x950,0xb48,0xaa0,0xdd0
.long 0x948,0xb44,0xae0,0xe60,0x940,0xb40,0xb30,0xee0
.long 0x9c8,0xb8c,0x7b0,0x7b0,0x9c0,0xb88,0x7f0,0x800
.long 0x9b8,0xb84,0x800,0x880,0x9b0,0xb80,0x840,0x910
.long 0x9a8,0xb7c,0x880,0x990,0x9a0,0xb78,0x8c0,0xa20
.long 0x998,0xb74,0x910,0xaa0,0x990,0xb70,0x950,0xb30
.long 0x988,0xb6c,0x990,0xbb0,0x980,0xb68,0x9d0,0xc00
.long 0x978,0xb64,0xa20,0xc80,0x970,0xb60,0xa60,0xd10
.long 0x968,0xb5c,0xaa0,0xd90,0x960,0xb58,0xae0,0xe20
.long 0x958,0xb54,0xb30,0xea0,0x950,0xb50,0xb70,0xf30
.long 0x9d8,0xb9c,0x7f0,0x7f0,0x9d0,0xb98,0x800,0x840
.long 0x9c8,0xb94,0x840,0x8c0,0x9c0,0xb90,0x880,0x950
.long 0x9b8,0xb8c,0x8c0,0x9d0,0x9b0,0xb88,0x910,0xa60
.long 0x9a8,0xb84,0x950,0xae0,0x9a0,0xb80,0x990,0xb70
.long 0x998,0xb7c,0x9d0,0xbf0,0x990,0xb78,0xa20,0xc40
.long 0x988,0xb74,0xa60,0xcc0,0x980,0xb70,0xaa0,0xd50
.long 0x978,0xb6c,0xae0,0xdd0,0x970,0xb68,0xb30,0xe60
.long 0x968,0xb64,0xb70,0xee0,0x960,0xb60,0xbb0,0xf70
.long 0x9e8,0xbac,0x800,0x800,0x9e0,0xba8,0x840,0x880
.long 0x9d8,0xba4,0x880,0x910,0x9d0,0xba0,0x8c0,0x990
.long 0x9c8,0xb9c,0x910,0xa20,0x9c0,0xb98,0x950,0xaa0
.long 0x9b8,0xb94,0x990,0xb30,0x9b0,0xb90,0x9d0,0xbb0
.long 0x9a8,0xb8c,0xa20,0xc00,0x9a0,0xb88,0xa60,0xc80
.long 0x998,0xb84,0xaa0,0xd10,0x990,0xb80,0xae0,0xd90
.long 0x988,0xb7c,0xb30,0xe20,0x980,0xb78,0xb70,0xea0
.long 0x978,0xb74,0xbb0,0xf30,0x970,0xb70,0xbf0,0xfb0
.long 0xabc,0xbbc,0x0,0x0,0xab8,0xbbe,0x10,0x110
.long 0xab4,0xbb8,0x20,0x220,0xab0,0xbba,0x30,0x330
.long 0xaac,0xbb4,0x40,0x440,0xaa8,0xbb6,0x50,0x550
.long 0xaa4,0xbb0,0x60,0x660,0xaa0,0xbb2,0x70,0x770
.long 0xa9c,0xbac,0x80,0x880,0xa98,0xbae,0x90,0x990
.long 0xa94,0xba8,0xa0,0xaa0,0xa90,0xbaa,0xb0,0xbb0
.long 0xa8c,0xba4,0xc0,0xcc0,0xa88,0xba6,0xd0,0xdd0
.long 0xa84,0xba0,0xe0,0xee0,0xa80,0xba2,0xf0,0xff0
.long 0xa7c,0xb9c,0x100,0x1100,0xa78,0xb9e,0x110,0x1210
.long 0xa74,0xb98,0x120,0x1320,0xa70,0xb9a,0x130,0x1430
.long 0xa6c,0xb94,0x140,0x1540,0xa68,0xb96,0x150,0x1650
.long 0xa64,0xb90,0x160,0x1760,0xa60,0xb92,0x170,0x1870
.long 0xa5c,0xb8c,0x180,0x1980,0xa58,0xb8e,0x190,0x1a90
.long 0xa54,0xb88,0x1a0,0x1ba0,0xa50,0xb8a,0x1b0,0x1cb0
.long 0xa4c,0xb84,0x1c0,0x1dc0,0xa48,0xb86,0x1d0,0x1ed0
.long 0xa44,0xb80,0x1e0,0x1fe0,0xa40,0xb82,0x1f0,0x20f0
.long 0xa3c,0xb7c,0x200,0x10,0xa38,0xb7e,0x210,0x120
.long 0xa34,0xb78,0x220,0x230,0xa30,0xb7a,0x230,0x340
.long 0xa2c,0xb74,0x240,0x450,0xa28,0xb76,0x250,0x560
.long 0xa24,0xb70,0x260,0x670,0xa20,0xb72,0x270,0x780
.long 0xa1c,0xb6c,0x280,0x890,0xa18,0xb6e,0x290,0x9a0
.long 0xa14,0xb68,0x2a0,0xab0,0xa10,0xb6a,0x2b0,0xbc0
.long 0xa0c,0xb64,0x2c0,0xcd0,0xa08,0xb66,0x2d0,0xde0
.long 0xa04,0xb60,0x2e0,0xef0,0xa00,0xb62,0x2f0,0x1000
.long 0x9fc,0xb5c,0x300,0x1110,0x9f8,0xb5e,0x310,0x1220
.long 0x9f4,0xb58,0x320,0x1330,0x9f0,0xb5a,0x330,0x1440
.long 0x9ec,0xb54,0x340,0x1550,0x9e8,0xb56,0x350,0x1660
.long 0x9e4,0xb50,0x360,0x1770,0x9e0,0xb52,0x370,0x1880
.long 0x9dc,0xb4c,0x380,0x1990,0x9d8,0xb4e,0x390,0x1aa0
.long 0x9d4,0xb48,0x3a0,0x1bb0,0x9d0,0xb4a,0x3b0,0x1cc0
.long 0x9cc,0xb44,0x3c0,0x1dd0,0x9c8,0xb46,0x3d0,0x1ee0
.long 0x9c4,0xb40,0x3e0,0x1ff0,0x9c0,0xb42,0x3f0,0x2100
.long 0x80003f80,0x80003f80,0x80003f80,0x80003f80,0x80003f80,0xbe483f7b,0xbec43f6d,0xbf0e3f55
.long 0x80003f80,0xbec43f6d,0xbf353f35,0xbf6d3ec4,0x80003f80,0xbf0e3f55,0xbf6d3ec4,0xbf7bbe48
.long 0x80003f80,0xa50dbf80,0x80003f80,0xa50dbf80,0x80003f80,0x3e48bf7b,0xbec43f6d,0x3f0ebf55
.long 0x80003f80,0x3ec4bf6d,0xbf353f35,0x3f6dbec4,0x80003f80,0x3f0ebf55,0xbf6d3ec4,0x3f7b3e48
.long 0x80003f80,0xbf353f35,0xbf80248d,0xbf35bf35,0x80003f80,0xbf553f0e,0xbf6dbec4,0xbe48bf7b
.long 0x80003f80,0xbf6d3ec4,0xbf35bf35,0x3ec4bf6d,0x80003f80,0xbf7b3e48,0xbec4bf6d,0x3f55bf0e
.long 0x80003f80,0x3f35bf35,0xbf80248d,0x3f353f35,0x80003f80,0x3f55bf0e,0xbf6dbec4,0x3e483f7b
.long 0x80003f80,0x3f6dbec4,0xbf35bf35,0xbec43f6d,0x80003f80,0x3f7bbe48,0xbec4bf6d,0xbf553f0e
.long 0x80003f80,0xbf80248d,0xa50dbf80,0x3f80a554,0x80003f80,0xbf7bbe48,0x3ec4bf6d,0x3f553f0e
.long 0x80003f80,0xbf6dbec4,0x3f35bf35,0x3ec43f6d,0x80003f80,0xbf55bf0e,0x3f6dbec4,0xbe483f7b
.long 0x80003f80,0x3f80a554,0xa50dbf80,0xbf80248d,0x80003f80,0x3f7b3e48,0x3ec4bf6d,0xbf55bf0e
.long 0x80003f80,0x3f6d3ec4,0x3f35bf35,0xbec4bf6d,0x80003f80,0x3f553f0e,0x3f6dbec4,0x3e48bf7b
.long 0x80003f80,0xbf35bf35,0x3f80a554,0xbf353f35,0x80003f80,0xbf0ebf55,0x3f6d3ec4,0xbf7b3e48
.long 0x80003f80,0xbec4bf6d,0x3f353f35,0xbf6dbec4,0x80003f80,0xbe48bf7b,0x3ec43f6d,0xbf0ebf55
.long 0x80003f80,0x3f353f35,0x3f80a554,0x3f35bf35,0x80003f80,0x3f0e3f55,0x3f6d3ec4,0x3f7bbe48
.long 0x80003f80,0x3ec43f6d,0x3f353f35,0x3f6d3ec4,0x80003f80,0x3e483f7b,0x3ec43f6d,0x3f0e3f55
.long 0x80003f80,0x80003f80,0x80003f80,0x80003f80,0xbf353f35,0xbf553f0e,0xbf6d3ec4,0xbf7b3e48
.long 0xbf80248d,0xbf6dbec4,0xbf35bf35,0xbec4bf6d,0xbf35bf35,0xbe48bf7b,0x3ec4bf6d,0x3f55bf0e
.long 0x80003f80,0xa50dbf80,0x80003f80,0xa50dbf80,0xbf353f35,0x3f55bf0e,0xbf6d3ec4,0x3f7bbe48
.long 0xbf80248d,0x3f6d3ec4,0xbf35bf35,0x3ec43f6d,0xbf35bf35,0x3e483f7b,0x3ec4bf6d,0xbf553f0e
.long 0xa50dbf80,0x3f35bf35,0x3f80a554,0x3f353f35,0x3f35bf35,0x3f7b3e48,0x3ec43f6d,0xbf0e3f55
.long 0x3f80a554,0x3ec43f6d,0xbf353f35,0xbf6dbec4,0x3f353f35,0xbf0e3f55,0xbf6dbec4,0x3e48bf7b
.long 0xa50dbf80,0xbf353f35,0x3f80a554,0xbf35bf35,0x3f35bf35,0xbf7bbe48,0x3ec43f6d,0x3f0ebf55
.long 0x3f80a554,0xbec4bf6d,0xbf353f35,0x3f6d3ec4,0x3f353f35,0x3f0ebf55,0xbf6dbec4,0xbe483f7b
.long 0x80003f80,0xbf80248d,0xa50dbf80,0x3f80a554,0xbf353f35,0xbf0ebf55,0x3f6dbec4,0x3e483f7b
.long 0xbf80248d,0x3ec4bf6d,0x3f353f35,0xbf6d3ec4,0xbf35bf35,0x3f7bbe48,0xbec43f6d,0xbf0ebf55
.long 0x80003f80,0x3f80a554,0xa50dbf80,0xbf80248d,0xbf353f35,0x3f0e3f55,0x3f6dbec4,0xbe48bf7b
.long 0xbf80248d,0xbec43f6d,0x3f353f35,0x3f6dbec4,0xbf35bf35,0xbf7b3e48,0xbec43f6d,0x3f0e3f55
.long 0xa50dbf80,0x3f353f35,0xbf80248d,0x3f35bf35,0x3f35bf35,0xbe483f7b,0xbec4bf6d,0x3f553f0e
.long 0x3f80a554,0xbf6d3ec4,0x3f35bf35,0xbec43f6d,0x3f353f35,0xbf55bf0e,0x3f6d3ec4,0xbf7bbe48
.long 0xa50dbf80,0xbf35bf35,0xbf80248d,0xbf353f35,0x3f35bf35,0x3e48bf7b,0xbec4bf6d,0xbf55bf0e
.long 0x3f80a554,0x3f6dbec4,0x3f35bf35,0x3ec4bf6d,0x3f353f35,0x3f553f0e,0x3f6d3ec4,0x3f7b3e48
.long 0x3f800000,0x3f800000,0x3f800000,0x3f800000,0x3f800000,0x3f7b3e48,0x3f6d3ec4,0x3f553f0e
.long 0x3f800000,0x3f6d3ec4,0x3f353f35,0x3ec43f6d,0x3f800000,0x3f553f0e,0x3ec43f6d,0xbe483f7b
.long 0x3f800000,0xbf80250d,0x3f800000,0xbf80250d,0x3f800000,0xbf7bbe48,0x3f6d3ec4,0xbf55bf0e
.long 0x3f800000,0xbf6dbec4,0x3f353f35,0xbec4bf6d,0x3f800000,0xbf55bf0e,0x3ec43f6d,0x3e48bf7b
.long 0x3f800000,0x3f353f35,0x248d3f80,0xbf353f35,0x3f800000,0x3f0e3f55,0xbec43f6d,0xbf7b3e48
.long 0x3f800000,0x3ec43f6d,0xbf353f35,0xbf6dbec4,0x3f800000,0x3e483f7b,0xbf6d3ec4,0xbf0ebf55
.long 0x3f800000,0xbf35bf35,0x248d3f80,0x3f35bf35,0x3f800000,0xbf0ebf55,0xbec43f6d,0x3f7bbe48
.long 0x3f800000,0xbec4bf6d,0xbf353f35,0x3f6d3ec4,0x3f800000,0xbe48bf7b,0xbf6d3ec4,0x3f0e3f55
.long 0x3f800000,0x248d3f80,0xbf80250d,0xa554bf80,0x3f800000,0xbe483f7b,0xbf6dbec4,0x3f0ebf55
.long 0x3f800000,0xbec43f6d,0xbf35bf35,0x3f6dbec4,0x3f800000,0xbf0e3f55,0xbec4bf6d,0x3f7b3e48
.long 0x3f800000,0xa554bf80,0xbf80250d,0x248d3f80,0x3f800000,0x3e48bf7b,0xbf6dbec4,0xbf0e3f55
.long 0x3f800000,0x3ec4bf6d,0xbf35bf35,0xbf6d3ec4,0x3f800000,0x3f0ebf55,0xbec4bf6d,0xbf7bbe48
.long 0x3f800000,0xbf353f35,0xa554bf80,0x3f353f35,0x3f800000,0xbf553f0e,0x3ec4bf6d,0x3e483f7b
.long 0x3f800000,0xbf6d3ec4,0x3f35bf35,0xbec43f6d,0x3f800000,0xbf7b3e48,0x3f6dbec4,0xbf553f0e
.long 0x3f800000,0x3f35bf35,0xa554bf80,0xbf35bf35,0x3f800000,0x3f55bf0e,0x3ec4bf6d,0xbe48bf7b
.long 0x3f800000,0x3f6dbec4,0x3f35bf35,0x3ec4bf6d,0x3f800000,0x3f7bbe48,0x3f6dbec4,0x3f55bf0e
.long 0x3f800000,0x3f800000,0x3f800000,0x3f800000,0x3f353f35,0x3f0e3f55,0x3ec43f6d,0x3e483f7b
.long 0x248d3f80,0xbec43f6d,0xbf353f35,0xbf6d3ec4,0xbf353f35,0xbf7b3e48,0xbf6dbec4,0xbf0ebf55
.long 0x3f800000,0xbf80250d,0x3f800000,0xbf80250d,0x3f353f35,0xbf0ebf55,0x3ec43f6d,0xbe48bf7b
.long 0x248d3f80,0x3ec4bf6d,0xbf353f35,0x3f6dbec4,0xbf353f35,0x3f7bbe48,0xbf6dbec4,0x3f0e3f55
.long 0xbf80250d,0xbf35bf35,0xa554bf80,0x3f35bf35,0xbf35bf35,0x3e48bf7b,0x3f6dbec4,0x3f553f0e
.long 0xa554bf80,0x3f6dbec4,0x3f353f35,0xbec43f6d,0x3f35bf35,0x3f553f0e,0xbec43f6d,0xbf7bbe48
.long 0xbf80250d,0x3f353f35,0xa554bf80,0xbf353f35,0xbf35bf35,0xbe483f7b,0x3f6dbec4,0xbf55bf0e
.long 0xa554bf80,0xbf6d3ec4,0x3f353f35,0x3ec4bf6d,0x3f35bf35,0xbf55bf0e,0xbec43f6d,0x3f7b3e48
.long 0x3f800000,0x248d3f80,0xbf80250d,0xa554bf80,0x3f353f35,0xbf553f0e,0xbec4bf6d,0x3f7bbe48
.long 0x248d3f80,0xbf6dbec4,0x3f35bf35,0x3ec43f6d,0xbf353f35,0xbe48bf7b,0x3f6d3ec4,0xbf553f0e
.long 0x3f800000,0xa554bf80,0xbf80250d,0x248d3f80,0x3f353f35,0x3f55bf0e,0xbec4bf6d,0xbf7b3e48
.long 0x248d3f80,0x3f6d3ec4,0x3f35bf35,0xbec4bf6d,0xbf353f35,0x3e483f7b,0x3f6d3ec4,0x3f55bf0e
.long 0xbf80250d,0x3f35bf35,0x248d3f80,0xbf35bf35,0xbf35bf35,0x3f7b3e48,0xbf6d3ec4,0x3f0ebf55
.long 0xa554bf80,0x3ec43f6d,0xbf35bf35,0x3f6d3ec4,0x3f35bf35,0xbf0e3f55,0x3ec4bf6d,0xbe483f7b
.long 0xbf80250d,0xbf353f35,0x248d3f80,0x3f353f35,0xbf35bf35,0xbf7bbe48,0xbf6d3ec4,0xbf0e3f55
.long 0xa554bf80,0xbec4bf6d,0xbf35bf35,0xbf6dbec4,0x3f35bf35,0x3f0ebf55,0x3ec4bf6d,0x3e48bf7b
.long 0x80003f80,0x80003f80,0x80003f80,0x80003f80,0xbf80248d,0xbf7bbe48,0xbf6dbec4,0xbf55bf0e
.long 0xa50dbf80,0x3ec4bf6d,0x3f35bf35,0x3f6dbec4,0x3f80a554,0x3f553f0e,0x3ec43f6d,0xbe483f7b
.long 0x80003f80,0xa50dbf80,0x80003f80,0xa50dbf80,0xbf80248d,0x3f7b3e48,0xbf6dbec4,0x3f553f0e
.long 0xa50dbf80,0xbec43f6d,0x3f35bf35,0xbf6d3ec4,0x3f80a554,0xbf55bf0e,0x3ec43f6d,0x3e48bf7b
.long 0x80003f80,0xbf353f35,0xbf80248d,0xbf35bf35,0xbf80248d,0xbf0ebf55,0x3ec4bf6d,0x3f7bbe48
.long 0xa50dbf80,0x3f6dbec4,0x3f353f35,0xbec43f6d,0x3f80a554,0x3e483f7b,0xbf6d3ec4,0xbf0ebf55
.long 0x80003f80,0x3f35bf35,0xbf80248d,0x3f353f35,0xbf80248d,0x3f0e3f55,0x3ec4bf6d,0xbf7b3e48
.long 0xa50dbf80,0xbf6d3ec4,0x3f353f35,0x3ec4bf6d,0x3f80a554,0xbe48bf7b,0xbf6d3ec4,0x3f0e3f55
.long 0x80003f80,0xbf80248d,0xa50dbf80,0x3f80a554,0xbf80248d,0x3e48bf7b,0x3f6d3ec4,0xbf0e3f55
.long 0xa50dbf80,0x3f6d3ec4,0xbf353f35,0xbec4bf6d,0x3f80a554,0xbf0e3f55,0xbec4bf6d,0x3f7b3e48
.long 0x80003f80,0x3f80a554,0xa50dbf80,0xbf80248d,0xbf80248d,0xbe483f7b,0x3f6d3ec4,0x3f0ebf55
.long 0xa50dbf80,0xbf6dbec4,0xbf353f35,0x3ec43f6d,0x3f80a554,0x3f0ebf55,0xbec4bf6d,0xbf7bbe48
.long 0x80003f80,0xbf35bf35,0x3f80a554,0xbf353f35,0xbf80248d,0x3f55bf0e,0xbec43f6d,0xbe48bf7b
.long 0xa50dbf80,0x3ec43f6d,0xbf35bf35,0x3f6d3ec4,0x3f80a554,0xbf7b3e48,0x3f6dbec4,0xbf553f0e
.long 0x80003f80,0x3f353f35,0x3f80a554,0x3f35bf35,0xbf80248d,0xbf553f0e,0xbec43f6d,0x3e483f7b
.long 0xa50dbf80,0xbec4bf6d,0xbf35bf35,0xbf6dbec4,0x3f80a554,0x3f7bbe48,0x3f6dbec4,0x3f55bf0e
.long 0x80003f80,0x80003f80,0x80003f80,0x80003f80,0xbf35bf35,0xbf0ebf55,0xbec4bf6d,0xbe48bf7b
.long 0x3f80a554,0x3f6d3ec4,0x3f353f35,0x3ec43f6d,0xbf353f35,0xbf7b3e48,0xbf6dbec4,0xbf0ebf55
.long 0x80003f80,0xa50dbf80,0x80003f80,0xa50dbf80,0xbf35bf35,0x3f0e3f55,0xbec4bf6d,0x3e483f7b
.long 0x3f80a554,0xbf6dbec4,0x3f353f35,0xbec4bf6d,0xbf353f35,0x3f7bbe48,0xbf6dbec4,0x3f0e3f55
.long 0xa50dbf80,0x3f35bf35,0x3f80a554,0x3f353f35,0x3f353f35,0xbe483f7b,0xbf6d3ec4,0xbf55bf0e
.long 0xbf80248d,0xbec4bf6d,0x3f35bf35,0x3f6d3ec4,0x3f35bf35,0x3f553f0e,0xbec43f6d,0xbf7bbe48
.long 0xa50dbf80,0xbf353f35,0x3f80a554,0xbf35bf35,0x3f353f35,0x3e48bf7b,0xbf6d3ec4,0x3f553f0e
.long 0xbf80248d,0x3ec43f6d,0x3f35bf35,0xbf6dbec4,0x3f35bf35,0xbf55bf0e,0xbec43f6d,0x3f7b3e48
.long 0x80003f80,0xbf80248d,0xa50dbf80,0x3f80a554,0xbf35bf35,0x3f55bf0e,0x3ec43f6d,0xbf7b3e48
.long 0x3f80a554,0xbec43f6d,0xbf35bf35,0x3f6dbec4,0xbf353f35,0xbe48bf7b,0x3f6d3ec4,0xbf553f0e
.long 0x80003f80,0x3f80a554,0xa50dbf80,0xbf80248d,0xbf35bf35,0xbf553f0e,0x3ec43f6d,0x3f7bbe48
.long 0x3f80a554,0x3ec4bf6d,0xbf35bf35,0xbf6d3ec4,0xbf353f35,0x3e483f7b,0x3f6d3ec4,0x3f55bf0e
.long 0xa50dbf80,0x3f353f35,0xbf80248d,0x3f35bf35,0x3f353f35,0xbf7bbe48,0x3f6dbec4,0xbf0e3f55
.long 0xbf80248d,0x3f6dbec4,0xbf353f35,0x3ec4bf6d,0x3f35bf35,0xbf0e3f55,0x3ec4bf6d,0xbe483f7b
.long 0xa50dbf80,0xbf35bf35,0xbf80248d,0xbf353f35,0x3f353f35,0x3f7b3e48,0x3f6dbec4,0x3f0ebf55
.long 0xbf80248d,0xbf6d3ec4,0xbf353f35,0xbec43f6d,0x3f35bf35,0x3f0ebf55,0x3ec4bf6d,0x3e48bf7b
.long 0x3f800000,0x3f800000,0x3f800000,0x3f800000,0x248d3f80,0xbe483f7b,0xbec43f6d,0xbf0e3f55
.long 0xbf80250d,0xbf6dbec4,0xbf35bf35,0xbec4bf6d,0xa554bf80,0x3f0ebf55,0x3f6dbec4,0x3f7b3e48
.long 0x3f800000,0xbf80250d,0x3f800000,0xbf80250d,0x248d3f80,0x3e48bf7b,0xbec43f6d,0x3f0ebf55
.long 0xbf80250d,0x3f6d3ec4,0xbf35bf35,0x3ec43f6d,0xa554bf80,0xbf0e3f55,0x3f6dbec4,0xbf7bbe48
.long 0x3f800000,0x3f353f35,0x248d3f80,0xbf353f35,0x248d3f80,0xbf553f0e,0xbf6dbec4,0xbe48bf7b
.long 0xbf80250d,0xbec4bf6d,0x3f35bf35,0x3f6d3ec4,0xa554bf80,0x3f7bbe48,0x3ec43f6d,0xbf553f0e
.long 0x3f800000,0xbf35bf35,0x248d3f80,0x3f35bf35,0x248d3f80,0x3f55bf0e,0xbf6dbec4,0x3e483f7b
.long 0xbf80250d,0x3ec43f6d,0x3f35bf35,0xbf6dbec4,0xa554bf80,0xbf7b3e48,0x3ec43f6d,0x3f55bf0e
.long 0x3f800000,0x248d3f80,0xbf80250d,0xa554bf80,0x248d3f80,0xbf7bbe48,0x3ec4bf6d,0x3f553f0e
.long 0xbf80250d,0x3ec4bf6d,0x3f353f35,0xbf6d3ec4,0xa554bf80,0x3f553f0e,0xbf6d3ec4,0x3e48bf7b
.long 0x3f800000,0xa554bf80,0xbf80250d,0x248d3f80,0x248d3f80,0x3f7b3e48,0x3ec4bf6d,0xbf55bf0e
.long 0xbf80250d,0xbec43f6d,0x3f353f35,0x3f6dbec4,0xa554bf80,0xbf55bf0e,0xbf6d3ec4,0xbe483f7b
.long 0x3f800000,0xbf353f35,0xa554bf80,0x3f353f35,0x248d3f80,0xbf0ebf55,0x3f6d3ec4,0xbf7b3e48
.long 0xbf80250d,0x3f6dbec4,0xbf353f35,0x3ec4bf6d,0xa554bf80,0x3e483f7b,0xbec4bf6d,0x3f0e3f55
.long 0x3f800000,0x3f35bf35,0xa554bf80,0xbf35bf35,0x248d3f80,0x3f0e3f55,0x3f6d3ec4,0x3f7bbe48
.long 0xbf80250d,0xbf6d3ec4,0xbf353f35,0xbec43f6d,0xa554bf80,0xbe48bf7b,0xbec4bf6d,0xbf0ebf55
.long 0x3f800000,0x3f800000,0x3f800000,0x3f800000,0xbf353f35,0xbf553f0e,0xbf6d3ec4,0xbf7b3e48
.long 0xa554bf80,0x3ec4bf6d,0x3f35bf35,0x3f6dbec4,0x3f353f35,0x3e483f7b,0xbec43f6d,0xbf553f0e
.long 0x3f800000,0xbf80250d,0x3f800000,0xbf80250d,0xbf353f35,0x3f55bf0e,0xbf6d3ec4,0x3f7bbe48
.long 0xa554bf80,0xbec43f6d,0x3f35bf35,0xbf6d3ec4,0x3f353f35,0xbe48bf7b,0xbec43f6d,0x3f55bf0e
.long 0xbf80250d,0xbf35bf35,0xa554bf80,0x3f35bf35,0x3f35bf35,0x3f7b3e48,0x3ec43f6d,0xbf0e3f55
.long 0x248d3f80,0xbf6d3ec4,0xbf35bf35,0x3ec4bf6d,0xbf35bf35,0x3f0ebf55,0x3f6d3ec4,0xbe483f7b
.long 0xbf80250d,0x3f353f35,0xa554bf80,0xbf353f35,0x3f35bf35,0xbf7bbe48,0x3ec43f6d,0x3f0ebf55
.long 0x248d3f80,0x3f6dbec4,0xbf35bf35,0xbec43f6d,0xbf35bf35,0xbf0e3f55,0x3f6d3ec4,0x3e48bf7b
.long 0x3f800000,0x248d3f80,0xbf80250d,0xa554bf80,0xbf353f35,0xbf0ebf55,0x3f6dbec4,0x3e483f7b
.long 0xa554bf80,0x3f6d3ec4,0xbf353f35,0xbec4bf6d,0x3f353f35,0xbf7b3e48,0x3ec4bf6d,0x3f0e3f55
.long 0x3f800000,0xa554bf80,0xbf80250d,0x248d3f80,0xbf353f35,0x3f0e3f55,0x3f6dbec4,0xbe48bf7b
.long 0xa554bf80,0xbf6dbec4,0xbf353f35,0x3ec43f6d,0x3f353f35,0x3f7bbe48,0x3ec4bf6d,0xbf0ebf55
.long 0xbf80250d,0x3f35bf35,0x248d3f80,0xbf35bf35,0x3f35bf35,0xbe483f7b,0xbec4bf6d,0x3f553f0e
.long 0x248d3f80,0xbec4bf6d,0x3f353f35,0xbf6dbec4,0xbf35bf35,0x3f553f0e,0xbf6dbec4,0x3f7b3e48
.long 0xbf80250d,0xbf353f35,0x248d3f80,0x3f353f35,0x3f35bf35,0x3e48bf7b,0xbec4bf6d,0xbf55bf0e
.long 0x248d3f80,0x3ec43f6d,0x3f353f35,0x3f6d3ec4,0xbf35bf35,0xbf55bf0e,0xbf6dbec4,0xbf7bbe48
.long 0x3f800000,0x3f800000,0x3f800000,0x3f800000,0x3f800000,0x3f7ffec4,0x3f7ffb11,0x3f7ff4e6
.long 0x3f800000,0x3f7ffb11,0x3f7fec43,0x3f7fd397,0x3f800000,0x3f7ff4e6,0x3f7fd397,0x3f7f9c18
.long 0x3f800000,0x3f7ec46d,0x3f7b14be,0x3f74fa0b,0x3f800000,0x3f7e9bc9,0x3f7a7302,0x3f73913f
.long 0x3f800000,0x3f7e70b0,0x3f79c79d,0x3f721352,0x3f800000,0x3f7e4323,0x3f791298,0x3f708066
.long 0x3f800000,0x3f7fec43,0x3f7fb10f,0x3f7f4e6d,0x3f800000,0x3f7fe129,0x3f7f84ab,0x3f7eea9d
.long 0x3f800000,0x3f7fd397,0x3f7f4e6d,0x3f7e70b0,0x3f800000,0x3f7fc38f,0x3f7f0e58,0x3f7de0b1
.long 0x3f800000,0x3f7e1324,0x3f7853f8,0x3f6ed89e,0x3f800000,0x3f7de0b1,0x3f778bc5,0x3f6d1c1d
.long 0x3f800000,0x3f7dabcc,0x3f76ba07,0x3f6b4b0c,0x3f800000,0x3f7d7474,0x3f75dec6,0x3f696591
.long 0x3f800000,0x3f7fb10f,0x3f7ec46d,0x3f7d3aac,0x3f800000,0x3f7f9c18,0x3f7e70b0,0x3f7c7eb0
.long 0x3f800000,0x3f7f84ab,0x3f7e1324,0x3f7baccd,0x3f800000,0x3f7f6ac7,0x3f7dabcc,0x3f7ac516
.long 0x3f800000,0x3f7d3aac,0x3f74fa0b,0x3f676bd8,0x3f800000,0x3f7cfe73,0x3f740bdd,0x3f655e0b
.long 0x3f800000,0x3f7cbfc9,0x3f731447,0x3f633c5a,0x3f800000,0x3f7c7eb0,0x3f721352,0x3f6106f2
.long 0x3f800000,0x3f7f4e6d,0x3f7d3aac,0x3f79c79d,0x3f800000,0x3f7f2f9d,0x3f7cbfc9,0x3f78b47b
.long 0x3f800000,0x3f7f0e58,0x3f7c3b28,0x3f778bc5,0x3f800000,0x3f7eea9d,0x3f7baccd,0x3f764d97
.long 0x3f800000,0x3f7c3b28,0x3f710908,0x3f5ebe05,0x3f800000,0x3f7bf531,0x3f6ff573,0x3f5c61c7
.long 0x3f800000,0x3f7baccd,0x3f6ed89e,0x3f59f26a,0x3f800000,0x3f7b61fc,0x3f6db293,0x3f577026
.long 0x3f800000,0x3f800000,0x3f800000,0x3f800000,0x3f7fec43,0x3f7fe129,0x3f7fd397,0x3f7fc38f
.long 0x3f7fb10f,0x3f7f84ab,0x3f7f4e6d,0x3f7f0e58,0x3f7f4e6d,0x3f7eea9d,0x3f7e70b0,0x3f7de0b1
.long 0x3f6c835e,0x3f61c598,0x3f54db31,0x3f45e403,0x3f6a09a7,0x3f5df6be,0x3f4f7a1f,0x3f3ebc1b
.long 0x3f676bd8,0x3f59f26a,0x3f49d112,0x3f373a23,0x3f64aa59,0x3f55b993,0x3f43e200,0x3f2f61a5
.long 0x3f7ec46d,0x3f7e1324,0x3f7d3aac,0x3f7c3b28,0x3f7e1324,0x3f7cfe73,0x3f7baccd,0x3f7a1e84
.long 0x3f7d3aac,0x3f7baccd,0x3f79c79d,0x3f778bc5,0x3f7c3b28,0x3f7a1e84,0x3f778bc5,0x3f748422
.long 0x3f61c598,0x3f514d3d,0x3f3daef9,0x3f273656,0x3f5ebe05,0x3f4cae79,0x3f373a23,0x3f1ebc12
.long 0x3f5b941a,0x3f47de65,0x3f3085bb,0x3f15f6d9,0x3f584853,0x3f42de29,0x3f299415,0x3f0cead0
.long 0x3f7b14be,0x3f7853f8,0x3f74fa0b,0x3f710908,0x3f79c79d,0x3f764d97,0x3f721352,0x3f6d1c1d
.long 0x3f7853f8,0x3f740bdd,0x3f6ed89e,0x3f68bf3c,0x3f76ba07,0x3f718f57,0x3f6b4b0c,0x3f63f473
.long 0x3f54db31,0x3f3daef9,0x3f226799,0x3f039c3d,0x3f514d3d,0x3f385216,0x3f1b02c6,0x3ef41f07
.long 0x3f4d9f02,0x3f32c8c9,0x3f13682a,0x3ee0924f,0x3f49d112,0x3f2d1469,0x3f0b9a6b,0x3ecc9b8b
.long 0x3f74fa0b,0x3f6ed89e,0x3f676bd8,0x3f5ebe05,0x3f731447,0x3f6be858,0x3f633c5a,0x3f591e6a
.long 0x3f710908,0x3f68bf3c,0x3f5ebe05,0x3f531849,0x3f6ed89e,0x3f655e0b,0x3f59f26a,0x3f4cae79
.long 0x3f45e403,0x3f273656,0x3f039c3d,0x3eb8442a,0x3f41d870,0x3f212ff9,0x3ef6e0cb,0x3ea395c5
.long 0x3f3daef9,0x3f1b02c6,0x3ee63375,0x3e8e9a22,0x3f396842,0x3f14b039,0x3ed53641,0x3e72b651
.long 0x3f800000,0x3f800000,0x3f800000,0x3f800000,0x3f7fb10f,0x3f7f9c18,0x3f7f84ab,0x3f7f6ac7
.long 0x3f7ec46d,0x3f7e70b0,0x3f7e1324,0x3f7dabcc,0x3f7d3aac,0x3f7c7eb0,0x3f7baccd,0x3f7ac516
.long 0x3f3504f3,0x3f226799,0x3f0e39da,0x3ef15aea,0x3f2beb4a,0x3f173c07,0x3f00e7e4,0x3ed25a09
.long 0x3f226799,0x3f0b9a6b,0x3ee63375,0x3eb263ef,0x3f187fc0,0x3eff17b2,0x3ec9b953,0x3e919ddd
.long 0x3f7b14be,0x3f79c79d,0x3f7853f8,0x3f76ba07,0x3f7853f8,0x3f764d97,0x3f740bdd,0x3f718f57
.long 0x3f74fa0b,0x3f721352,0x3f6ed89e,0x3f6b4b0c,0x3f710908,0x3f6d1c1d,0x3f68bf3c,0x3f63f473
.long 0x3f0e39da,0x3ee63375,0x3eac7cd4,0x3e605c13,0x3f039c3d,0x3ecc9b8b,0x3e8e9a22,0x3e1c76de
.long 0x3ef15aea,0x3eb263ef,0x3e605c13,0x3dafb680,0x3edae880,0x3e97a117,0x3e22abb6,0x3c96c9b6
.long 0x3f6c835e,0x3f676bd8,0x3f61c598,0x3f5b941a,0x3f676bd8,0x3f6106f2,0x3f59f26a,0x3f5233c6
.long 0x3f61c598,0x3f59f26a,0x3f514d3d,0x3f47de65,0x3f5b941a,0x3f5233c6,0x3f47de65,0x3f3ca003
.long 0x3ec3ef15,0x3e78cfcc,0x3dc8bd36,0xbd48fb30,0x3eac7cd4,0x3e419b37,0x3d16c32c,0xbdee3876
.long 0x3e94a031,0x3e09cf86,0xbcc90ab0,0xbe3b6ecf,0x3e78cfcc,0x3da3308c,0xbdafb680,0xbe7ee6e1
.long 0x3f54db31,0x3f49d112,0x3f3daef9,0x3f3085bb,0x3f4d9f02,0x3f40d0da,0x3f32c8c9,0x3f239da9
.long 0x3f45e403,0x3f373a23,0x3f273656,0x3f15f6d9,0x3f3daef9,0x3f2d1469,0x3f1b02c6,0x3f07a136
.long 0x3e47c5c2,0x3cc90ab0,0xbe164083,0xbea09ae5,0x3e164083,0xbcfb49ba,0xbe541501,0xbec1071e
.long 0x3dc8bd36,0xbdafb680,0xbe888e93,0xbee0924f,0x3d48fb30,0xbe1008b7,0xbea68f12,0xbeff17b2
.long 0x3f800000,0x3f800000,0x3f800000,0x3f800000,0x3f7f4e6d,0x3f7f2f9d,0x3f7f0e58,0x3f7eea9d
.long 0x3f7d3aac,0x3f7cbfc9,0x3f7c3b28,0x3f7baccd,0x3f79c79d,0x3f78b47b,0x3f778bc5,0x3f764d97
.long 0x3ec3ef15,0x3e94a031,0x3e47c5c2,0x3dc8bd36,0x3ea09ae5,0x3e5a3997,0x3de1bc2e,0x3bc90f88
.long 0x3e78cfcc,0x3e09cf86,0x3cc90ab0,0xbdafb680,0x3e2f10a2,0x3d621469,0xbd7b2b74,0xbe354098
.long 0x3f74fa0b,0x3f731447,0x3f710908,0x3f6ed89e,0x3f6ed89e,0x3f6be858,0x3f68bf3c,0x3f655e0b
.long 0x3f676bd8,0x3f633c5a,0x3f5ebe05,0x3f59f26a,0x3f5ebe05,0x3f591e6a,0x3f531849,0x3f4cae79
.long 0x3dc8bd36,0xbcc90ab0,0xbe164083,0xbe888e93,0x3cc90ab0,0xbdd53db9,0xbe6c9a7f,0xbeb554ec
.long 0xbd48fb30,0xbe3b6ecf,0xbea09ae5,0xbee0924f,0xbdfab273,0xbe8586ce,0xbec9b953,0xbf04f484
.long 0x3f54db31,0x3f4d9f02,0x3f45e403,0x3f3daef9,0x3f49d112,0x3f40d0da,0x3f373a23,0x3f2d1469
.long 0x3f3daef9,0x3f32c8c9,0x3f273656,0x3f1b02c6,0x3f3085bb,0x3f239da9,0x3f15f6d9,0x3f07a136
.long 0xbe47c5c2,0xbeac7cd4,0xbef15aea,0xbf187fc0,0xbe888e93,0xbed25a09,0xbf0b9a6b,0xbf2ac082
.long 0xbeac7cd4,0xbef6e0cb,0xbf1d7fd1,0xbf3b8f3b,0xbecf7bca,0xbf0cead0,0xbf2e3bde,0xbf4ac77f
.long 0x3f226799,0x3f13682a,0x3f039c3d,0x3ee63375,0x3f13682a,0x3f0242b1,0x3ee0924f,0x3ebb31a0
.long 0x3f039c3d,0x3ee0924f,0x3eb8442a,0x3e8e9a22,0x3ee63375,0x3ebb31a0,0x3e8e9a22,0x3e419b37
.long 0xbef15aea,0xbf1d7fd1,0xbf3daef9,0xbf584853,0xbf08f59b,0xbf2d1469,0xbf4bbbf8,0xbf63f473
.long 0xbf187fc0,0xbf3b8f3b,0xbf584853,0xbf6db293,0xbf273656,0xbf48d8b3,0xbf633c5a,0xbf756d97
.long 0x3f800000,0x3f800000,0x3f800000,0x3f800000,0x3f7ec46d,0x3f7e9bc9,0x3f7e70b0,0x3f7e4323
.long 0x3f7b14be,0x3f7a7302,0x3f79c79d,0x3f791298,0x3f74fa0b,0x3f73913f,0x3f721352,0x3f708066
.long 0x248d3132,0xbdc8bd36,0xbe47c5c2,0xbe94a031,0xbdc8bd36,0xbe4dee60,0xbe9aa086,0xbecc9b8b
.long 0xbe47c5c2,0xbe9aa086,0xbecf7bca,0xbf00e7e4,0xbe94a031,0xbecc9b8b,0xbf00e7e4,0xbf19c200
.long 0x3f6c835e,0x3f6a09a7,0x3f676bd8,0x3f64aa59,0x3f61c598,0x3f5df6be,0x3f59f26a,0x3f55b993
.long 0x3f54db31,0x3f4f7a1f,0x3f49d112,0x3f43e200,0x3f45e403,0x3f3ebc1b,0x3f373a23,0x3f2f61a5
.long 0xbec3ef15,0xbefc5d27,0xbf187fc0,0xbf3085bb,0xbef15aea,0xbf14b039,0xbf2e3bde,0xbf44e3f5
.long 0xbf0e39da,0xbf299415,0xbf41d870,0xbf5695e5,0xbf226799,0xbf3ca003,0xbf531849,0xbf655e0b
.long 0x3f3504f3,0x3f2beb4a,0x3f226799,0x3f187fc0,0x3f226799,0x3f173c07,0x3f0b9a6b,0x3eff17b2
.long 0x3f0e39da,0x3f00e7e4,0x3ee63375,0x3ec9b953,0x3ef15aea,0x3ed25a09,0x3eb263ef,0x3e919ddd
.long 0xbf3504f3,0xbf4d9f02,0xbf61c598,0xbf710908,0xbf45e403,0xbf5c61c7,0xbf6db293,0xbf796e4e
.long 0xbf54db31,0xbf68bf3c,0xbf76ba07,0xbf7e70b0,0xbf61c598,0xbf7294f8,0xbf7cbfc9,0xbf7ffec4
.long 0x3ec3ef15,0x3ea09ae5,0x3e78cfcc,0x3e2f10a2,0x3e94a031,0x3e5a3997,0x3e09cf86,0x3d621469
.long 0x3e47c5c2,0x3de1bc2e,0x3cc90ab0,0xbd7b2b74,0x3dc8bd36,0x3bc90f88,0xbdafb680,0xbe354098
.long 0xbf6c835e,0xbf79c79d,0xbf7fb10f,0xbf7e1324,0xbf74fa0b,0xbf7e4323,0xbf7f84ab,0xbf78b47b
.long 0xbf7b14be,0xbf7ffb11,0xbf7c3b28,0xbf6ff573,0xbf7ec46d,0xbf7eea9d,0xbf75dec6,0xbf63f473
.long 0x3f800000,0x3f800000,0x3f800000,0x3f800000,0x3f7e1324,0x3f7de0b1,0x3f7dabcc,0x3f7d7474
.long 0x3f7853f8,0x3f778bc5,0x3f76ba07,0x3f75dec6,0x3f6ed89e,0x3f6d1c1d,0x3f6b4b0c,0x3f696591
.long 0xbec3ef15,0xbef15aea,0xbf0e39da,0xbf226799,0xbefc5d27,0xbf14b039,0xbf299415,0xbf3ca003
.long 0xbf187fc0,0xbf2e3bde,0xbf41d870,0xbf531849,0xbf3085bb,0xbf44e3f5,0xbf5695e5,0xbf655e0b
.long 0x3f61c598,0x3f5ebe05,0x3f5b941a,0x3f584853,0x3f514d3d,0x3f4cae79,0x3f47de65,0x3f42de29
.long 0x3f3daef9,0x3f373a23,0x3f3085bb,0x3f299415,0x3f273656,0x3f1ebc12,0x3f15f6d9,0x3f0cead0
.long 0xbf45e403,0xbf584853,0xbf676bd8,0xbf731447,0xbf584853,0xbf6816a8,0xbf740bdd,0xbf7bf531
.long 0xbf676bd8,0xbf740bdd,0xbf7c3b28,0xbf7fd397,0xbf731447,0xbf7bf531,0xbf7fd397,0xbf7e9bc9
.long 0x3f0e39da,0x3f039c3d,0x3ef15aea,0x3edae880,0x3ee63375,0x3ecc9b8b,0x3eb263ef,0x3e97a117
.long 0x3eac7cd4,0x3e8e9a22,0x3e605c13,0x3e22abb6,0x3e605c13,0x3e1c76de,0x3dafb680,0x3c96c9b6
.long 0xbf7b14be,0xbf7fb10f,0xbf7ec46d,0xbf7853f8,0xbf7f4e6d,0xbf7f2f9d,0xbf791298,0xbf6d1c1d
.long 0xbf7fb10f,0xbf7a7302,0xbf6ed89e,0xbf5d2d53,0xbf7c3b28,0xbf718f57,0xbf604621,0xbf48d8b3
.long 0x3dc8bd36,0x3cc90ab0,0xbd48fb30,0xbdfab273,0xbcc90ab0,0xbdd53db9,0xbe3b6ecf,0xbe8586ce
.long 0xbe164083,0xbe6c9a7f,0xbea09ae5,0xbec9b953,0xbe888e93,0xbeb554ec,0xbee0924f,0xbf04f484
.long 0xbf74fa0b,0xbf64aa59,0xbf4d9f02,0xbf3085bb,0xbf6a09a7,0xbf53fac3,0xbf373a23,0xbf14b039
.long 0xbf5b941a,0xbf3fc767,0xbf1d7fd1,0xbeebcbbb,0xbf49d112,0xbf286605,0xbf00e7e4,0xbea986c4
.long 0x3f800000,0x3f800000,0x3f800000,0x3f800000,0x3f7d3aac,0x3f7cfe73,0x3f7cbfc9,0x3f7c7eb0
.long 0x3f74fa0b,0x3f740bdd,0x3f731447,0x3f721352,0x3f676bd8,0x3f655e0b,0x3f633c5a,0x3f6106f2
.long 0xbf3504f3,0xbf45e403,0xbf54db31,0xbf61c598,0xbf4d9f02,0xbf5c61c7,0xbf68bf3c,0xbf7294f8
.long 0xbf61c598,0xbf6db293,0xbf76ba07,0xbf7cbfc9,0xbf710908,0xbf796e4e,0xbf7e70b0,0xbf7ffec4
.long 0x3f54db31,0x3f514d3d,0x3f4d9f02,0x3f49d112,0x3f3daef9,0x3f385216,0x3f32c8c9,0x3f2d1469
.long 0x3f226799,0x3f1b02c6,0x3f13682a,0x3f0b9a6b,0x3f039c3d,0x3ef41f07,0x3ee0924f,0x3ecc9b8b
.long 0xbf7b14be,0xbf7f4e6d,0xbf7fb10f,0xbf7c3b28,0xbf7fb10f,0xbf7f2f9d,0xbf7a7302,0xbf718f57
.long 0xbf7ec46d,0xbf791298,0xbf6ed89e,0xbf604621,0xbf7853f8,0xbf6d1c1d,0xbf5d2d53,0xbf48d8b3
.long 0x3ec3ef15,0x3eac7cd4,0x3e94a031,0x3e78cfcc,0x3e78cfcc,0x3e419b37,0x3e09cf86,0x3da3308c
.long 0x3dc8bd36,0x3d16c32c,0xbcc90ab0,0xbdafb680,0xbd48fb30,0xbdee3876,0xbe3b6ecf,0xbe7ee6e1
.long 0xbf6c835e,0xbf5b941a,0xbf45e403,0xbf2beb4a,0xbf5b941a,0xbf44e3f5,0xbf299415,0xbf0a48ad
.long 0xbf45e403,0xbf299415,0xbf08f59b,0xbec9b953,0xbf2beb4a,0xbf0a48ad,0xbec9b953,0xbe72b651
.long 0xbe47c5c2,0xbe888e93,0xbeac7cd4,0xbecf7bca,0xbeac7cd4,0xbed25a09,0xbef6e0cb,0xbf0cead0
.long 0xbef15aea,0xbf0b9a6b,0xbf1d7fd1,0xbf2e3bde,0xbf187fc0,0xbf2ac082,0xbf3b8f3b,0xbf4ac77f
.long 0xbf0e39da,0xbecf7bca,0xbe78cfcc,0xbd96a905,0xbedae880,0xbe8586ce,0xbdafb680,0x3dbc3ac3
.long 0xbe94a031,0xbde1bc2e,0x3d96a905,0x3e827dc0,0xbe164083,0x3d2fe007,0x3e6c9a7f,0x3ed25a09
.long 0x3f800000,0x3f800000,0x3f800000,0x3f800000,0x3f7c3b28,0x3f7bf531,0x3f7baccd,0x3f7b61fc
.long 0x3f710908,0x3f6ff573,0x3f6ed89e,0x3f6db293,0x3f5ebe05,0x3f5c61c7,0x3f59f26a,0x3f577026
.long 0xbf6c835e,0xbf74fa0b,0xbf7b14be,0xbf7ec46d,0xbf79c79d,0xbf7e4323,0xbf7ffb11,0xbf7eea9d
.long 0xbf7fb10f,0xbf7f84ab,0xbf7c3b28,0xbf75dec6,0xbf7e1324,0xbf78b47b,0xbf6ff573,0xbf63f473
.long 0x3f45e403,0x3f41d870,0x3f3daef9,0x3f396842,0x3f273656,0x3f212ff9,0x3f1b02c6,0x3f14b039
.long 0x3f039c3d,0x3ef6e0cb,0x3ee63375,0x3ed53641,0x3eb8442a,0x3ea395c5,0x3e8e9a22,0x3e72b651
.long 0xbf74fa0b,0xbf6a09a7,0xbf5b941a,0xbf49d112,0xbf64aa59,0xbf53fac3,0xbf3fc767,0xbf286605
.long 0xbf4d9f02,0xbf373a23,0xbf1d7fd1,0xbf00e7e4,0xbf3085bb,0xbf14b039,0xbeebcbbb,0xbea986c4
.long 0x3e47c5c2,0x3e164083,0x3dc8bd36,0x3d48fb30,0x3cc90ab0,0xbcfb49ba,0xbdafb680,0xbe1008b7
.long 0xbe164083,0xbe541501,0xbe888e93,0xbea68f12,0xbea09ae5,0xbec1071e,0xbee0924f,0xbeff17b2
.long 0xbf0e39da,0xbedae880,0xbe94a031,0xbe164083,0xbecf7bca,0xbe8586ce,0xbde1bc2e,0x3d2fe007
.long 0xbe78cfcc,0xbdafb680,0x3d96a905,0x3e6c9a7f,0xbd96a905,0x3dbc3ac3,0x3e827dc0,0x3ed25a09
.long 0xbef15aea,0xbf08f59b,0xbf187fc0,0xbf273656,0xbf1d7fd1,0xbf2d1469,0xbf3b8f3b,0xbf48d8b3
.long 0xbf3daef9,0xbf4bbbf8,0xbf584853,0xbf633c5a,0xbf584853,0xbf63f473,0xbf6db293,0xbf756d97
.long 0x3dc8bd36,0x3e888e93,0x3edae880,0x3f13682a,0x3e888e93,0x3eddbe79,0x3f15f6d9,0x3f385216
.long 0x3edae880,0x3f15f6d9,0x3f396842,0x3f5695e5,0x3f13682a,0x3f385216,0x3f5695e5,0x3f6d1c1d
.long 0x0,0x0,0x0,0x0,0x0,0x3bc90f88,0x3c490e90,0x3c96c9b6
.long 0x0,0x3c490e90,0x3cc90ab0,0x3d16c32c,0x0,0x3c96c9b6,0x3d16c32c,0x3d621469
.long 0x0,0x3dc8bd36,0x3e47c5c2,0x3e94a031,0x0,0x3dd53db9,0x3e541501,0x3e9d9e78
.long 0x0,0x3de1bc2e,0x3e605c13,0x3ea68f12,0x0,0x3dee3876,0x3e6c9a7f,0x3eaf713a
.long 0x0,0x3cc90ab0,0x3d48fb30,0x3d96a905,0x0,0x3cfb49ba,0x3d7b2b74,0x3dbc3ac3
.long 0x0,0x3d16c32c,0x3d96a905,0x3de1bc2e,0x0,0x3d2fe007,0x3dafb680,0x3e039502
.long 0x0,0x3dfab273,0x3e78cfcc,0x3eb8442a,0x0,0x3e039502,0x3e827dc0,0x3ec1071e
.long 0x0,0x3e09cf86,0x3e888e93,0x3ec9b953,0x0,0x3e1008b7,0x3e8e9a22,0x3ed25a09
.long 0x0,0x3d48fb30,0x3dc8bd36,0x3e164083,0x0,0x3d621469,0x3de1bc2e,0x3e28defc
.long 0x0,0x3d7b2b74,0x3dfab273,0x3e3b6ecf,0x0,0x3d8a200a,0x3e09cf86,0x3e4dee60
.long 0x0,0x3e164083,0x3e94a031,0x3edae880,0x0,0x3e1c76de,0x3e9aa086,0x3ee363fa
.long 0x0,0x3e22abb6,0x3ea09ae5,0x3eebcbbb,0x0,0x3e28defc,0x3ea68f12,0x3ef41f07
.long 0x0,0x3d96a905,0x3e164083,0x3e605c13,0x0,0x3da3308c,0x3e22abb6,0x3e72b651
.long 0x0,0x3dafb680,0x3e2f10a2,0x3e827dc0,0x0,0x3dbc3ac3,0x3e3b6ecf,0x3e8b9507
.long 0x0,0x3e2f10a2,0x3eac7cd4,0x3efc5d27,0x0,0x3e354098,0x3eb263ef,0x3f0242b1
.long 0x0,0x3e3b6ecf,0x3eb8442a,0x3f064b82,0x0,0x3e419b37,0x3ebe1d4a,0x3f0a48ad
.long 0x0,0x0,0x0,0x0,0x3cc90ab0,0x3cfb49ba,0x3d16c32c,0x3d2fe007
.long 0x3d48fb30,0x3d7b2b74,0x3d96a905,0x3dafb680,0x3d96a905,0x3dbc3ac3,0x3de1bc2e,0x3e039502
.long 0x3ec3ef15,0x3ef15aea,0x3f0e39da,0x3f226799,0x3ecf7bca,0x3eff17b2,0x3f15f6d9,0x3f2ac082
.long 0x3edae880,0x3f064b82,0x3f1d7fd1,0x3f32c8c9,0x3ee63375,0x3f0cead0,0x3f24d225,0x3f3a7ca4
.long 0x3dc8bd36,0x3dfab273,0x3e164083,0x3e2f10a2,0x3dfab273,0x3e1c76de,0x3e3b6ecf,0x3e5a3997
.long 0x3e164083,0x3e3b6ecf,0x3e605c13,0x3e827dc0,0x3e2f10a2,0x3e5a3997,0x3e827dc0,0x3e97a117
.long 0x3ef15aea,0x3f13682a,0x3f2beb4a,0x3f41d870,0x3efc5d27,0x3f19c200,0x3f32c8c9,0x3f48d8b3
.long 0x3f039c3d,0x3f1ff6cb,0x3f396842,0x3f4f7a1f,0x3f08f59b,0x3f26050a,0x3f3fc767,0x3f55b993
.long 0x3e47c5c2,0x3e78cfcc,0x3e94a031,0x3eac7cd4,0x3e605c13,0x3e8b9507,0x3ea68f12,0x3ec1071e
.long 0x3e78cfcc,0x3e9aa086,0x3eb8442a,0x3ed53641,0x3e888e93,0x3ea986c4,0x3ec9b953,0x3ee900b7
.long 0x3f0e39da,0x3f2beb4a,0x3f45e403,0x3f5b941a,0x3f13682a,0x3f31a81d,0x3f4bbbf8,0x3f6106f2
.long 0x3f187fc0,0x3f373a23,0x3f514d3d,0x3f660f88,0x3f1d7fd1,0x3f3ca003,0x3f5695e5,0x3f6aab7b
.long 0x3e94a031,0x3eb8442a,0x3edae880,0x3efc5d27,0x3ea09ae5,0x3ec6d529,0x3eebcbbb,0x3f07a136
.long 0x3eac7cd4,0x3ed53641,0x3efc5d27,0x3f10d3cd,0x3eb8442a,0x3ee363fa,0x3f064b82,0x3f19c200
.long 0x3f226799,0x3f41d870,0x3f5b941a,0x3f6ed89e,0x3f273656,0x3f46e22a,0x3f604621,0x3f7294f8
.long 0x3f2beb4a,0x3f4bbbf8,0x3f64aa59,0x3f75dec6,0x3f3085bb,0x3f5064af,0x3f68bf3c,0x3f78b47b
.long 0x0,0x0,0x0,0x0,0x3d48fb30,0x3d621469,0x3d7b2b74,0x3d8a200a
.long 0x3dc8bd36,0x3de1bc2e,0x3dfab273,0x3e09cf86,0x3e164083,0x3e28defc,0x3e3b6ecf,0x3e4dee60
.long 0x3f3504f3,0x3f45e403,0x3f54db31,0x3f61c598,0x3f3daef9,0x3f4e8d90,0x3f5d2d53,0x3f696591
.long 0x3f45e403,0x3f5695e5,0x3f64aa59,0x3f6ff573,0x3f4d9f02,0x3f5df6be,0x3f6b4b0c,0x3f756d97
.long 0x3e47c5c2,0x3e605c13,0x3e78cfcc,0x3e888e93,0x3e78cfcc,0x3e8b9507,0x3e9aa086,0x3ea986c4
.long 0x3e94a031,0x3ea68f12,0x3eb8442a,0x3ec9b953,0x3eac7cd4,0x3ec1071e,0x3ed53641,0x3ee900b7
.long 0x3f54db31,0x3f64aa59,0x3f710908,0x3f79c79d,0x3f5b941a,0x3f6aab7b,0x3f75dec6,0x3f7cfe73
.long 0x3f61c598,0x3f6ff573,0x3f79c79d,0x3f7f0e58,0x3f676bd8,0x3f748422,0x3f7cbfc9,0x3f7ff4e6
.long 0x3ec3ef15,0x3edae880,0x3ef15aea,0x3f039c3d,0x3edae880,0x3ef41f07,0x3f064b82,0x3f121eb0
.long 0x3ef15aea,0x3f064b82,0x3f13682a,0x3f1ff6cb,0x3f039c3d,0x3f121eb0,0x3f1ff6cb,0x3f2d1469
.long 0x3f6c835e,0x3f7853f8,0x3f7ec46d,0x3f7fb10f,0x3f710908,0x3f7b61fc,0x3f7fd397,0x3f7e4323
.long 0x3f74fa0b,0x3f7dabcc,0x3f7fec43,0x3f7baccd,0x3f7853f8,0x3f7f2f9d,0x3f7f0e58,0x3f77f110
.long 0x3f0e39da,0x3f1d7fd1,0x3f2beb4a,0x3f396842,0x3f187fc0,0x3f286605,0x3f373a23,0x3f44e3f5
.long 0x3f226799,0x3f32c8c9,0x3f41d870,0x3f4f7a1f,0x3f2beb4a,0x3f3ca003,0x3f4bbbf8,0x3f591e6a
.long 0x3f7b14be,0x3f7fec43,0x3f7d3aac,0x3f731447,0x3f7d3aac,0x3f7fe129,0x3f7a7302,0x3f6d1c1d
.long 0x3f7ec46d,0x3f7f0e58,0x3f76ba07,0x3f660f88,0x3f7fb10f,0x3f7d7474,0x3f721352,0x3f5df6be
.long 0x0,0x0,0x0,0x0,0x3d96a905,0x3da3308c,0x3dafb680,0x3dbc3ac3
.long 0x3e164083,0x3e22abb6,0x3e2f10a2,0x3e3b6ecf,0x3e605c13,0x3e72b651,0x3e827dc0,0x3e8b9507
.long 0x3f6c835e,0x3f74fa0b,0x3f7b14be,0x3f7ec46d,0x3f731447,0x3f7a1e84,0x3f7e70b0,0x3f7ffec4
.long 0x3f7853f8,0x3f7dabcc,0x3f7fec43,0x3f7f0e58,0x3f7c3b28,0x3f7f9c18,0x3f7f84ab,0x3f7bf531
.long 0x3e94a031,0x3ea09ae5,0x3eac7cd4,0x3eb8442a,0x3eb8442a,0x3ec6d529,0x3ed53641,0x3ee363fa
.long 0x3edae880,0x3eebcbbb,0x3efc5d27,0x3f064b82,0x3efc5d27,0x3f07a136,0x3f10d3cd,0x3f19c200
.long 0x3f7ec46d,0x3f7fec43,0x3f7d3aac,0x3f76ba07,0x3f7fec43,0x3f7e9bc9,0x3f791298,0x3f6f6830
.long 0x3f7fb10f,0x3f7baccd,0x3f731447,0x3f660f88,0x3f7e1324,0x3f772417,0x3f6b4b0c,0x3f5ac450
.long 0x3f0e39da,0x3f187fc0,0x3f226799,0x3f2beb4a,0x3f1d7fd1,0x3f286605,0x3f32c8c9,0x3f3ca003
.long 0x3f2beb4a,0x3f373a23,0x3f41d870,0x3f4bbbf8,0x3f396842,0x3f44e3f5,0x3f4f7a1f,0x3f591e6a
.long 0x3f7b14be,0x3f710908,0x3f61c598,0x3f4d9f02,0x3f76ba07,0x3f696591,0x3f5695e5,0x3f3ebc1b
.long 0x3f710908,0x3f604621,0x3f49d112,0x3f2e3bde,0x3f6a09a7,0x3f55b993,0x3f3b8f3b,0x3f1c420c
.long 0x3f45e403,0x3f514d3d,0x3f5b941a,0x3f64aa59,0x3f514d3d,0x3f5c61c7,0x3f660f88,0x3f6e46be
.long 0x3f5b941a,0x3f660f88,0x3f6ed89e,0x3f75dec6,0x3f64aa59,0x3f6e46be,0x3f75dec6,0x3f7b61fc
.long 0x3f61c598,0x3f49d112,0x3f2beb4a,0x3f08f59b,0x3f584853,0x3f3ca003,0x3f1b02c6,0x3ee900b7
.long 0x3f4d9f02,0x3f2e3bde,0x3f08f59b,0x3ebe1d4a,0x3f41d870,0x3f1ebc12,0x3eebcbbb,0x3e919ddd
.long 0x0,0x0,0x0,0x0,0x3dc8bd36,0x3dd53db9,0x3de1bc2e,0x3dee3876
.long 0x3e47c5c2,0x3e541501,0x3e605c13,0x3e6c9a7f,0x3e94a031,0x3e9d9e78,0x3ea68f12,0x3eaf713a
.long 0x3f800000,0x3f7ec46d,0x3f7b14be,0x3f74fa0b,0x3f7ec46d,0x3f7ac516,0x3f740bdd,0x3f6aab7b
.long 0x3f7b14be,0x3f740bdd,0x3f6a09a7,0x3f5d2d53,0x3f74fa0b,0x3f6aab7b,0x3f5d2d53,0x3f4cae79
.long 0x3ec3ef15,0x3ecf7bca,0x3edae880,0x3ee63375,0x3ef15aea,0x3eff17b2,0x3f064b82,0x3f0cead0
.long 0x3f0e39da,0x3f15f6d9,0x3f1d7fd1,0x3f24d225,0x3f226799,0x3f2ac082,0x3f32c8c9,0x3f3a7ca4
.long 0x3f6c835e,0x3f5ebe05,0x3f4d9f02,0x3f396842,0x3f61c598,0x3f5064af,0x3f3b8f3b,0x3f239da9
.long 0x3f54db31,0x3f3fc767,0x3f273656,0x3f0b9a6b,0x3f45e403,0x3f2d1469,0x3f10d3cd,0x3ee363fa
.long 0x3f3504f3,0x3f3daef9,0x3f45e403,0x3f4d9f02,0x3f45e403,0x3f4e8d90,0x3f5695e5,0x3f5df6be
.long 0x3f54db31,0x3f5d2d53,0x3f64aa59,0x3f6b4b0c,0x3f61c598,0x3f696591,0x3f6ff573,0x3f756d97
.long 0x3f3504f3,0x3f187fc0,0x3ef15aea,0x3eac7cd4,0x3f226799,0x3f0242b1,0x3ebe1d4a,0x3e667c66
.long 0x3f0e39da,0x3ed53641,0x3e888e93,0x3de1bc2e,0x3ef15aea,0x3ea395c5,0x3e22abb6,0xbbc90f88
.long 0x3f6c835e,0x3f731447,0x3f7853f8,0x3f7c3b28,0x3f74fa0b,0x3f7a1e84,0x3f7dabcc,0x3f7f9c18
.long 0x3f7b14be,0x3f7e70b0,0x3f7fec43,0x3f7f84ab,0x3f7ec46d,0x3f7ffec4,0x3f7f0e58,0x3f7bf531
.long 0x3ec3ef15,0x3e605c13,0x3d48fb30,0xbdfab273,0x3e94a031,0x3dee3876,0xbd7b2b74,0xbe72b651
.long 0x3e47c5c2,0x3c490e90,0xbe2f10a2,0xbeb263ef,0x3dc8bd36,0xbdbc3ac3,0xbe8e9a22,0xbee900b7
.long 0x0,0x0,0x0,0x0,0x3dfab273,0x3e039502,0x3e09cf86,0x3e1008b7
.long 0x3e78cfcc,0x3e827dc0,0x3e888e93,0x3e8e9a22,0x3eb8442a,0x3ec1071e,0x3ec9b953,0x3ed25a09
.long 0x3f6c835e,0x3f61c598,0x3f54db31,0x3f45e403,0x3f5ebe05,0x3f5064af,0x3f3fc767,0x3f2d1469
.long 0x3f4d9f02,0x3f3b8f3b,0x3f273656,0x3f10d3cd,0x3f396842,0x3f239da9,0x3f0b9a6b,0x3ee363fa
.long 0x3ef15aea,0x3efc5d27,0x3f039c3d,0x3f08f59b,0x3f13682a,0x3f19c200,0x3f1ff6cb,0x3f26050a
.long 0x3f2beb4a,0x3f32c8c9,0x3f396842,0x3f3fc767,0x3f41d870,0x3f48d8b3,0x3f4f7a1f,0x3f55b993
.long 0x3f226799,0x3f08f59b,0x3edae880,0x3ea09ae5,0x3f08f59b,0x3ed8106b,0x3e9aa086,0x3e354098
.long 0x3edae880,0x3e9aa086,0x3e2f10a2,0x3d16c32c,0x3ea09ae5,0x3e354098,0x3d16c32c,0xbdd53db9
.long 0x3f54db31,0x3f5b941a,0x3f61c598,0x3f676bd8,0x3f64aa59,0x3f6aab7b,0x3f6ff573,0x3f748422
.long 0x3f710908,0x3f75dec6,0x3f79c79d,0x3f7cbfc9,0x3f79c79d,0x3f7cfe73,0x3f7f0e58,0x3f7ff4e6
.long 0x3e47c5c2,0x3d48fb30,0xbdc8bd36,0xbe78cfcc,0x3d96a905,0xbda3308c,0xbe6c9a7f,0xbec1071e
.long 0xbd48fb30,0xbe541501,0xbeb8442a,0xbf00e7e4,0xbe2f10a2,0xbea986c4,0xbef6e0cb,0xbf1ebc12
.long 0x3f7ec46d,0x3f7fec43,0x3f7fb10f,0x3f7e1324,0x3f7fec43,0x3f7e9bc9,0x3f7baccd,0x3f772417
.long 0x3f7d3aac,0x3f791298,0x3f731447,0x3f6b4b0c,0x3f76ba07,0x3f6f6830,0x3f660f88,0x3f5ac450
.long 0xbe94a031,0xbee63375,0xbf187fc0,0xbf396842,0xbecf7bca,0xbf0f8784,0xbf32c8c9,0xbf5064af
.long 0xbf039c3d,0xbf299415,0xbf49d112,0xbf633c5a,0xbf1d7fd1,0xbf40d0da,0xbf5d2d53,0xbf718f57
.long 0x0,0x0,0x0,0x0,0x3e164083,0x3e1c76de,0x3e22abb6,0x3e28defc
.long 0x3e94a031,0x3e9aa086,0x3ea09ae5,0x3ea68f12,0x3edae880,0x3ee363fa,0x3eebcbbb,0x3ef41f07
.long 0x3f3504f3,0x3f226799,0x3f0e39da,0x3ef15aea,0x3f187fc0,0x3f0242b1,0x3ed53641,0x3ea395c5
.long 0x3ef15aea,0x3ebe1d4a,0x3e888e93,0x3e22abb6,0x3eac7cd4,0x3e667c66,0x3de1bc2e,0xbbc90f88
.long 0x3f0e39da,0x3f13682a,0x3f187fc0,0x3f1d7fd1,0x3f2beb4a,0x3f31a81d,0x3f373a23,0x3f3ca003
.long 0x3f45e403,0x3f4bbbf8,0x3f514d3d,0x3f5695e5,0x3f5b941a,0x3f6106f2,0x3f660f88,0x3f6aab7b
.long 0x3e47c5c2,0x3d96a905,0xbd48fb30,0xbe2f10a2,0x3d48fb30,0xbda3308c,0xbe541501,0xbea986c4
.long 0xbdc8bd36,0xbe6c9a7f,0xbeb8442a,0xbef6e0cb,0xbe78cfcc,0xbec1071e,0xbf00e7e4,0xbf1ebc12
.long 0x3f6c835e,0x3f710908,0x3f74fa0b,0x3f7853f8,0x3f7853f8,0x3f7b61fc,0x3f7dabcc,0x3f7f2f9d
.long 0x3f7ec46d,0x3f7fd397,0x3f7fec43,0x3f7f0e58,0x3f7fb10f,0x3f7e4323,0x3f7baccd,0x3f77f110
.long 0xbec3ef15,0xbf039c3d,0xbf226799,0xbf3daef9,0xbf039c3d,0xbf239da9,0xbf3fc767,0xbf577026
.long 0xbf226799,0xbf3fc767,0xbf584853,0xbf6b4b0c,0xbf3daef9,0xbf577026,0xbf6b4b0c,0xbf78b47b
.long 0x3f7b14be,0x3f76ba07,0x3f710908,0x3f6a09a7,0x3f710908,0x3f696591,0x3f604621,0x3f55b993
.long 0x3f61c598,0x3f5695e5,0x3f49d112,0x3f3b8f3b,0x3f4d9f02,0x3f3ebc1b,0x3f2e3bde,0x3f1c420c
.long 0xbf54db31,0xbf6a09a7,0xbf7853f8,0xbf7f4e6d,0xbf676bd8,0xbf772417,0xbf7f0e58,0xbf7eea9d
.long 0xbf74fa0b,0xbf7e70b0,0xbf7f4e6d,0xbf778bc5,0xbf7d3aac,0xbf7fc38f,0xbf791298,0xbf696591
.long 0x0,0x0,0x0,0x0,0x3e2f10a2,0x3e354098,0x3e3b6ecf,0x3e419b37
.long 0x3eac7cd4,0x3eb263ef,0x3eb8442a,0x3ebe1d4a,0x3efc5d27,0x3f0242b1,0x3f064b82,0x3f0a48ad
.long 0x3ec3ef15,0x3e94a031,0x3e47c5c2,0x3dc8bd36,0x3e605c13,0x3dee3876,0x3c490e90,0xbdbc3ac3
.long 0x3d48fb30,0xbd7b2b74,0xbe2f10a2,0xbe8e9a22,0xbdfab273,0xbe72b651,0xbeb263ef,0xbee900b7
.long 0x3f226799,0x3f273656,0x3f2beb4a,0x3f3085bb,0x3f41d870,0x3f46e22a,0x3f4bbbf8,0x3f5064af
.long 0x3f5b941a,0x3f604621,0x3f64aa59,0x3f68bf3c,0x3f6ed89e,0x3f7294f8,0x3f75dec6,0x3f78b47b
.long 0xbe94a031,0xbecf7bca,0xbf039c3d,0xbf1d7fd1,0xbee63375,0xbf0f8784,0xbf299415,0xbf40d0da
.long 0xbf187fc0,0xbf32c8c9,0xbf49d112,0xbf5d2d53,0xbf396842,0xbf5064af,0xbf633c5a,0xbf718f57
.long 0x3f7b14be,0x3f7d3aac,0x3f7ec46d,0x3f7fb10f,0x3f7fec43,0x3f7fe129,0x3f7f0e58,0x3f7d7474
.long 0x3f7d3aac,0x3f7a7302,0x3f76ba07,0x3f721352,0x3f731447,0x3f6d1c1d,0x3f660f88,0x3f5df6be
.long 0xbf54db31,0xbf676bd8,0xbf74fa0b,0xbf7d3aac,0xbf6a09a7,0xbf772417,0xbf7e70b0,0xbf7fc38f
.long 0xbf7853f8,0xbf7f0e58,0xbf7f4e6d,0xbf791298,0xbf7f4e6d,0xbf7eea9d,0xbf778bc5,0xbf696591
.long 0x3f61c598,0x3f584853,0x3f4d9f02,0x3f41d870,0x3f49d112,0x3f3ca003,0x3f2e3bde,0x3f1ebc12
.long 0x3f2beb4a,0x3f1b02c6,0x3f08f59b,0x3eebcbbb,0x3f08f59b,0x3ee900b7,0x3ebe1d4a,0x3e919ddd
.long 0xbf7ec46d,0xbf76ba07,0xbf676bd8,0xbf514d3d,0xbf76ba07,0xbf66becc,0xbf4f7a1f,0xbf31a81d
.long 0xbf676bd8,0xbf4f7a1f,0xbf3085bb,0xbf0b9a6b,0xbf514d3d,0xbf31a81d,0xbf0b9a6b,0xbec1071e
.long 0x3f803f80,0x3f803f80,0x3f803f80,0x3f803f80,0x3f7b3f80,0x3f553f6d,0xbe48248d,0xbf0ebec4
.long 0x3f6d3f80,0x3ec43f35,0xbf6dbf80,0xbec4bf35,0x3f553f80,0xbe483ec4,0x3f0ea554,0x3f7b3f6d
.long 0x3f353f80,0xbf35248d,0x3f353f80,0xbf35248d,0x3f0e3f80,0xbf7bbec4,0xbf55248d,0xbe48bf6d
.long 0x3ec43f80,0xbf6dbf35,0xbec4bf80,0x3f6d3f35,0x3e483f80,0xbf0ebf6d,0x3f7ba554,0xbf553ec4
.long 0x248d3f80,0xa554bf80,0x248d3f80,0xa554bf80,0xbe483f80,0x3f0ebf6d,0xbf7b248d,0x3f553ec4
.long 0xbec43f80,0x3f6dbf35,0x3ec4bf80,0xbf6d3f35,0xbf0e3f80,0x3f7bbec4,0x3f55a554,0x3e48bf6d
.long 0xbf353f80,0x3f35a554,0xbf353f80,0x3f35a554,0xbf553f80,0x3e483ec4,0xbf0e248d,0xbf7b3f6d
.long 0xbf6d3f80,0xbec43f35,0x3f6dbf80,0x3ec4bf35,0xbf7b3f80,0xbf553f6d,0x3e48a554,0x3f0ebec4
.long 0xbf803f80,0xbf803f80,0xbf803f80,0xbf803f80,0xbf7b3f80,0xbf553f6d,0x3e48248d,0x3f0ebec4
.long 0xbf6d3f80,0xbec43f35,0x3f6dbf80,0x3ec4bf35,0xbf553f80,0x3e483ec4,0xbf0ea554,0xbf7b3f6d
.long 0xbf353f80,0x3f35248d,0xbf353f80,0x3f35248d,0xbf0e3f80,0x3f7bbec4,0x3f55248d,0x3e48bf6d
.long 0xbec43f80,0x3f6dbf35,0x3ec4bf80,0xbf6d3f35,0xbe483f80,0x3f0ebf6d,0xbf7ba554,0x3f553ec4
.long 0xa5543f80,0x248dbf80,0xa5543f80,0x248dbf80,0x3e483f80,0xbf0ebf6d,0x3f7b248d,0xbf553ec4
.long 0x3ec43f80,0xbf6dbf35,0xbec4bf80,0x3f6d3f35,0x3f0e3f80,0xbf7bbec4,0xbf55a554,0xbe48bf6d
.long 0x3f353f80,0xbf35a554,0x3f353f80,0xbf35a554,0x3f553f80,0xbe483ec4,0x3f0e248d,0x3f7b3f6d
.long 0x3f6d3f80,0x3ec43f35,0xbf6dbf80,0xbec4bf35,0x3f7b3f80,0x3f553f6d,0xbe48a554,0xbf0ebec4
.long 0x3f803f80,0x3f803f80,0x3f803f80,0x3f803f80,0x3f0e3f35,0x3e483ec4,0xbf55bf35,0xbf7bbf6d
.long 0xbec4248d,0xbf6dbf35,0x3ec4a554,0x3f6d3f35,0xbf7bbf35,0xbf0ebf6d,0x3e483f35,0xbf55bec4
.long 0xbf35bf80,0x3f35a554,0xbf35bf80,0x3f35a554,0x3e48bf35,0x3f553f6d,0x3f7b3f35,0xbf0e3ec4
.long 0x3f6da554,0xbec43f35,0xbf6d248d,0x3ec4bf35,0x3f553f35,0xbf7bbec4,0x3f0ebf35,0xbe483f6d
.long 0x248d3f80,0xa554bf80,0x248d3f80,0xa554bf80,0xbf553f35,0x3f7bbec4,0xbf0ebf35,0x3e483f6d
.long 0xbf6d248d,0x3ec43f35,0x3f6da554,0xbec4bf35,0xbe48bf35,0xbf553f6d,0xbf7b3f35,0x3f0e3ec4
.long 0x3f35bf80,0xbf35248d,0x3f35bf80,0xbf35248d,0x3f7bbf35,0x3f0ebf6d,0xbe483f35,0x3f55bec4
.long 0x3ec4a554,0x3f6dbf35,0xbec4248d,0xbf6d3f35,0xbf0e3f35,0xbe483ec4,0x3f55bf35,0x3f7bbf6d
.long 0xbf803f80,0xbf803f80,0xbf803f80,0xbf803f80,0xbf0e3f35,0xbe483ec4,0x3f55bf35,0x3f7bbf6d
.long 0x3ec4248d,0x3f6dbf35,0xbec4a554,0xbf6d3f35,0x3f7bbf35,0x3f0ebf6d,0xbe483f35,0x3f55bec4
.long 0x3f35bf80,0xbf35a554,0x3f35bf80,0xbf35a554,0xbe48bf35,0xbf553f6d,0xbf7b3f35,0x3f0e3ec4
.long 0xbf6da554,0x3ec43f35,0x3f6d248d,0xbec4bf35,0xbf553f35,0x3f7bbec4,0xbf0ebf35,0x3e483f6d
.long 0xa5543f80,0x248dbf80,0xa5543f80,0x248dbf80,0x3f553f35,0xbf7bbec4,0x3f0ebf35,0xbe483f6d
.long 0x3f6d248d,0xbec43f35,0xbf6da554,0x3ec4bf35,0x3e48bf35,0x3f553f6d,0x3f7b3f35,0xbf0e3ec4
.long 0xbf35bf80,0x3f35248d,0xbf35bf80,0x3f35248d,0xbf7bbf35,0xbf0ebf6d,0x3e483f35,0xbf55bec4
.long 0xbec4a554,0xbf6dbf35,0x3ec4248d,0x3f6d3f35,0x3f0e3f35,0x3e483ec4,0xbf55bf35,0xbf7bbf6d
.long 0x3f803f80,0x3f803f80,0x3f803f80,0x3f803f80,0xbf7bbf80,0xbf55bf6d,0x3e48a554,0x3f0e3ec4
.long 0x3f6d3f80,0x3ec43f35,0xbf6dbf80,0xbec4bf35,0xbf55bf80,0x3e48bec4,0xbf0e248d,0xbf7bbf6d
.long 0x3f353f80,0xbf35248d,0x3f353f80,0xbf35248d,0xbf0ebf80,0x3f7b3ec4,0x3f55a554,0x3e483f6d
.long 0x3ec43f80,0xbf6dbf35,0xbec4bf80,0x3f6d3f35,0xbe48bf80,0x3f0e3f6d,0xbf7b248d,0x3f55bec4
.long 0x248d3f80,0xa554bf80,0x248d3f80,0xa554bf80,0x3e48bf80,0xbf0e3f6d,0x3f7ba554,0xbf55bec4
.long 0xbec43f80,0x3f6dbf35,0x3ec4bf80,0xbf6d3f35,0x3f0ebf80,0xbf7b3ec4,0xbf55248d,0xbe483f6d
.long 0xbf353f80,0x3f35a554,0xbf353f80,0x3f35a554,0x3f55bf80,0xbe48bec4,0x3f0ea554,0x3f7bbf6d
.long 0xbf6d3f80,0xbec43f35,0x3f6dbf80,0x3ec4bf35,0x3f7bbf80,0x3f55bf6d,0xbe48248d,0xbf0e3ec4
.long 0xbf803f80,0xbf803f80,0xbf803f80,0xbf803f80,0x3f7bbf80,0x3f55bf6d,0xbe48a554,0xbf0e3ec4
.long 0xbf6d3f80,0xbec43f35,0x3f6dbf80,0x3ec4bf35,0x3f55bf80,0xbe48bec4,0x3f0e248d,0x3f7bbf6d
.long 0xbf353f80,0x3f35248d,0xbf353f80,0x3f35248d,0x3f0ebf80,0xbf7b3ec4,0xbf55a554,0xbe483f6d
.long 0xbec43f80,0x3f6dbf35,0x3ec4bf80,0xbf6d3f35,0x3e48bf80,0xbf0e3f6d,0x3f7b248d,0xbf55bec4
.long 0xa5543f80,0x248dbf80,0xa5543f80,0x248dbf80,0xbe48bf80,0x3f0e3f6d,0xbf7ba554,0x3f55bec4
.long 0x3ec43f80,0xbf6dbf35,0xbec4bf80,0x3f6d3f35,0xbf0ebf80,0x3f7b3ec4,0x3f55248d,0x3e483f6d
.long 0x3f353f80,0xbf35a554,0x3f353f80,0xbf35a554,0xbf55bf80,0x3e48bec4,0xbf0ea554,0xbf7bbf6d
.long 0x3f6d3f80,0x3ec43f35,0xbf6dbf80,0xbec4bf35,0xbf7bbf80,0xbf55bf6d,0x3e48248d,0x3f0e3ec4
.long 0x3f803f80,0x3f803f80,0x3f803f80,0x3f803f80,0xbf0ebf35,0xbe48bec4,0x3f553f35,0x3f7b3f6d
.long 0xbec4248d,0xbf6dbf35,0x3ec4a554,0x3f6d3f35,0x3f7b3f35,0x3f0e3f6d,0xbe48bf35,0x3f553ec4
.long 0xbf35bf80,0x3f35a554,0xbf35bf80,0x3f35a554,0xbe483f35,0xbf55bf6d,0xbf7bbf35,0x3f0ebec4
.long 0x3f6da554,0xbec43f35,0xbf6d248d,0x3ec4bf35,0xbf55bf35,0x3f7b3ec4,0xbf0e3f35,0x3e48bf6d
.long 0x248d3f80,0xa554bf80,0x248d3f80,0xa554bf80,0x3f55bf35,0xbf7b3ec4,0x3f0e3f35,0xbe48bf6d
.long 0xbf6d248d,0x3ec43f35,0x3f6da554,0xbec4bf35,0x3e483f35,0x3f55bf6d,0x3f7bbf35,0xbf0ebec4
.long 0x3f35bf80,0xbf35248d,0x3f35bf80,0xbf35248d,0xbf7b3f35,0xbf0e3f6d,0x3e48bf35,0xbf553ec4
.long 0x3ec4a554,0x3f6dbf35,0xbec4248d,0xbf6d3f35,0x3f0ebf35,0x3e48bec4,0xbf553f35,0xbf7b3f6d
.long 0xbf803f80,0xbf803f80,0xbf803f80,0xbf803f80,0x3f0ebf35,0x3e48bec4,0xbf553f35,0xbf7b3f6d
.long 0x3ec4248d,0x3f6dbf35,0xbec4a554,0xbf6d3f35,0xbf7b3f35,0xbf0e3f6d,0x3e48bf35,0xbf553ec4
.long 0x3f35bf80,0xbf35a554,0x3f35bf80,0xbf35a554,0x3e483f35,0x3f55bf6d,0x3f7bbf35,0xbf0ebec4
.long 0xbf6da554,0x3ec43f35,0x3f6d248d,0xbec4bf35,0x3f55bf35,0xbf7b3ec4,0x3f0e3f35,0xbe48bf6d
.long 0xa5543f80,0x248dbf80,0xa5543f80,0x248dbf80,0xbf55bf35,0x3f7b3ec4,0xbf0e3f35,0x3e48bf6d
.long 0x3f6d248d,0xbec43f35,0xbf6da554,0x3ec4bf35,0xbe483f35,0xbf55bf6d,0xbf7bbf35,0x3f0ebec4
.long 0xbf35bf80,0x3f35248d,0xbf35bf80,0x3f35248d,0x3f7b3f35,0x3f0e3f6d,0xbe48bf35,0x3f553ec4
.long 0xbec4a554,0xbf6dbf35,0x3ec4248d,0x3f6d3f35,0xbf0ebf35,0xbe48bec4,0x3f553f35,0x3f7b3f6d
.long 0x80008000,0x80008000,0x80008000,0x80008000,0xbe488000,0xbf0ebec4,0xbf7bbf80,0xbf55bf6d
.long 0xbec48000,0xbf6dbf35,0x3ec4a50d,0x3f6d3f35,0xbf0e8000,0xbf7bbf6d,0x3f553f80,0xbe483ec4
.long 0xbf358000,0xbf35bf80,0xbf358000,0xbf35bf80,0xbf558000,0xbe48bf6d,0xbf0ebf80,0x3f7b3ec4
.long 0xbf6d8000,0x3ec4bf35,0x3f6da50d,0xbec43f35,0xbf7b8000,0x3f55bec4,0x3e483f80,0xbf0ebf6d
.long 0xbf808000,0x3f80a50d,0xbf808000,0x3f80a50d,0xbf7b8000,0x3f553ec4,0x3e48bf80,0xbf0e3f6d
.long 0xbf6d8000,0x3ec43f35,0x3f6da50d,0xbec4bf35,0xbf558000,0xbe483f6d,0xbf0e3f80,0x3f7bbec4
.long 0xbf358000,0xbf353f80,0xbf358000,0xbf353f80,0xbf0e8000,0xbf7b3f6d,0x3f55bf80,0xbe48bec4
.long 0xbec48000,0xbf6d3f35,0x3ec4a50d,0x3f6dbf35,0xbe488000,0xbf0e3ec4,0xbf7b3f80,0xbf553f6d
.long 0xa50d8000,0xa50d8000,0xa50d8000,0xa50d8000,0x3e488000,0x3f0ebec4,0x3f7bbf80,0x3f55bf6d
.long 0x3ec48000,0x3f6dbf35,0xbec4a50d,0xbf6d3f35,0x3f0e8000,0x3f7bbf6d,0xbf553f80,0x3e483ec4
.long 0x3f358000,0x3f35bf80,0x3f358000,0x3f35bf80,0x3f558000,0x3e48bf6d,0x3f0ebf80,0xbf7b3ec4
.long 0x3f6d8000,0xbec4bf35,0xbf6da50d,0x3ec43f35,0x3f7b8000,0xbf55bec4,0xbe483f80,0x3f0ebf6d
.long 0x3f808000,0xbf80a50d,0x3f808000,0xbf80a50d,0x3f7b8000,0xbf553ec4,0xbe48bf80,0x3f0e3f6d
.long 0x3f6d8000,0xbec43f35,0xbf6da50d,0x3ec4bf35,0x3f558000,0x3e483f6d,0x3f0e3f80,0xbf7bbec4
.long 0x3f358000,0x3f353f80,0x3f358000,0x3f353f80,0x3f0e8000,0x3f7b3f6d,0xbf55bf80,0x3e48bec4
.long 0x3ec48000,0x3f6d3f35,0xbec4a50d,0xbf6dbf35,0x3e488000,0x3f0e3ec4,0x3f7b3f80,0x3f553f6d
.long 0x80008000,0x80008000,0x80008000,0x80008000,0xbf55bf35,0xbf7bbf6d,0xbf0ebf35,0xbe48bec4
.long 0xbf6dbf80,0xbec4bf35,0x3f6d3f80,0x3ec43f35,0xbe48bf35,0x3f553ec4,0xbf7bbf35,0xbf0ebf6d
.long 0x3f35a50d,0x3f353f80,0x3f35a50d,0x3f353f80,0x3f7b3f35,0xbf0e3ec4,0xbe483f35,0xbf55bf6d
.long 0x3ec43f80,0xbf6dbf35,0xbec4bf80,0x3f6d3f35,0xbf0e3f35,0x3e48bf6d,0x3f553f35,0xbf7bbec4
.long 0xbf808000,0x3f80a50d,0xbf808000,0x3f80a50d,0xbf0ebf35,0x3e483f6d,0x3f55bf35,0xbf7b3ec4
.long 0x3ec4bf80,0xbf6d3f35,0xbec43f80,0x3f6dbf35,0x3f7bbf35,0xbf0ebec4,0xbe48bf35,0xbf553f6d
.long 0x3f35a50d,0x3f35bf80,0x3f35a50d,0x3f35bf80,0xbe483f35,0x3f55bec4,0xbf7b3f35,0xbf0e3f6d
.long 0xbf6d3f80,0xbec43f35,0x3f6dbf80,0x3ec4bf35,0xbf553f35,0xbf7b3f6d,0xbf0e3f35,0xbe483ec4
.long 0xa50d8000,0xa50d8000,0xa50d8000,0xa50d8000,0x3f55bf35,0x3f7bbf6d,0x3f0ebf35,0x3e48bec4
.long 0x3f6dbf80,0x3ec4bf35,0xbf6d3f80,0xbec43f35,0x3e48bf35,0xbf553ec4,0x3f7bbf35,0x3f0ebf6d
.long 0xbf35a50d,0xbf353f80,0xbf35a50d,0xbf353f80,0xbf7b3f35,0x3f0e3ec4,0x3e483f35,0x3f55bf6d
.long 0xbec43f80,0x3f6dbf35,0x3ec4bf80,0xbf6d3f35,0x3f0e3f35,0xbe48bf6d,0xbf553f35,0x3f7bbec4
.long 0x3f808000,0xbf80a50d,0x3f808000,0xbf80a50d,0x3f0ebf35,0xbe483f6d,0xbf55bf35,0x3f7b3ec4
.long 0xbec4bf80,0x3f6d3f35,0x3ec43f80,0xbf6dbf35,0xbf7bbf35,0x3f0ebec4,0x3e48bf35,0x3f553f6d
.long 0xbf35a50d,0xbf35bf80,0xbf35a50d,0xbf35bf80,0x3e483f35,0xbf55bec4,0x3f7b3f35,0x3f0e3f6d
.long 0x3f6d3f80,0x3ec43f35,0xbf6dbf80,0xbec4bf35,0x3f553f35,0x3f7b3f6d,0x3f0e3f35,0x3e483ec4
.long 0x80008000,0x80008000,0x80008000,0x80008000,0x3e48a50d,0x3f0e3ec4,0x3f7b3f80,0x3f553f6d
.long 0xbec48000,0xbf6dbf35,0x3ec4a50d,0x3f6d3f35,0x3f0ea50d,0x3f7b3f6d,0xbf55bf80,0x3e48bec4
.long 0xbf358000,0xbf35bf80,0xbf358000,0xbf35bf80,0x3f55a50d,0x3e483f6d,0x3f0e3f80,0xbf7bbec4
.long 0xbf6d8000,0x3ec4bf35,0x3f6da50d,0xbec43f35,0x3f7ba50d,0xbf553ec4,0xbe48bf80,0x3f0e3f6d
.long 0xbf808000,0x3f80a50d,0xbf808000,0x3f80a50d,0x3f7ba50d,0xbf55bec4,0xbe483f80,0x3f0ebf6d
.long 0xbf6d8000,0x3ec43f35,0x3f6da50d,0xbec4bf35,0x3f55a50d,0x3e48bf6d,0x3f0ebf80,0xbf7b3ec4
.long 0xbf358000,0xbf353f80,0xbf358000,0xbf353f80,0x3f0ea50d,0x3f7bbf6d,0xbf553f80,0x3e483ec4
.long 0xbec48000,0xbf6d3f35,0x3ec4a50d,0x3f6dbf35,0x3e48a50d,0x3f0ebec4,0x3f7bbf80,0x3f55bf6d
.long 0xa50d8000,0xa50d8000,0xa50d8000,0xa50d8000,0xbe48a50d,0xbf0e3ec4,0xbf7b3f80,0xbf553f6d
.long 0x3ec48000,0x3f6dbf35,0xbec4a50d,0xbf6d3f35,0xbf0ea50d,0xbf7b3f6d,0x3f55bf80,0xbe48bec4
.long 0x3f358000,0x3f35bf80,0x3f358000,0x3f35bf80,0xbf55a50d,0xbe483f6d,0xbf0e3f80,0x3f7bbec4
.long 0x3f6d8000,0xbec4bf35,0xbf6da50d,0x3ec43f35,0xbf7ba50d,0x3f553ec4,0x3e48bf80,0xbf0e3f6d
.long 0x3f808000,0xbf80a50d,0x3f808000,0xbf80a50d,0xbf7ba50d,0x3f55bec4,0x3e483f80,0xbf0ebf6d
.long 0x3f6d8000,0xbec43f35,0xbf6da50d,0x3ec4bf35,0xbf55a50d,0xbe48bf6d,0xbf0ebf80,0x3f7b3ec4
.long 0x3f358000,0x3f353f80,0x3f358000,0x3f353f80,0xbf0ea50d,0xbf7bbf6d,0x3f553f80,0xbe483ec4
.long 0x3ec48000,0x3f6d3f35,0xbec4a50d,0xbf6dbf35,0xbe48a50d,0xbf0ebec4,0xbf7bbf80,0xbf55bf6d
.long 0x80008000,0x80008000,0x80008000,0x80008000,0x3f553f35,0x3f7b3f6d,0x3f0e3f35,0x3e483ec4
.long 0xbf6dbf80,0xbec4bf35,0x3f6d3f80,0x3ec43f35,0x3e483f35,0xbf55bec4,0x3f7b3f35,0x3f0e3f6d
.long 0x3f35a50d,0x3f353f80,0x3f35a50d,0x3f353f80,0xbf7bbf35,0x3f0ebec4,0x3e48bf35,0x3f553f6d
.long 0x3ec43f80,0xbf6dbf35,0xbec4bf80,0x3f6d3f35,0x3f0ebf35,0xbe483f6d,0xbf55bf35,0x3f7b3ec4
.long 0xbf808000,0x3f80a50d,0xbf808000,0x3f80a50d,0x3f0e3f35,0xbe48bf6d,0xbf553f35,0x3f7bbec4
.long 0x3ec4bf80,0xbf6d3f35,0xbec43f80,0x3f6dbf35,0xbf7b3f35,0x3f0e3ec4,0x3e483f35,0x3f55bf6d
.long 0x3f35a50d,0x3f35bf80,0x3f35a50d,0x3f35bf80,0x3e48bf35,0xbf553ec4,0x3f7bbf35,0x3f0ebf6d
.long 0xbf6d3f80,0xbec43f35,0x3f6dbf80,0x3ec4bf35,0x3f55bf35,0x3f7bbf6d,0x3f0ebf35,0x3e48bec4
.long 0xa50d8000,0xa50d8000,0xa50d8000,0xa50d8000,0xbf553f35,0xbf7b3f6d,0xbf0e3f35,0xbe483ec4
.long 0x3f6dbf80,0x3ec4bf35,0xbf6d3f80,0xbec43f35,0xbe483f35,0x3f55bec4,0xbf7b3f35,0xbf0e3f6d
.long 0xbf35a50d,0xbf353f80,0xbf35a50d,0xbf353f80,0x3f7bbf35,0xbf0ebec4,0xbe48bf35,0xbf553f6d
.long 0xbec43f80,0x3f6dbf35,0x3ec4bf80,0xbf6d3f35,0xbf0ebf35,0x3e483f6d,0x3f55bf35,0xbf7b3ec4
.long 0x3f808000,0xbf80a50d,0x3f808000,0xbf80a50d,0xbf0e3f35,0x3e48bf6d,0x3f553f35,0xbf7bbec4
.long 0xbec4bf80,0x3f6d3f35,0x3ec43f80,0xbf6dbf35,0x3f7b3f35,0xbf0e3ec4,0xbe483f35,0xbf55bf6d
.long 0xbf35a50d,0xbf35bf80,0xbf35a50d,0xbf35bf80,0xbe48bf35,0x3f553ec4,0xbf7bbf35,0xbf0ebf6d
.long 0x3f6d3f80,0x3ec43f35,0xbf6dbf80,0xbec4bf35,0xbf55bf35,0xbf7bbf6d,0xbf0ebf35,0xbe48bec4
.size L_tab, 41984

.section .rodata,"a"
.p2align 6
.amdhsa_kernel concat_heads__ssm_conv_s4d__spectral_gfnet__prompt_kernel
  .amdhsa_next_free_vgpr 168
  .amdhsa_next_free_sgpr 102
  .amdhsa_accum_offset 168
  .amdhsa_group_segment_fixed_size 0
  .amdhsa_kernarg_size 104
  .amdhsa_user_sgpr_count 2
  .amdhsa_user_sgpr_kernarg_segment_ptr 1
  .amdhsa_system_sgpr_workgroup_id_x 1
.end_amdhsa_kernel
```
